```python
import torch

def _softmax(x, axis=-1):
    return torch.softmax(x, dim=axis)
def _gelu(x):
    return torch.nn.functional.gelu(x, approximate="tanh")
def _silu(x):
    return torch.nn.functional.silu(x)
def _sigmoid(x):
    return torch.sigmoid(x)
def _layernorm(x, axis=-1, eps=1e-5):
    m = x.mean(dim=axis, keepdim=True)
    v = x.var(dim=axis, keepdim=True, unbiased=False)
    return (x - m) / torch.sqrt(v + eps)
def _scatter_add(tgt, idx, src, axis=0):
    return tgt.clone().index_add_(axis, idx, src)
def _segment_sum(src, seg, n):
    out = torch.zeros((n,) + src.shape[1:], dtype=src.dtype)
    return out.index_add_(0, seg, src)
def _pad(x, pw):
    flat = tuple(v for pair in reversed(pw) for v in pair)
    return torch.nn.functional.pad(x, flat)

kernel_name = 'concat_heads__mha_block_cached__mha_block_cached__near_ridge'

def setup_inputs():

    _w = (lambda a: (lambda t: t.to(torch.bfloat16) if t.is_floating_point() else t)(torch.as_tensor(a)))
    def _A_setup():
        B, Sq, D = 8, 96, 448
        H, Sk, Dh = 16, 512, 256
        return {
            "x": _w((lambda *s: torch.randn(*s, dtype=torch.bfloat16) * 0.8)(B, Sq, D)),
            "k_cache": _w((lambda *s: torch.randn(*s, dtype=torch.bfloat16) * 0.8)(B, H, Sk, Dh)),
            "v_cache": _w((lambda *s: torch.randn(*s, dtype=torch.bfloat16) * 0.05)(B, H, Sk, Dh)),
            "wq": _w((lambda *s: torch.randn(*s, dtype=torch.bfloat16) * 0.8)(D, H * Dh) * (D ** -0.5)),
            "wo": _w((lambda *s: torch.randn(*s, dtype=torch.bfloat16) * 0.05)(H * Dh, D) * ((H * Dh) ** -0.5)),
        }
    _A_in = _A_setup()

    def _B_setup():
        B, Sq, D = 8, 96, 448
        H, Sk, Dh = 16, 512, 256
        return {
            "x": _w((lambda *s: torch.randn(*s, dtype=torch.bfloat16) * 0.8)(B, Sq, D)),
            "k_cache": _w((lambda *s: torch.randn(*s, dtype=torch.bfloat16) * 0.8)(B, H, Sk, Dh)),
            "v_cache": _w((lambda *s: torch.randn(*s, dtype=torch.bfloat16) * 0.05)(B, H, Sk, Dh)),
            "wq": _w((lambda *s: torch.randn(*s, dtype=torch.bfloat16) * 0.8)(D, H * Dh) * (D ** -0.5)),
            "wo": _w((lambda *s: torch.randn(*s, dtype=torch.bfloat16) * 0.05)(H * Dh, D) * ((H * Dh) ** -0.5)),
        }
    _B_in = _B_setup()

    return {
        "A_x": _A_in["x"],
        "A_k_cache": _A_in["k_cache"],
        "A_v_cache": _A_in["v_cache"],
        "A_wq": _A_in["wq"],
        "A_wo": _A_in["wo"],
        "B_x": _B_in["x"],
        "B_k_cache": _B_in["k_cache"],
        "B_v_cache": _B_in["v_cache"],
        "B_wq": _B_in["wq"],
        "B_wo": _B_in["wo"],
    }

def reference(A_x, A_k_cache, A_v_cache, A_wq, A_wo, B_x, B_k_cache, B_v_cache, B_wq, B_wo):
    def _A_ref(x, k_cache, v_cache, wq, wo):
        B, Sq, D = x.shape
        H, Dh = 16, 256
        q = (lambda x, *d: x.permute(*d))((x @ wq).reshape(B, Sq, H, Dh), 0, 2, 1, 3)
        scores = torch.einsum("bhqd,bhkd->bhqk", q, k_cache) * (Dh ** -0.5)
        p = _softmax(scores, axis=-1)
        o = torch.einsum("bhqk,bhkd->bhqd", p, v_cache)
        return (lambda x, *d: x.permute(*d))(o, 0, 2, 1, 3).reshape(B, Sq, H * Dh) @ wo

    def _B_ref(x, k_cache, v_cache, wq, wo):
        B, Sq, D = x.shape
        H, Dh = 16, 256
        q = (lambda x, *d: x.permute(*d))((x @ wq).reshape(B, Sq, H, Dh), 0, 2, 1, 3)
        scores = torch.einsum("bhqd,bhkd->bhqk", q, k_cache) * (Dh ** -0.5)
        p = _softmax(scores, axis=-1)
        o = torch.einsum("bhqk,bhkd->bhqd", p, v_cache)
        return (lambda x, *d: x.permute(*d))(o, 0, 2, 1, 3).reshape(B, Sq, H * Dh) @ wo

    a = _A_ref(A_x, A_k_cache, A_v_cache, A_wq, A_wo)
    b = _B_ref(B_x, B_k_cache, B_v_cache, B_wq, B_wo)
    return torch.concatenate([a, b], axis=-1)
```

```asm
; @launch grid=(256,1,1) block=(512,1,1) lds=163840
.amdgcn_target "amdgcn-amd-amdhsa--gfx950"
.text
.globl concat_heads__mha_block_cached__mha_block_cached__near_ridge_kernel
.p2align 8
.type concat_heads__mha_block_cached__mha_block_cached__near_ridge_kernel,@function
concat_heads__mha_block_cached__mha_block_cached__near_ridge_kernel:
    s_cmp_ge_u32 s2, 256
    s_cbranch_scc1 L_end1
    s_load_dwordx16 s[40:55], s[0:1], 0
    s_load_dwordx4 s[56:59], s[0:1], 64
    s_load_dwordx2 s[60:61], s[0:1], 96
    s_and_b32 s3, s2, 7
    s_lshr_b32 s39, s2, 3
    s_lshr_b32 s24, s39, 3
    s_lshl_b32 s3, s3, 2
    s_add_u32 s3, s3, s24
    s_lshr_b32 s21, s3, 4
    s_and_b32 s22, s3, 15
    s_and_b32 s23, s39, 7
    v_lshrrev_b32 v14, 6, v0
    s_nop 0
    v_readfirstlane_b32 s16, v14
    v_and_b32 v0, 255, v0
    s_lshr_b32 s28, s23, 2
    s_and_b32 s27, s23, 3
    s_mul_i32 s28, s28, 3
    s_lshl_b32 s26, s24, 1
    s_add_u32 s26, s26, s28
    s_cmp_ge_u32 s26, 7
    s_cselect_b32 s19, 7, 0
    s_sub_u32 s26, s26, s19
    s_and_b32 s25, s16, 3
    s_lshl_b32 s17, s25, 10
    s_lshl_b32 s34, s23, 4
    s_add_u32 s34, s34, s22
    s_lshl_b32 s35, s34, 18
    s_mov_b32 s7, 0x20000
    s_mov_b32 s11, 0x20000
    s_mov_b32 s15, 0x20000
    s_cmp_ge_u32 s16, 4
    s_cbranch_scc1 L_roleB
    v_lshrrev_b32 v46, 3, v0
    v_and_b32 v47, 7, v0
    v_bfe_u32 v14, v0, 4, 3
    v_xor_b32 v14, v14, v47
    v_lshlrev_b32 v14, 4, v14
    v_mul_u32_u24 v1, 896, v46
    v_add_u32 v1, v1, v14
    v_bfe_u32 v14, v0, 4, 1
    v_bfe_u32 v15, v0, 6, 1
    v_lshl_add_u32 v14, v15, 1, v14
    v_lshlrev_b32 v14, 1, v14
    v_xor_b32 v14, v14, v47
    v_lshlrev_b32 v14, 4, v14
    v_lshl_add_u32 v2, v46, 13, v14
    s_lshl_b32 s29, s26, 7
    s_lshl_b32 s30, s26, 19
    s_lshl_b32 s31, s27, 7
    s_mov_b32 s32, s31
    s_mov_b32 s6, 86016
    s_mov_b32 s10, 3662336
    s_mov_b32 s14, 262144
    s_mul_i32 s36, s23, 86016
    s_lshl_b32 s37, s22, 9
    s_cmp_eq_u32 s21, 0
    s_waitcnt lgkmcnt(0)
    s_cselect_b64 s[4:5], s[40:41], s[50:51]
    s_cselect_b64 s[8:9], s[46:47], s[56:57]
    s_cselect_b64 s[12:13], s[44:45], s[54:55]
    s_add_u32 s4, s4, s36
    s_addc_u32 s5, s5, 0
    s_add_u32 s8, s8, s37
    s_addc_u32 s9, s9, 0
    s_add_u32 s12, s12, s35
    s_addc_u32 s13, s13, 0
    s_add_u32 m0, s17, 0
    s_add_u32 s18, s29, 0
    buffer_load_dwordx4 v1, s[4:7], s18 offen lds
    s_add_u32 m0, s17, 4096
    s_add_u32 s18, s29, 28672
    buffer_load_dwordx4 v1, s[4:7], s18 offen lds
    s_add_u32 m0, s17, 8192
    s_add_u32 s18, s29, 57344
    buffer_load_dwordx4 v1, s[4:7], s18 offen lds
    s_add_u32 s29, s29, 128
    s_cmp_eq_u32 s29, 896
    s_cselect_b32 s29, 0, s29
    s_add_u32 m0, s17, 49152
    s_add_u32 s18, s30, s31
    buffer_load_dwordx4 v2, s[8:11], s18 offen lds
    s_add_u32 m0, s17, 53248
    s_add_u32 s18, s18, 262144
    buffer_load_dwordx4 v2, s[8:11], s18 offen lds
    s_add_u32 s30, s30, 524288
    s_cmp_eq_u32 s30, 3670016
    s_cselect_b32 s30, 0, s30
    s_add_u32 m0, s17, 12288
    s_add_u32 s18, s29, 0
    buffer_load_dwordx4 v1, s[4:7], s18 offen lds
    s_add_u32 m0, s17, 16384
    s_add_u32 s18, s29, 28672
    buffer_load_dwordx4 v1, s[4:7], s18 offen lds
    s_add_u32 m0, s17, 20480
    s_add_u32 s18, s29, 57344
    buffer_load_dwordx4 v1, s[4:7], s18 offen lds
    s_add_u32 s29, s29, 128
    s_cmp_eq_u32 s29, 896
    s_cselect_b32 s29, 0, s29
    s_add_u32 m0, s17, 57344
    s_add_u32 s18, s30, s31
    buffer_load_dwordx4 v2, s[8:11], s18 offen lds
    s_add_u32 m0, s17, 61440
    s_add_u32 s18, s18, 262144
    buffer_load_dwordx4 v2, s[8:11], s18 offen lds
    s_add_u32 s30, s30, 524288
    s_cmp_eq_u32 s30, 3670016
    s_cselect_b32 s30, 0, s30
    s_add_u32 m0, s17, 24576
    s_add_u32 s18, s29, 0
    buffer_load_dwordx4 v1, s[4:7], s18 offen lds
    s_add_u32 m0, s17, 28672
    s_add_u32 s18, s29, 28672
    buffer_load_dwordx4 v1, s[4:7], s18 offen lds
    s_add_u32 m0, s17, 32768
    s_add_u32 s18, s29, 57344
    buffer_load_dwordx4 v1, s[4:7], s18 offen lds
    s_add_u32 s29, s29, 128
    s_cmp_eq_u32 s29, 896
    s_cselect_b32 s29, 0, s29
    s_add_u32 m0, s17, 65536
    s_add_u32 s18, s30, s31
    buffer_load_dwordx4 v2, s[8:11], s18 offen lds
    s_add_u32 m0, s17, 69632
    s_add_u32 s18, s18, 262144
    buffer_load_dwordx4 v2, s[8:11], s18 offen lds
    s_add_u32 s30, s30, 524288
    s_cmp_eq_u32 s30, 3670016
    s_cselect_b32 s30, 0, s30
    v_and_b32 v14, 15, v0
    v_bfe_u32 v15, v0, 7, 1
    v_lshl_add_u32 v46, v15, 4, v14
    v_bfe_u32 v14, v0, 1, 3
    v_bfe_u32 v15, v0, 4, 2
    v_xor_b32 v15, v15, v14
    v_lshlrev_b32 v15, 4, v15
    v_lshl_add_u32 v43, v46, 7, v15
    v_xor_b32 v44, 64, v43
    v_bfe_u32 v15, v0, 5, 1
    v_bfe_u32 v47, v0, 6, 1
    v_lshl_add_u32 v15, v47, 2, v15
    v_xor_b32 v15, v15, v14
    v_lshlrev_b32 v15, 4, v15
    v_lshl_add_u32 v45, v46, 7, v15
    v_bfe_u32 v15, v0, 4, 1
    v_lshl_add_u32 v45, v15, 3, v45
    v_xor_b32 v13, 32, v45
    v_bfe_u32 v14, v0, 2, 2
    v_bfe_u32 v15, v0, 4, 2
    v_lshl_add_u32 v3, v15, 3, v14
    v_lshlrev_b32 v3, 7, v3
    v_bfe_u32 v14, v0, 3, 2
    v_lshlrev_b32 v15, 1, v47
    v_xor_b32 v14, v14, v15
    v_lshl_add_u32 v3, v14, 5, v3
    v_and_b32 v14, 3, v0
    v_lshl_add_u32 v3, v14, 3, v3
    v_xor_b32 v12, 32, v3
    s_waitcnt vmcnt(10)
    s_barrier
    ds_read_b128 v[64:67], v43 offset:0
    ds_read_b128 v[68:71], v43 offset:4096
    ds_read_b128 v[72:75], v43 offset:8192
    ds_read_b128 v[76:79], v44 offset:0
    ds_read_b128 v[80:83], v44 offset:4096
    ds_read_b128 v[84:87], v44 offset:8192
    v_add_u32 v14, 49152, v3
    ds_read_b64_tr_b16 v[4:5], v14 offset:0
    ds_read_b64_tr_b16 v[6:7], v14 offset:512
    v_add_u32 v15, 49152, v12
    ds_read_b64_tr_b16 v[8:9], v15 offset:0
    ds_read_b64_tr_b16 v[10:11], v15 offset:512
    s_add_u32 m0, s17, 36864
    s_add_u32 s18, s29, 0
    buffer_load_dwordx4 v1, s[4:7], s18 offen lds
    ds_read_b64_tr_b16 v[48:49], v14 offset:4096
    ds_read_b64_tr_b16 v[50:51], v14 offset:4608
    ds_read_b64_tr_b16 v[52:53], v15 offset:4096
    ds_read_b64_tr_b16 v[54:55], v15 offset:4608
    s_add_u32 m0, s17, 40960
    s_add_u32 s18, s29, 28672
    buffer_load_dwordx4 v1, s[4:7], s18 offen lds
    s_add_u32 m0, s17, 45056
    s_add_u32 s18, s29, 57344
    buffer_load_dwordx4 v1, s[4:7], s18 offen lds
    s_add_u32 s29, s29, 128
    s_cmp_eq_u32 s29, 896
    s_cselect_b32 s29, 0, s29
    s_add_u32 m0, s17, 73728
    s_add_u32 s18, s30, s31
    buffer_load_dwordx4 v2, s[8:11], s18 offen lds
    s_add_u32 m0, s17, 77824
    s_add_u32 s18, s18, 262144
    buffer_load_dwordx4 v2, s[8:11], s18 offen lds
    s_add_u32 s30, s30, 524288
    s_cmp_eq_u32 s30, 3670016
    s_cselect_b32 s30, 0, s30
    s_waitcnt vmcnt(10) lgkmcnt(0)
    s_barrier
    ds_read_b128 v[88:91], v43 offset:12288
    ds_read_b128 v[92:95], v43 offset:16384
    ds_read_b128 v[96:99], v43 offset:20480
    ds_read_b128 v[100:103], v44 offset:12288
    ds_read_b128 v[104:107], v44 offset:16384
    ds_read_b128 v[108:111], v44 offset:20480
    v_mfma_f32_16x16x32_bf16 v[16:19], v[4:7], v[64:67], 0
    v_add_u32 v14, 57344, v3
    v_mfma_f32_16x16x32_bf16 v[20:23], v[4:7], v[68:71], 0
    ds_read_b64_tr_b16 v[56:57], v14 offset:0
    v_mfma_f32_16x16x32_bf16 v[24:27], v[4:7], v[72:75], 0
    ds_read_b64_tr_b16 v[58:59], v14 offset:512
    v_mfma_f32_16x16x32_bf16 v[28:31], v[8:11], v[64:67], 0
    v_add_u32 v15, 57344, v12
    v_mfma_f32_16x16x32_bf16 v[32:35], v[8:11], v[68:71], 0
    ds_read_b64_tr_b16 v[60:61], v15 offset:0
    v_mfma_f32_16x16x32_bf16 v[36:39], v[8:11], v[72:75], 0
    ds_read_b64_tr_b16 v[62:63], v15 offset:512
    v_mfma_f32_16x16x32_bf16 v[16:19], v[48:51], v[76:79], v[16:19]
    ds_read_b64_tr_b16 v[4:5], v14 offset:4096
    v_mfma_f32_16x16x32_bf16 v[20:23], v[48:51], v[80:83], v[20:23]
    ds_read_b64_tr_b16 v[6:7], v14 offset:4608
    v_mfma_f32_16x16x32_bf16 v[24:27], v[48:51], v[84:87], v[24:27]
    ds_read_b64_tr_b16 v[8:9], v15 offset:4096
    v_mfma_f32_16x16x32_bf16 v[28:31], v[52:55], v[76:79], v[28:31]
    ds_read_b64_tr_b16 v[10:11], v15 offset:4608
    v_mfma_f32_16x16x32_bf16 v[32:35], v[52:55], v[80:83], v[32:35]
    s_add_u32 m0, s17, 0
    s_add_u32 s18, s29, 0
    buffer_load_dwordx4 v1, s[4:7], s18 offen lds
    v_mfma_f32_16x16x32_bf16 v[36:39], v[52:55], v[84:87], v[36:39]
    s_add_u32 m0, s17, 4096
    s_add_u32 s18, s29, 28672
    buffer_load_dwordx4 v1, s[4:7], s18 offen lds
    s_add_u32 m0, s17, 8192
    s_add_u32 s18, s29, 57344
    buffer_load_dwordx4 v1, s[4:7], s18 offen lds
    s_add_u32 s29, s29, 128
    s_cmp_eq_u32 s29, 896
    s_cselect_b32 s29, 0, s29
    s_add_u32 m0, s17, 49152
    s_add_u32 s18, s30, s31
    buffer_load_dwordx4 v2, s[8:11], s18 offen lds
    s_add_u32 m0, s17, 53248
    s_add_u32 s18, s18, 262144
    buffer_load_dwordx4 v2, s[8:11], s18 offen lds
    s_add_u32 s30, s30, 524288
    s_cmp_eq_u32 s30, 3670016
    s_cselect_b32 s30, 0, s30
    s_waitcnt vmcnt(10) lgkmcnt(0)
    s_barrier
    ds_read_b128 v[112:115], v43 offset:24576
    ds_read_b128 v[116:119], v43 offset:28672
    ds_read_b128 v[120:123], v43 offset:32768
    ds_read_b128 v[124:127], v44 offset:24576
    ds_read_b128 v[128:131], v44 offset:28672
    ds_read_b128 v[132:135], v44 offset:32768
    v_mfma_f32_16x16x32_bf16 v[16:19], v[56:59], v[88:91], v[16:19]
    v_add_u32 v14, 65536, v3
    v_mfma_f32_16x16x32_bf16 v[20:23], v[56:59], v[92:95], v[20:23]
    ds_read_b64_tr_b16 v[48:49], v14 offset:0
    v_mfma_f32_16x16x32_bf16 v[24:27], v[56:59], v[96:99], v[24:27]
    ds_read_b64_tr_b16 v[50:51], v14 offset:512
    v_mfma_f32_16x16x32_bf16 v[28:31], v[60:63], v[88:91], v[28:31]
    v_add_u32 v15, 65536, v12
    v_mfma_f32_16x16x32_bf16 v[32:35], v[60:63], v[92:95], v[32:35]
    ds_read_b64_tr_b16 v[52:53], v15 offset:0
    v_mfma_f32_16x16x32_bf16 v[36:39], v[60:63], v[96:99], v[36:39]
    ds_read_b64_tr_b16 v[54:55], v15 offset:512
    v_mfma_f32_16x16x32_bf16 v[16:19], v[4:7], v[100:103], v[16:19]
    ds_read_b64_tr_b16 v[56:57], v14 offset:4096
    v_mfma_f32_16x16x32_bf16 v[20:23], v[4:7], v[104:107], v[20:23]
    ds_read_b64_tr_b16 v[58:59], v14 offset:4608
    v_mfma_f32_16x16x32_bf16 v[24:27], v[4:7], v[108:111], v[24:27]
    ds_read_b64_tr_b16 v[60:61], v15 offset:4096
    v_mfma_f32_16x16x32_bf16 v[28:31], v[8:11], v[100:103], v[28:31]
    ds_read_b64_tr_b16 v[62:63], v15 offset:4608
    v_mfma_f32_16x16x32_bf16 v[32:35], v[8:11], v[104:107], v[32:35]
    s_add_u32 m0, s17, 12288
    s_add_u32 s18, s29, 0
    buffer_load_dwordx4 v1, s[4:7], s18 offen lds
    v_mfma_f32_16x16x32_bf16 v[36:39], v[8:11], v[108:111], v[36:39]
    s_add_u32 m0, s17, 16384
    s_add_u32 s18, s29, 28672
    buffer_load_dwordx4 v1, s[4:7], s18 offen lds
    s_add_u32 m0, s17, 20480
    s_add_u32 s18, s29, 57344
    buffer_load_dwordx4 v1, s[4:7], s18 offen lds
    s_add_u32 s29, s29, 128
    s_cmp_eq_u32 s29, 896
    s_cselect_b32 s29, 0, s29
    s_add_u32 m0, s17, 57344
    s_add_u32 s18, s30, s31
    buffer_load_dwordx4 v2, s[8:11], s18 offen lds
    s_add_u32 m0, s17, 61440
    s_add_u32 s18, s18, 262144
    buffer_load_dwordx4 v2, s[8:11], s18 offen lds
    s_add_u32 s30, s30, 524288
    s_cmp_eq_u32 s30, 3670016
    s_cselect_b32 s30, 0, s30
    s_waitcnt vmcnt(10) lgkmcnt(0)
    s_barrier
    ds_read_b128 v[136:139], v43 offset:36864
    ds_read_b128 v[140:143], v43 offset:40960
    ds_read_b128 v[144:147], v43 offset:45056
    ds_read_b128 v[148:151], v44 offset:36864
    ds_read_b128 v[152:155], v44 offset:40960
    ds_read_b128 v[156:159], v44 offset:45056
    v_mfma_f32_16x16x32_bf16 v[16:19], v[48:51], v[112:115], v[16:19]
    v_add_u32 v14, 73728, v3
    v_mfma_f32_16x16x32_bf16 v[20:23], v[48:51], v[116:119], v[20:23]
    ds_read_b64_tr_b16 v[4:5], v14 offset:0
    v_mfma_f32_16x16x32_bf16 v[24:27], v[48:51], v[120:123], v[24:27]
    ds_read_b64_tr_b16 v[6:7], v14 offset:512
    v_mfma_f32_16x16x32_bf16 v[28:31], v[52:55], v[112:115], v[28:31]
    v_add_u32 v15, 73728, v12
    v_mfma_f32_16x16x32_bf16 v[32:35], v[52:55], v[116:119], v[32:35]
    ds_read_b64_tr_b16 v[8:9], v15 offset:0
    v_mfma_f32_16x16x32_bf16 v[36:39], v[52:55], v[120:123], v[36:39]
    ds_read_b64_tr_b16 v[10:11], v15 offset:512
    v_mfma_f32_16x16x32_bf16 v[16:19], v[56:59], v[124:127], v[16:19]
    ds_read_b64_tr_b16 v[48:49], v14 offset:4096
    v_mfma_f32_16x16x32_bf16 v[20:23], v[56:59], v[128:131], v[20:23]
    ds_read_b64_tr_b16 v[50:51], v14 offset:4608
    v_mfma_f32_16x16x32_bf16 v[24:27], v[56:59], v[132:135], v[24:27]
    ds_read_b64_tr_b16 v[52:53], v15 offset:4096
    v_mfma_f32_16x16x32_bf16 v[28:31], v[60:63], v[124:127], v[28:31]
    ds_read_b64_tr_b16 v[54:55], v15 offset:4608
    v_mfma_f32_16x16x32_bf16 v[32:35], v[60:63], v[128:131], v[32:35]
    s_add_u32 m0, s17, 24576
    s_add_u32 s18, s29, 0
    buffer_load_dwordx4 v1, s[4:7], s18 offen lds
    v_mfma_f32_16x16x32_bf16 v[36:39], v[60:63], v[132:135], v[36:39]
    s_add_u32 m0, s17, 28672
    s_add_u32 s18, s29, 28672
    buffer_load_dwordx4 v1, s[4:7], s18 offen lds
    s_add_u32 m0, s17, 32768
    s_add_u32 s18, s29, 57344
    buffer_load_dwordx4 v1, s[4:7], s18 offen lds
    s_add_u32 s29, s29, 128
    s_cmp_eq_u32 s29, 896
    s_cselect_b32 s29, 0, s29
    s_add_u32 m0, s17, 65536
    s_add_u32 s18, s30, s31
    buffer_load_dwordx4 v2, s[8:11], s18 offen lds
    s_add_u32 m0, s17, 69632
    s_add_u32 s18, s18, 262144
    buffer_load_dwordx4 v2, s[8:11], s18 offen lds
    s_add_u32 s30, s30, 524288
    s_cmp_eq_u32 s30, 3670016
    s_cselect_b32 s30, 0, s30
    s_add_u32 s31, s31, 128
    s_and_b32 s31, s31, 511
    s_waitcnt vmcnt(10) lgkmcnt(0)
    s_barrier
    ds_read_b128 v[160:163], v43 offset:0
    ds_read_b128 v[164:167], v43 offset:4096
    ds_read_b128 v[168:171], v43 offset:8192
    ds_read_b128 v[172:175], v44 offset:0
    ds_read_b128 v[176:179], v44 offset:4096
    ds_read_b128 v[180:183], v44 offset:8192
    v_mfma_f32_16x16x32_bf16 v[16:19], v[4:7], v[136:139], v[16:19]
    v_add_u32 v14, 49152, v3
    v_mfma_f32_16x16x32_bf16 v[20:23], v[4:7], v[140:143], v[20:23]
    ds_read_b64_tr_b16 v[56:57], v14 offset:0
    v_mfma_f32_16x16x32_bf16 v[24:27], v[4:7], v[144:147], v[24:27]
    ds_read_b64_tr_b16 v[58:59], v14 offset:512
    v_mfma_f32_16x16x32_bf16 v[28:31], v[8:11], v[136:139], v[28:31]
    v_add_u32 v15, 49152, v12
    v_mfma_f32_16x16x32_bf16 v[32:35], v[8:11], v[140:143], v[32:35]
    ds_read_b64_tr_b16 v[60:61], v15 offset:0
    v_mfma_f32_16x16x32_bf16 v[36:39], v[8:11], v[144:147], v[36:39]
    ds_read_b64_tr_b16 v[62:63], v15 offset:512
    v_mfma_f32_16x16x32_bf16 v[16:19], v[48:51], v[148:151], v[16:19]
    ds_read_b64_tr_b16 v[4:5], v14 offset:4096
    v_mfma_f32_16x16x32_bf16 v[20:23], v[48:51], v[152:155], v[20:23]
    ds_read_b64_tr_b16 v[6:7], v14 offset:4608
    v_mfma_f32_16x16x32_bf16 v[24:27], v[48:51], v[156:159], v[24:27]
    ds_read_b64_tr_b16 v[8:9], v15 offset:4096
    v_mfma_f32_16x16x32_bf16 v[28:31], v[52:55], v[148:151], v[28:31]
    ds_read_b64_tr_b16 v[10:11], v15 offset:4608
    v_mfma_f32_16x16x32_bf16 v[32:35], v[52:55], v[152:155], v[32:35]
    s_add_u32 m0, s17, 73728
    s_add_u32 s18, s30, s31
    buffer_load_dwordx4 v2, s[8:11], s18 offen lds
    v_mfma_f32_16x16x32_bf16 v[36:39], v[52:55], v[156:159], v[36:39]
    s_add_u32 m0, s17, 77824
    s_add_u32 s18, s18, 262144
    buffer_load_dwordx4 v2, s[8:11], s18 offen lds
    s_add_u32 s30, s30, 524288
    s_cmp_eq_u32 s30, 3670016
    s_cselect_b32 s30, 0, s30
    s_add_u32 m0, s17, 81920
    s_add_u32 s18, s30, s31
    buffer_load_dwordx4 v2, s[8:11], s18 offen lds
    s_add_u32 m0, s17, 86016
    s_add_u32 s18, s18, 262144
    buffer_load_dwordx4 v2, s[8:11], s18 offen lds
    s_add_u32 s30, s30, 524288
    s_cmp_eq_u32 s30, 3670016
    s_cselect_b32 s30, 0, s30
    s_add_u32 m0, s17, 155648
    s_add_u32 s18, s30, s31
    buffer_load_dwordx4 v2, s[8:11], s18 offen lds
    s_add_u32 m0, s17, 159744
    s_add_u32 s18, s18, 262144
    buffer_load_dwordx4 v2, s[8:11], s18 offen lds
    s_add_u32 s30, s30, 524288
    s_cmp_eq_u32 s30, 3670016
    s_cselect_b32 s30, 0, s30
    s_waitcnt vmcnt(11) lgkmcnt(0)
    s_barrier
    ds_read_b128 v[184:187], v43 offset:12288
    ds_read_b128 v[188:191], v43 offset:16384
    ds_read_b128 v[192:195], v43 offset:20480
    ds_read_b128 v[196:199], v44 offset:12288
    ds_read_b128 v[200:203], v44 offset:16384
    ds_read_b128 v[204:207], v44 offset:20480
    v_mfma_f32_16x16x32_bf16 v[16:19], v[56:59], v[160:163], v[16:19]
    v_add_u32 v14, 57344, v3
    v_mfma_f32_16x16x32_bf16 v[20:23], v[56:59], v[164:167], v[20:23]
    ds_read_b64_tr_b16 v[48:49], v14 offset:0
    v_mfma_f32_16x16x32_bf16 v[24:27], v[56:59], v[168:171], v[24:27]
    ds_read_b64_tr_b16 v[50:51], v14 offset:512
    v_mfma_f32_16x16x32_bf16 v[28:31], v[60:63], v[160:163], v[28:31]
    v_add_u32 v15, 57344, v12
    v_mfma_f32_16x16x32_bf16 v[32:35], v[60:63], v[164:167], v[32:35]
    ds_read_b64_tr_b16 v[52:53], v15 offset:0
    v_mfma_f32_16x16x32_bf16 v[36:39], v[60:63], v[168:171], v[36:39]
    ds_read_b64_tr_b16 v[54:55], v15 offset:512
    v_mfma_f32_16x16x32_bf16 v[16:19], v[4:7], v[172:175], v[16:19]
    ds_read_b64_tr_b16 v[56:57], v14 offset:4096
    v_mfma_f32_16x16x32_bf16 v[20:23], v[4:7], v[176:179], v[20:23]
    ds_read_b64_tr_b16 v[58:59], v14 offset:4608
    v_mfma_f32_16x16x32_bf16 v[24:27], v[4:7], v[180:183], v[24:27]
    ds_read_b64_tr_b16 v[60:61], v15 offset:4096
    v_mfma_f32_16x16x32_bf16 v[28:31], v[8:11], v[172:175], v[28:31]
    ds_read_b64_tr_b16 v[62:63], v15 offset:4608
    v_mfma_f32_16x16x32_bf16 v[32:35], v[8:11], v[176:179], v[32:35]
    s_add_u32 m0, s17, 49152
    s_add_u32 s18, s30, s31
    buffer_load_dwordx4 v2, s[8:11], s18 offen lds
    v_mfma_f32_16x16x32_bf16 v[36:39], v[8:11], v[180:183], v[36:39]
    s_add_u32 m0, s17, 53248
    s_add_u32 s18, s18, 262144
    buffer_load_dwordx4 v2, s[8:11], s18 offen lds
    s_add_u32 s30, s30, 524288
    s_cmp_eq_u32 s30, 3670016
    s_cselect_b32 s30, 0, s30
    s_waitcnt vmcnt(8) lgkmcnt(0)
    s_barrier
    ds_read_b128 v[208:211], v43 offset:24576
    ds_read_b128 v[212:215], v43 offset:28672
    ds_read_b128 v[216:219], v43 offset:32768
    ds_read_b128 v[220:223], v44 offset:24576
    ds_read_b128 v[224:227], v44 offset:28672
    ds_read_b128 v[228:231], v44 offset:32768
    v_mfma_f32_16x16x32_bf16 v[16:19], v[48:51], v[184:187], v[16:19]
    v_add_u32 v14, 65536, v3
    v_mfma_f32_16x16x32_bf16 v[20:23], v[48:51], v[188:191], v[20:23]
    ds_read_b64_tr_b16 v[4:5], v14 offset:0
    v_mfma_f32_16x16x32_bf16 v[24:27], v[48:51], v[192:195], v[24:27]
    ds_read_b64_tr_b16 v[6:7], v14 offset:512
    v_mfma_f32_16x16x32_bf16 v[28:31], v[52:55], v[184:187], v[28:31]
    v_add_u32 v15, 65536, v12
    v_mfma_f32_16x16x32_bf16 v[32:35], v[52:55], v[188:191], v[32:35]
    ds_read_b64_tr_b16 v[8:9], v15 offset:0
    v_mfma_f32_16x16x32_bf16 v[36:39], v[52:55], v[192:195], v[36:39]
    ds_read_b64_tr_b16 v[10:11], v15 offset:512
    v_mfma_f32_16x16x32_bf16 v[16:19], v[56:59], v[196:199], v[16:19]
    ds_read_b64_tr_b16 v[48:49], v14 offset:4096
    v_mfma_f32_16x16x32_bf16 v[20:23], v[56:59], v[200:203], v[20:23]
    ds_read_b64_tr_b16 v[50:51], v14 offset:4608
    v_mfma_f32_16x16x32_bf16 v[24:27], v[56:59], v[204:207], v[24:27]
    ds_read_b64_tr_b16 v[52:53], v15 offset:4096
    v_mfma_f32_16x16x32_bf16 v[28:31], v[60:63], v[196:199], v[28:31]
    ds_read_b64_tr_b16 v[54:55], v15 offset:4608
    v_mfma_f32_16x16x32_bf16 v[32:35], v[60:63], v[200:203], v[32:35]
    s_add_u32 m0, s17, 57344
    s_add_u32 s18, s30, s31
    buffer_load_dwordx4 v2, s[8:11], s18 offen lds
    v_mfma_f32_16x16x32_bf16 v[36:39], v[60:63], v[204:207], v[36:39]
    s_waitcnt lgkmcnt(6)
    v_mfma_f32_16x16x32_bf16 v[16:19], v[4:7], v[208:211], v[16:19]
    s_add_u32 m0, s17, 61440
    s_add_u32 s18, s18, 262144
    buffer_load_dwordx4 v2, s[8:11], s18 offen lds
    s_add_u32 s30, s30, 524288
    s_cmp_eq_u32 s30, 3670016
    s_cselect_b32 s30, 0, s30
    v_mfma_f32_16x16x32_bf16 v[20:23], v[4:7], v[212:215], v[20:23]
    v_mfma_f32_16x16x32_bf16 v[24:27], v[4:7], v[216:219], v[24:27]
    s_waitcnt lgkmcnt(4)
    v_mfma_f32_16x16x32_bf16 v[28:31], v[8:11], v[208:211], v[28:31]
    v_mfma_f32_16x16x32_bf16 v[32:35], v[8:11], v[212:215], v[32:35]
    v_mfma_f32_16x16x32_bf16 v[36:39], v[8:11], v[216:219], v[36:39]
    s_waitcnt lgkmcnt(2)
    v_mfma_f32_16x16x32_bf16 v[16:19], v[48:51], v[220:223], v[16:19]
    v_mfma_f32_16x16x32_bf16 v[20:23], v[48:51], v[224:227], v[20:23]
    v_mfma_f32_16x16x32_bf16 v[24:27], v[48:51], v[228:231], v[24:27]
    s_waitcnt lgkmcnt(0)
    v_mfma_f32_16x16x32_bf16 v[28:31], v[52:55], v[220:223], v[28:31]
    v_mfma_f32_16x16x32_bf16 v[32:35], v[52:55], v[224:227], v[32:35]
    v_mfma_f32_16x16x32_bf16 v[36:39], v[52:55], v[228:231], v[36:39]
    s_nop 1
    v_cvt_pk_bf16_f32 v48, v16, v17
    v_cvt_pk_bf16_f32 v49, v18, v19
    ds_write_b64 v45, v[48:49] offset:0
    s_nop 0
    v_cvt_pk_bf16_f32 v50, v28, v29
    v_cvt_pk_bf16_f32 v51, v30, v31
    ds_write_b64 v13, v[50:51] offset:0
    v_cvt_pk_bf16_f32 v52, v20, v21
    v_cvt_pk_bf16_f32 v53, v22, v23
    ds_write_b64 v45, v[52:53] offset:4096
    v_cvt_pk_bf16_f32 v54, v32, v33
    v_cvt_pk_bf16_f32 v55, v34, v35
    ds_write_b64 v13, v[54:55] offset:4096
    v_cvt_pk_bf16_f32 v48, v24, v25
    v_cvt_pk_bf16_f32 v49, v26, v27
    ds_write_b64 v45, v[48:49] offset:8192
    v_cvt_pk_bf16_f32 v50, v36, v37
    v_cvt_pk_bf16_f32 v51, v38, v39
    ds_write_b64 v13, v[50:51] offset:8192
    s_waitcnt vmcnt(6) lgkmcnt(0)
    s_barrier
    v_add_u32 v14, 73728, v3
    ds_read_b64_tr_b16 v[4:5], v14 offset:0
    ds_read_b64_tr_b16 v[6:7], v14 offset:512
    v_add_u32 v15, 73728, v12
    ds_read_b64_tr_b16 v[8:9], v15 offset:0
    ds_read_b64_tr_b16 v[10:11], v15 offset:512
    s_add_u32 m0, s17, 24576
    s_add_u32 s18, s30, s31
    buffer_load_dwordx4 v2, s[8:11], s18 offen lds
    ds_read_b64_tr_b16 v[48:49], v14 offset:4096
    ds_read_b64_tr_b16 v[50:51], v14 offset:4608
    ds_read_b64_tr_b16 v[52:53], v15 offset:4096
    ds_read_b64_tr_b16 v[54:55], v15 offset:4608
    s_add_u32 m0, s17, 28672
    s_add_u32 s18, s18, 262144
    buffer_load_dwordx4 v2, s[8:11], s18 offen lds
    s_add_u32 s30, s30, 524288
    s_cmp_eq_u32 s30, 3670016
    s_cselect_b32 s30, 0, s30
    s_waitcnt lgkmcnt(6)
    v_mfma_f32_16x16x32_bf16 v[16:19], v[4:7], v[64:67], 0
    v_add_u32 v14, 81920, v3
    v_mfma_f32_16x16x32_bf16 v[20:23], v[4:7], v[68:71], 0
    ds_read_b64_tr_b16 v[56:57], v14 offset:0
    v_mfma_f32_16x16x32_bf16 v[24:27], v[4:7], v[72:75], 0
    ds_read_b64_tr_b16 v[58:59], v14 offset:512
    s_waitcnt lgkmcnt(6)
    v_mfma_f32_16x16x32_bf16 v[28:31], v[8:11], v[64:67], 0
    v_add_u32 v15, 81920, v12
    v_mfma_f32_16x16x32_bf16 v[32:35], v[8:11], v[68:71], 0
    ds_read_b64_tr_b16 v[60:61], v15 offset:0
    v_mfma_f32_16x16x32_bf16 v[36:39], v[8:11], v[72:75], 0
    ds_read_b64_tr_b16 v[62:63], v15 offset:512
    s_waitcnt lgkmcnt(6)
    v_mfma_f32_16x16x32_bf16 v[16:19], v[48:51], v[76:79], v[16:19]
    ds_read_b64_tr_b16 v[4:5], v14 offset:4096
    v_mfma_f32_16x16x32_bf16 v[20:23], v[48:51], v[80:83], v[20:23]
    ds_read_b64_tr_b16 v[6:7], v14 offset:4608
    v_mfma_f32_16x16x32_bf16 v[24:27], v[48:51], v[84:87], v[24:27]
    ds_read_b64_tr_b16 v[8:9], v15 offset:4096
    s_waitcnt lgkmcnt(7)
    v_mfma_f32_16x16x32_bf16 v[28:31], v[52:55], v[76:79], v[28:31]
    ds_read_b64_tr_b16 v[10:11], v15 offset:4608
    v_mfma_f32_16x16x32_bf16 v[32:35], v[52:55], v[80:83], v[32:35]
    s_add_u32 m0, s17, 32768
    s_add_u32 s18, s30, s31
    buffer_load_dwordx4 v2, s[8:11], s18 offen lds
    v_mfma_f32_16x16x32_bf16 v[36:39], v[52:55], v[84:87], v[36:39]
    s_add_u32 m0, s17, 36864
    s_add_u32 s18, s18, 262144
    buffer_load_dwordx4 v2, s[8:11], s18 offen lds
    s_add_u32 s30, s30, 524288
    s_cmp_eq_u32 s30, 3670016
    s_cselect_b32 s30, 0, s30
    s_add_u32 s31, s31, 128
    s_and_b32 s31, s31, 511
    s_add_u32 m0, s17, 40960
    s_add_u32 s18, s30, s31
    buffer_load_dwordx4 v2, s[8:11], s18 offen lds
    s_add_u32 m0, s17, 45056
    s_add_u32 s18, s18, 262144
    buffer_load_dwordx4 v2, s[8:11], s18 offen lds
    s_add_u32 s30, s30, 524288
    s_cmp_eq_u32 s30, 3670016
    s_cselect_b32 s30, 0, s30
    s_add_u32 m0, s17, 65536
    s_add_u32 s18, s30, s31
    buffer_load_dwordx4 v2, s[8:11], s18 offen lds
    s_add_u32 m0, s17, 69632
    s_add_u32 s18, s18, 262144
    buffer_load_dwordx4 v2, s[8:11], s18 offen lds
    s_add_u32 s30, s30, 524288
    s_cmp_eq_u32 s30, 3670016
    s_cselect_b32 s30, 0, s30
    s_waitcnt vmcnt(10) lgkmcnt(0)
    s_barrier
    v_mfma_f32_16x16x32_bf16 v[16:19], v[56:59], v[88:91], v[16:19]
    v_add_u32 v14, 155648, v3
    v_mfma_f32_16x16x32_bf16 v[20:23], v[56:59], v[92:95], v[20:23]
    ds_read_b64_tr_b16 v[48:49], v14 offset:0
    v_mfma_f32_16x16x32_bf16 v[24:27], v[56:59], v[96:99], v[24:27]
    ds_read_b64_tr_b16 v[50:51], v14 offset:512
    v_mfma_f32_16x16x32_bf16 v[28:31], v[60:63], v[88:91], v[28:31]
    v_add_u32 v15, 155648, v12
    v_mfma_f32_16x16x32_bf16 v[32:35], v[60:63], v[92:95], v[32:35]
    ds_read_b64_tr_b16 v[52:53], v15 offset:0
    v_mfma_f32_16x16x32_bf16 v[36:39], v[60:63], v[96:99], v[36:39]
    ds_read_b64_tr_b16 v[54:55], v15 offset:512
    v_mfma_f32_16x16x32_bf16 v[16:19], v[4:7], v[100:103], v[16:19]
    ds_read_b64_tr_b16 v[56:57], v14 offset:4096
    v_mfma_f32_16x16x32_bf16 v[20:23], v[4:7], v[104:107], v[20:23]
    ds_read_b64_tr_b16 v[58:59], v14 offset:4608
    v_mfma_f32_16x16x32_bf16 v[24:27], v[4:7], v[108:111], v[24:27]
    ds_read_b64_tr_b16 v[60:61], v15 offset:4096
    v_mfma_f32_16x16x32_bf16 v[28:31], v[8:11], v[100:103], v[28:31]
    ds_read_b64_tr_b16 v[62:63], v15 offset:4608
    v_mfma_f32_16x16x32_bf16 v[32:35], v[8:11], v[104:107], v[32:35]
    s_add_u32 m0, s17, 73728
    s_add_u32 s18, s30, s31
    buffer_load_dwordx4 v2, s[8:11], s18 offen lds
    v_mfma_f32_16x16x32_bf16 v[36:39], v[8:11], v[108:111], v[36:39]
    s_waitcnt lgkmcnt(6)
    v_mfma_f32_16x16x32_bf16 v[16:19], v[48:51], v[112:115], v[16:19]
    v_add_u32 v14, 49152, v3
    v_mfma_f32_16x16x32_bf16 v[20:23], v[48:51], v[116:119], v[20:23]
    ds_read_b64_tr_b16 v[4:5], v14 offset:0
    v_mfma_f32_16x16x32_bf16 v[24:27], v[48:51], v[120:123], v[24:27]
    ds_read_b64_tr_b16 v[6:7], v14 offset:512
    s_waitcnt lgkmcnt(6)
    v_mfma_f32_16x16x32_bf16 v[28:31], v[52:55], v[112:115], v[28:31]
    v_add_u32 v15, 49152, v12
    v_mfma_f32_16x16x32_bf16 v[32:35], v[52:55], v[116:119], v[32:35]
    ds_read_b64_tr_b16 v[8:9], v15 offset:0
    v_mfma_f32_16x16x32_bf16 v[36:39], v[52:55], v[120:123], v[36:39]
    ds_read_b64_tr_b16 v[10:11], v15 offset:512
    s_waitcnt lgkmcnt(6)
    v_mfma_f32_16x16x32_bf16 v[16:19], v[56:59], v[124:127], v[16:19]
    ds_read_b64_tr_b16 v[48:49], v14 offset:4096
    v_mfma_f32_16x16x32_bf16 v[20:23], v[56:59], v[128:131], v[20:23]
    ds_read_b64_tr_b16 v[50:51], v14 offset:4608
    v_mfma_f32_16x16x32_bf16 v[24:27], v[56:59], v[132:135], v[24:27]
    ds_read_b64_tr_b16 v[52:53], v15 offset:4096
    s_waitcnt lgkmcnt(7)
    v_mfma_f32_16x16x32_bf16 v[28:31], v[60:63], v[124:127], v[28:31]
    ds_read_b64_tr_b16 v[54:55], v15 offset:4608
    v_mfma_f32_16x16x32_bf16 v[32:35], v[60:63], v[128:131], v[32:35]
    s_add_u32 m0, s17, 77824
    s_add_u32 s18, s18, 262144
    buffer_load_dwordx4 v2, s[8:11], s18 offen lds
    s_add_u32 s30, s30, 524288
    s_cmp_eq_u32 s30, 3670016
    s_cselect_b32 s30, 0, s30
    v_mfma_f32_16x16x32_bf16 v[36:39], v[60:63], v[132:135], v[36:39]
    s_add_u32 m0, s17, 81920
    s_add_u32 s18, s30, s31
    buffer_load_dwordx4 v2, s[8:11], s18 offen lds
    s_add_u32 m0, s17, 86016
    s_add_u32 s18, s18, 262144
    buffer_load_dwordx4 v2, s[8:11], s18 offen lds
    s_add_u32 s30, s30, 524288
    s_cmp_eq_u32 s30, 3670016
    s_cselect_b32 s30, 0, s30
    s_waitcnt vmcnt(10) lgkmcnt(0)
    s_barrier
    v_mfma_f32_16x16x32_bf16 v[16:19], v[4:7], v[136:139], v[16:19]
    v_add_u32 v14, 57344, v3
    v_mfma_f32_16x16x32_bf16 v[20:23], v[4:7], v[140:143], v[20:23]
    ds_read_b64_tr_b16 v[56:57], v14 offset:0
    v_mfma_f32_16x16x32_bf16 v[24:27], v[4:7], v[144:147], v[24:27]
    ds_read_b64_tr_b16 v[58:59], v14 offset:512
    v_mfma_f32_16x16x32_bf16 v[28:31], v[8:11], v[136:139], v[28:31]
    v_add_u32 v15, 57344, v12
    v_mfma_f32_16x16x32_bf16 v[32:35], v[8:11], v[140:143], v[32:35]
    ds_read_b64_tr_b16 v[60:61], v15 offset:0
    v_mfma_f32_16x16x32_bf16 v[36:39], v[8:11], v[144:147], v[36:39]
    ds_read_b64_tr_b16 v[62:63], v15 offset:512
    v_mfma_f32_16x16x32_bf16 v[16:19], v[48:51], v[148:151], v[16:19]
    ds_read_b64_tr_b16 v[4:5], v14 offset:4096
    v_mfma_f32_16x16x32_bf16 v[20:23], v[48:51], v[152:155], v[20:23]
    ds_read_b64_tr_b16 v[6:7], v14 offset:4608
    v_mfma_f32_16x16x32_bf16 v[24:27], v[48:51], v[156:159], v[24:27]
    ds_read_b64_tr_b16 v[8:9], v15 offset:4096
    v_mfma_f32_16x16x32_bf16 v[28:31], v[52:55], v[148:151], v[28:31]
    ds_read_b64_tr_b16 v[10:11], v15 offset:4608
    v_mfma_f32_16x16x32_bf16 v[32:35], v[52:55], v[152:155], v[32:35]
    s_add_u32 m0, s17, 49152
    s_add_u32 s18, s30, s31
    buffer_load_dwordx4 v2, s[8:11], s18 offen lds
    v_mfma_f32_16x16x32_bf16 v[36:39], v[52:55], v[156:159], v[36:39]
    s_waitcnt lgkmcnt(6)
    v_mfma_f32_16x16x32_bf16 v[16:19], v[56:59], v[160:163], v[16:19]
    v_add_u32 v14, 24576, v3
    v_mfma_f32_16x16x32_bf16 v[20:23], v[56:59], v[164:167], v[20:23]
    ds_read_b64_tr_b16 v[48:49], v14 offset:0
    v_mfma_f32_16x16x32_bf16 v[24:27], v[56:59], v[168:171], v[24:27]
    ds_read_b64_tr_b16 v[50:51], v14 offset:512
    s_waitcnt lgkmcnt(6)
    v_mfma_f32_16x16x32_bf16 v[28:31], v[60:63], v[160:163], v[28:31]
    v_add_u32 v15, 24576, v12
    v_mfma_f32_16x16x32_bf16 v[32:35], v[60:63], v[164:167], v[32:35]
    ds_read_b64_tr_b16 v[52:53], v15 offset:0
    v_mfma_f32_16x16x32_bf16 v[36:39], v[60:63], v[168:171], v[36:39]
    ds_read_b64_tr_b16 v[54:55], v15 offset:512
    s_waitcnt lgkmcnt(6)
    v_mfma_f32_16x16x32_bf16 v[16:19], v[4:7], v[172:175], v[16:19]
    ds_read_b64_tr_b16 v[56:57], v14 offset:4096
    v_mfma_f32_16x16x32_bf16 v[20:23], v[4:7], v[176:179], v[20:23]
    ds_read_b64_tr_b16 v[58:59], v14 offset:4608
    v_mfma_f32_16x16x32_bf16 v[24:27], v[4:7], v[180:183], v[24:27]
    ds_read_b64_tr_b16 v[60:61], v15 offset:4096
    s_waitcnt lgkmcnt(7)
    v_mfma_f32_16x16x32_bf16 v[28:31], v[8:11], v[172:175], v[28:31]
    ds_read_b64_tr_b16 v[62:63], v15 offset:4608
    v_mfma_f32_16x16x32_bf16 v[32:35], v[8:11], v[176:179], v[32:35]
    s_add_u32 m0, s17, 53248
    s_add_u32 s18, s18, 262144
    buffer_load_dwordx4 v2, s[8:11], s18 offen lds
    s_add_u32 s30, s30, 524288
    s_cmp_eq_u32 s30, 3670016
    s_cselect_b32 s30, 0, s30
    v_mfma_f32_16x16x32_bf16 v[36:39], v[8:11], v[180:183], v[36:39]
    s_add_u32 m0, s17, 155648
    s_add_u32 s18, s30, s31
    buffer_load_dwordx4 v2, s[8:11], s18 offen lds
    s_add_u32 m0, s17, 159744
    s_add_u32 s18, s18, 262144
    buffer_load_dwordx4 v2, s[8:11], s18 offen lds
    s_add_u32 s30, s30, 524288
    s_cmp_eq_u32 s30, 3670016
    s_cselect_b32 s30, 0, s30
    s_waitcnt vmcnt(10) lgkmcnt(0)
    s_barrier
    v_mfma_f32_16x16x32_bf16 v[16:19], v[48:51], v[184:187], v[16:19]
    v_add_u32 v14, 32768, v3
    v_mfma_f32_16x16x32_bf16 v[20:23], v[48:51], v[188:191], v[20:23]
    ds_read_b64_tr_b16 v[4:5], v14 offset:0
    v_mfma_f32_16x16x32_bf16 v[24:27], v[48:51], v[192:195], v[24:27]
    ds_read_b64_tr_b16 v[6:7], v14 offset:512
    v_mfma_f32_16x16x32_bf16 v[28:31], v[52:55], v[184:187], v[28:31]
    v_add_u32 v15, 32768, v12
    v_mfma_f32_16x16x32_bf16 v[32:35], v[52:55], v[188:191], v[32:35]
    ds_read_b64_tr_b16 v[8:9], v15 offset:0
    v_mfma_f32_16x16x32_bf16 v[36:39], v[52:55], v[192:195], v[36:39]
    ds_read_b64_tr_b16 v[10:11], v15 offset:512
    v_mfma_f32_16x16x32_bf16 v[16:19], v[56:59], v[196:199], v[16:19]
    ds_read_b64_tr_b16 v[48:49], v14 offset:4096
    v_mfma_f32_16x16x32_bf16 v[20:23], v[56:59], v[200:203], v[20:23]
    ds_read_b64_tr_b16 v[50:51], v14 offset:4608
    v_mfma_f32_16x16x32_bf16 v[24:27], v[56:59], v[204:207], v[24:27]
    ds_read_b64_tr_b16 v[52:53], v15 offset:4096
    v_mfma_f32_16x16x32_bf16 v[28:31], v[60:63], v[196:199], v[28:31]
    ds_read_b64_tr_b16 v[54:55], v15 offset:4608
    v_mfma_f32_16x16x32_bf16 v[32:35], v[60:63], v[200:203], v[32:35]
    s_add_u32 m0, s17, 24576
    s_add_u32 s18, s30, s31
    buffer_load_dwordx4 v2, s[8:11], s18 offen lds
    v_mfma_f32_16x16x32_bf16 v[36:39], v[60:63], v[204:207], v[36:39]
    s_waitcnt lgkmcnt(6)
    v_mfma_f32_16x16x32_bf16 v[16:19], v[4:7], v[208:211], v[16:19]
    v_add_u32 v14, 40960, v3
    v_mfma_f32_16x16x32_bf16 v[20:23], v[4:7], v[212:215], v[20:23]
    ds_read_b64_tr_b16 v[56:57], v14 offset:0
    v_mfma_f32_16x16x32_bf16 v[24:27], v[4:7], v[216:219], v[24:27]
    ds_read_b64_tr_b16 v[58:59], v14 offset:512
    s_waitcnt lgkmcnt(6)
    v_mfma_f32_16x16x32_bf16 v[28:31], v[8:11], v[208:211], v[28:31]
    v_add_u32 v15, 40960, v12
    v_mfma_f32_16x16x32_bf16 v[32:35], v[8:11], v[212:215], v[32:35]
    ds_read_b64_tr_b16 v[60:61], v15 offset:0
    v_mfma_f32_16x16x32_bf16 v[36:39], v[8:11], v[216:219], v[36:39]
    ds_read_b64_tr_b16 v[62:63], v15 offset:512
    s_waitcnt lgkmcnt(6)
    v_mfma_f32_16x16x32_bf16 v[16:19], v[48:51], v[220:223], v[16:19]
    ds_read_b64_tr_b16 v[4:5], v14 offset:4096
    v_mfma_f32_16x16x32_bf16 v[20:23], v[48:51], v[224:227], v[20:23]
    ds_read_b64_tr_b16 v[6:7], v14 offset:4608
    v_mfma_f32_16x16x32_bf16 v[24:27], v[48:51], v[228:231], v[24:27]
    ds_read_b64_tr_b16 v[8:9], v15 offset:4096
    s_waitcnt lgkmcnt(7)
    v_mfma_f32_16x16x32_bf16 v[28:31], v[52:55], v[220:223], v[28:31]
    ds_read_b64_tr_b16 v[10:11], v15 offset:4608
    v_mfma_f32_16x16x32_bf16 v[32:35], v[52:55], v[224:227], v[32:35]
    s_add_u32 m0, s17, 28672
    s_add_u32 s18, s18, 262144
    buffer_load_dwordx4 v2, s[8:11], s18 offen lds
    s_add_u32 s30, s30, 524288
    s_cmp_eq_u32 s30, 3670016
    s_cselect_b32 s30, 0, s30
    s_add_u32 s31, s31, 128
    s_and_b32 s31, s31, 511
    v_mfma_f32_16x16x32_bf16 v[36:39], v[52:55], v[228:231], v[36:39]
    v_cvt_pk_bf16_f32 v48, v16, v17
    v_cvt_pk_bf16_f32 v49, v18, v19
    ds_write_b64 v45, v[48:49] offset:12288
    v_cvt_pk_bf16_f32 v50, v28, v29
    v_cvt_pk_bf16_f32 v51, v30, v31
    ds_write_b64 v13, v[50:51] offset:12288
    v_cvt_pk_bf16_f32 v52, v20, v21
    v_cvt_pk_bf16_f32 v53, v22, v23
    ds_write_b64 v45, v[52:53] offset:16384
    v_cvt_pk_bf16_f32 v54, v32, v33
    v_cvt_pk_bf16_f32 v55, v34, v35
    ds_write_b64 v13, v[54:55] offset:16384
    v_cvt_pk_bf16_f32 v48, v24, v25
    v_cvt_pk_bf16_f32 v49, v26, v27
    ds_write_b64 v45, v[48:49] offset:20480
    v_cvt_pk_bf16_f32 v50, v36, v37
    v_cvt_pk_bf16_f32 v51, v38, v39
    ds_write_b64 v13, v[50:51] offset:20480
    s_add_u32 m0, s17, 57344
    s_add_u32 s18, s30, s31
    buffer_load_dwordx4 v2, s[8:11], s18 offen lds
    s_add_u32 m0, s17, 61440
    s_add_u32 s18, s18, 262144
    buffer_load_dwordx4 v2, s[8:11], s18 offen lds
    s_add_u32 s30, s30, 524288
    s_cmp_eq_u32 s30, 3670016
    s_cselect_b32 s30, 0, s30
    s_waitcnt vmcnt(10) lgkmcnt(0)
    s_barrier
    v_mfma_f32_16x16x32_bf16 v[16:19], v[56:59], v[64:67], 0
    v_add_u32 v14, 65536, v3
    v_mfma_f32_16x16x32_bf16 v[20:23], v[56:59], v[68:71], 0
    ds_read_b64_tr_b16 v[48:49], v14 offset:0
    v_mfma_f32_16x16x32_bf16 v[24:27], v[56:59], v[72:75], 0
    ds_read_b64_tr_b16 v[50:51], v14 offset:512
    v_mfma_f32_16x16x32_bf16 v[28:31], v[60:63], v[64:67], 0
    v_add_u32 v15, 65536, v12
    v_mfma_f32_16x16x32_bf16 v[32:35], v[60:63], v[68:71], 0
    ds_read_b64_tr_b16 v[52:53], v15 offset:0
    v_mfma_f32_16x16x32_bf16 v[36:39], v[60:63], v[72:75], 0
    ds_read_b64_tr_b16 v[54:55], v15 offset:512
    v_mfma_f32_16x16x32_bf16 v[16:19], v[4:7], v[76:79], v[16:19]
    ds_read_b64_tr_b16 v[56:57], v14 offset:4096
    v_mfma_f32_16x16x32_bf16 v[20:23], v[4:7], v[80:83], v[20:23]
    ds_read_b64_tr_b16 v[58:59], v14 offset:4608
    v_mfma_f32_16x16x32_bf16 v[24:27], v[4:7], v[84:87], v[24:27]
    ds_read_b64_tr_b16 v[60:61], v15 offset:4096
    v_mfma_f32_16x16x32_bf16 v[28:31], v[8:11], v[76:79], v[28:31]
    ds_read_b64_tr_b16 v[62:63], v15 offset:4608
    v_mfma_f32_16x16x32_bf16 v[32:35], v[8:11], v[80:83], v[32:35]
    s_add_u32 m0, s17, 32768
    s_add_u32 s18, s30, s31
    buffer_load_dwordx4 v2, s[8:11], s18 offen lds
    v_mfma_f32_16x16x32_bf16 v[36:39], v[8:11], v[84:87], v[36:39]
    s_waitcnt lgkmcnt(6)
    v_mfma_f32_16x16x32_bf16 v[16:19], v[48:51], v[88:91], v[16:19]
    v_add_u32 v14, 73728, v3
    v_mfma_f32_16x16x32_bf16 v[20:23], v[48:51], v[92:95], v[20:23]
    ds_read_b64_tr_b16 v[4:5], v14 offset:0
    v_mfma_f32_16x16x32_bf16 v[24:27], v[48:51], v[96:99], v[24:27]
    ds_read_b64_tr_b16 v[6:7], v14 offset:512
    s_waitcnt lgkmcnt(6)
    v_mfma_f32_16x16x32_bf16 v[28:31], v[52:55], v[88:91], v[28:31]
    v_add_u32 v15, 73728, v12
    v_mfma_f32_16x16x32_bf16 v[32:35], v[52:55], v[92:95], v[32:35]
    ds_read_b64_tr_b16 v[8:9], v15 offset:0
    v_mfma_f32_16x16x32_bf16 v[36:39], v[52:55], v[96:99], v[36:39]
    ds_read_b64_tr_b16 v[10:11], v15 offset:512
    s_waitcnt lgkmcnt(6)
    v_mfma_f32_16x16x32_bf16 v[16:19], v[56:59], v[100:103], v[16:19]
    ds_read_b64_tr_b16 v[48:49], v14 offset:4096
    v_mfma_f32_16x16x32_bf16 v[20:23], v[56:59], v[104:107], v[20:23]
    ds_read_b64_tr_b16 v[50:51], v14 offset:4608
    v_mfma_f32_16x16x32_bf16 v[24:27], v[56:59], v[108:111], v[24:27]
    ds_read_b64_tr_b16 v[52:53], v15 offset:4096
    s_waitcnt lgkmcnt(7)
    v_mfma_f32_16x16x32_bf16 v[28:31], v[60:63], v[100:103], v[28:31]
    ds_read_b64_tr_b16 v[54:55], v15 offset:4608
    v_mfma_f32_16x16x32_bf16 v[32:35], v[60:63], v[104:107], v[32:35]
    s_add_u32 m0, s17, 36864
    s_add_u32 s18, s18, 262144
    buffer_load_dwordx4 v2, s[8:11], s18 offen lds
    s_add_u32 s30, s30, 524288
    s_cmp_eq_u32 s30, 3670016
    s_cselect_b32 s30, 0, s30
    v_mfma_f32_16x16x32_bf16 v[36:39], v[60:63], v[108:111], v[36:39]
    s_add_u32 m0, s17, 40960
    s_add_u32 s18, s30, s31
    buffer_load_dwordx4 v2, s[8:11], s18 offen lds
    s_add_u32 m0, s17, 45056
    s_add_u32 s18, s18, 262144
    buffer_load_dwordx4 v2, s[8:11], s18 offen lds
    s_add_u32 s30, s30, 524288
    s_cmp_eq_u32 s30, 3670016
    s_cselect_b32 s30, 0, s30
    s_waitcnt vmcnt(10) lgkmcnt(0)
    s_barrier
    v_mfma_f32_16x16x32_bf16 v[16:19], v[4:7], v[112:115], v[16:19]
    v_add_u32 v14, 81920, v3
    v_mfma_f32_16x16x32_bf16 v[20:23], v[4:7], v[116:119], v[20:23]
    ds_read_b64_tr_b16 v[56:57], v14 offset:0
    v_mfma_f32_16x16x32_bf16 v[24:27], v[4:7], v[120:123], v[24:27]
    ds_read_b64_tr_b16 v[58:59], v14 offset:512
    v_mfma_f32_16x16x32_bf16 v[28:31], v[8:11], v[112:115], v[28:31]
    v_add_u32 v15, 81920, v12
    v_mfma_f32_16x16x32_bf16 v[32:35], v[8:11], v[116:119], v[32:35]
    ds_read_b64_tr_b16 v[60:61], v15 offset:0
    v_mfma_f32_16x16x32_bf16 v[36:39], v[8:11], v[120:123], v[36:39]
    ds_read_b64_tr_b16 v[62:63], v15 offset:512
    v_mfma_f32_16x16x32_bf16 v[16:19], v[48:51], v[124:127], v[16:19]
    ds_read_b64_tr_b16 v[4:5], v14 offset:4096
    v_mfma_f32_16x16x32_bf16 v[20:23], v[48:51], v[128:131], v[20:23]
    ds_read_b64_tr_b16 v[6:7], v14 offset:4608
    v_mfma_f32_16x16x32_bf16 v[24:27], v[48:51], v[132:135], v[24:27]
    ds_read_b64_tr_b16 v[8:9], v15 offset:4096
    v_mfma_f32_16x16x32_bf16 v[28:31], v[52:55], v[124:127], v[28:31]
    ds_read_b64_tr_b16 v[10:11], v15 offset:4608
    v_mfma_f32_16x16x32_bf16 v[32:35], v[52:55], v[128:131], v[32:35]
    s_add_u32 m0, s17, 65536
    s_add_u32 s18, s30, s31
    buffer_load_dwordx4 v2, s[8:11], s18 offen lds
    v_mfma_f32_16x16x32_bf16 v[36:39], v[52:55], v[132:135], v[36:39]
    s_waitcnt lgkmcnt(6)
    v_mfma_f32_16x16x32_bf16 v[16:19], v[56:59], v[136:139], v[16:19]
    v_add_u32 v14, 49152, v3
    v_mfma_f32_16x16x32_bf16 v[20:23], v[56:59], v[140:143], v[20:23]
    ds_read_b64_tr_b16 v[48:49], v14 offset:0
    v_mfma_f32_16x16x32_bf16 v[24:27], v[56:59], v[144:147], v[24:27]
    ds_read_b64_tr_b16 v[50:51], v14 offset:512
    s_waitcnt lgkmcnt(6)
    v_mfma_f32_16x16x32_bf16 v[28:31], v[60:63], v[136:139], v[28:31]
    v_add_u32 v15, 49152, v12
    v_mfma_f32_16x16x32_bf16 v[32:35], v[60:63], v[140:143], v[32:35]
    ds_read_b64_tr_b16 v[52:53], v15 offset:0
    v_mfma_f32_16x16x32_bf16 v[36:39], v[60:63], v[144:147], v[36:39]
    ds_read_b64_tr_b16 v[54:55], v15 offset:512
    s_waitcnt lgkmcnt(6)
    v_mfma_f32_16x16x32_bf16 v[16:19], v[4:7], v[148:151], v[16:19]
    ds_read_b64_tr_b16 v[56:57], v14 offset:4096
    v_mfma_f32_16x16x32_bf16 v[20:23], v[4:7], v[152:155], v[20:23]
    ds_read_b64_tr_b16 v[58:59], v14 offset:4608
    v_mfma_f32_16x16x32_bf16 v[24:27], v[4:7], v[156:159], v[24:27]
    ds_read_b64_tr_b16 v[60:61], v15 offset:4096
    s_waitcnt lgkmcnt(7)
    v_mfma_f32_16x16x32_bf16 v[28:31], v[8:11], v[148:151], v[28:31]
    ds_read_b64_tr_b16 v[62:63], v15 offset:4608
    v_mfma_f32_16x16x32_bf16 v[32:35], v[8:11], v[152:155], v[32:35]
    s_add_u32 m0, s17, 69632
    s_add_u32 s18, s18, 262144
    buffer_load_dwordx4 v2, s[8:11], s18 offen lds
    s_add_u32 s30, s30, 524288
    s_cmp_eq_u32 s30, 3670016
    s_cselect_b32 s30, 0, s30
    v_mfma_f32_16x16x32_bf16 v[36:39], v[8:11], v[156:159], v[36:39]
    s_add_u32 m0, s17, 73728
    s_add_u32 s18, s30, s31
    buffer_load_dwordx4 v2, s[8:11], s18 offen lds
    s_add_u32 m0, s17, 77824
    s_add_u32 s18, s18, 262144
    buffer_load_dwordx4 v2, s[8:11], s18 offen lds
    s_add_u32 s30, s30, 524288
    s_cmp_eq_u32 s30, 3670016
    s_cselect_b32 s30, 0, s30
    s_waitcnt vmcnt(10) lgkmcnt(0)
    s_barrier
    v_mfma_f32_16x16x32_bf16 v[16:19], v[48:51], v[160:163], v[16:19]
    v_add_u32 v14, 155648, v3
    v_mfma_f32_16x16x32_bf16 v[20:23], v[48:51], v[164:167], v[20:23]
    ds_read_b64_tr_b16 v[4:5], v14 offset:0
    v_mfma_f32_16x16x32_bf16 v[24:27], v[48:51], v[168:171], v[24:27]
    ds_read_b64_tr_b16 v[6:7], v14 offset:512
    v_mfma_f32_16x16x32_bf16 v[28:31], v[52:55], v[160:163], v[28:31]
    v_add_u32 v15, 155648, v12
    v_mfma_f32_16x16x32_bf16 v[32:35], v[52:55], v[164:167], v[32:35]
    ds_read_b64_tr_b16 v[8:9], v15 offset:0
    v_mfma_f32_16x16x32_bf16 v[36:39], v[52:55], v[168:171], v[36:39]
    ds_read_b64_tr_b16 v[10:11], v15 offset:512
    v_mfma_f32_16x16x32_bf16 v[16:19], v[56:59], v[172:175], v[16:19]
    ds_read_b64_tr_b16 v[48:49], v14 offset:4096
    v_mfma_f32_16x16x32_bf16 v[20:23], v[56:59], v[176:179], v[20:23]
    ds_read_b64_tr_b16 v[50:51], v14 offset:4608
    v_mfma_f32_16x16x32_bf16 v[24:27], v[56:59], v[180:183], v[24:27]
    ds_read_b64_tr_b16 v[52:53], v15 offset:4096
    v_mfma_f32_16x16x32_bf16 v[28:31], v[60:63], v[172:175], v[28:31]
    ds_read_b64_tr_b16 v[54:55], v15 offset:4608
    v_mfma_f32_16x16x32_bf16 v[32:35], v[60:63], v[176:179], v[32:35]
    s_add_u32 m0, s17, 49152
    s_add_u32 s18, s30, s31
    buffer_load_dwordx4 v2, s[8:11], s18 offen lds
    v_mfma_f32_16x16x32_bf16 v[36:39], v[60:63], v[180:183], v[36:39]
    s_waitcnt lgkmcnt(6)
    v_mfma_f32_16x16x32_bf16 v[16:19], v[4:7], v[184:187], v[16:19]
    v_add_u32 v14, 24576, v3
    v_mfma_f32_16x16x32_bf16 v[20:23], v[4:7], v[188:191], v[20:23]
    ds_read_b64_tr_b16 v[56:57], v14 offset:0
    v_mfma_f32_16x16x32_bf16 v[24:27], v[4:7], v[192:195], v[24:27]
    ds_read_b64_tr_b16 v[58:59], v14 offset:512
    s_waitcnt lgkmcnt(6)
    v_mfma_f32_16x16x32_bf16 v[28:31], v[8:11], v[184:187], v[28:31]
    v_add_u32 v15, 24576, v12
    v_mfma_f32_16x16x32_bf16 v[32:35], v[8:11], v[188:191], v[32:35]
    ds_read_b64_tr_b16 v[60:61], v15 offset:0
    v_mfma_f32_16x16x32_bf16 v[36:39], v[8:11], v[192:195], v[36:39]
    ds_read_b64_tr_b16 v[62:63], v15 offset:512
    s_waitcnt lgkmcnt(6)
    v_mfma_f32_16x16x32_bf16 v[16:19], v[48:51], v[196:199], v[16:19]
    ds_read_b64_tr_b16 v[4:5], v14 offset:4096
    v_mfma_f32_16x16x32_bf16 v[20:23], v[48:51], v[200:203], v[20:23]
    ds_read_b64_tr_b16 v[6:7], v14 offset:4608
    v_mfma_f32_16x16x32_bf16 v[24:27], v[48:51], v[204:207], v[24:27]
    ds_read_b64_tr_b16 v[8:9], v15 offset:4096
    s_waitcnt lgkmcnt(7)
    v_mfma_f32_16x16x32_bf16 v[28:31], v[52:55], v[196:199], v[28:31]
    ds_read_b64_tr_b16 v[10:11], v15 offset:4608
    v_mfma_f32_16x16x32_bf16 v[32:35], v[52:55], v[200:203], v[32:35]
    s_add_u32 m0, s17, 53248
    s_add_u32 s18, s18, 262144
    buffer_load_dwordx4 v2, s[8:11], s18 offen lds
    s_add_u32 s30, s30, 524288
    s_cmp_eq_u32 s30, 3670016
    s_cselect_b32 s30, 0, s30
    v_mfma_f32_16x16x32_bf16 v[36:39], v[52:55], v[204:207], v[36:39]
    s_add_u32 m0, s17, 81920
    s_add_u32 s18, s30, s31
    buffer_load_dwordx4 v2, s[8:11], s18 offen lds
    s_add_u32 m0, s17, 86016
    s_add_u32 s18, s18, 262144
    buffer_load_dwordx4 v2, s[8:11], s18 offen lds
    s_add_u32 s30, s30, 524288
    s_cmp_eq_u32 s30, 3670016
    s_cselect_b32 s30, 0, s30
    s_add_u32 s31, s31, 128
    s_and_b32 s31, s31, 511
    s_waitcnt vmcnt(10) lgkmcnt(0)
    s_barrier
    v_mfma_f32_16x16x32_bf16 v[16:19], v[56:59], v[208:211], v[16:19]
    v_add_u32 v14, 57344, v3
    v_mfma_f32_16x16x32_bf16 v[20:23], v[56:59], v[212:215], v[20:23]
    ds_read_b64_tr_b16 v[48:49], v14 offset:0
    v_mfma_f32_16x16x32_bf16 v[24:27], v[56:59], v[216:219], v[24:27]
    ds_read_b64_tr_b16 v[50:51], v14 offset:512
    v_mfma_f32_16x16x32_bf16 v[28:31], v[60:63], v[208:211], v[28:31]
    v_add_u32 v15, 57344, v12
    v_mfma_f32_16x16x32_bf16 v[32:35], v[60:63], v[212:215], v[32:35]
    ds_read_b64_tr_b16 v[52:53], v15 offset:0
    v_mfma_f32_16x16x32_bf16 v[36:39], v[60:63], v[216:219], v[36:39]
    ds_read_b64_tr_b16 v[54:55], v15 offset:512
    v_mfma_f32_16x16x32_bf16 v[16:19], v[4:7], v[220:223], v[16:19]
    ds_read_b64_tr_b16 v[56:57], v14 offset:4096
    v_mfma_f32_16x16x32_bf16 v[20:23], v[4:7], v[224:227], v[20:23]
    ds_read_b64_tr_b16 v[58:59], v14 offset:4608
    v_mfma_f32_16x16x32_bf16 v[24:27], v[4:7], v[228:231], v[24:27]
    ds_read_b64_tr_b16 v[60:61], v15 offset:4096
    v_mfma_f32_16x16x32_bf16 v[28:31], v[8:11], v[220:223], v[28:31]
    ds_read_b64_tr_b16 v[62:63], v15 offset:4608
    v_mfma_f32_16x16x32_bf16 v[32:35], v[8:11], v[224:227], v[32:35]
    v_mfma_f32_16x16x32_bf16 v[36:39], v[8:11], v[228:231], v[36:39]
    v_cvt_pk_bf16_f32 v4, v16, v17
    v_cvt_pk_bf16_f32 v5, v18, v19
    ds_write_b64 v45, v[4:5] offset:0
    s_nop 1
    v_cvt_pk_bf16_f32 v6, v28, v29
    v_cvt_pk_bf16_f32 v7, v30, v31
    ds_write_b64 v13, v[6:7] offset:0
    v_cvt_pk_bf16_f32 v8, v20, v21
    v_cvt_pk_bf16_f32 v9, v22, v23
    ds_write_b64 v45, v[8:9] offset:4096
    v_cvt_pk_bf16_f32 v10, v32, v33
    v_cvt_pk_bf16_f32 v11, v34, v35
    ds_write_b64 v13, v[10:11] offset:4096
    v_cvt_pk_bf16_f32 v4, v24, v25
    v_cvt_pk_bf16_f32 v5, v26, v27
    ds_write_b64 v45, v[4:5] offset:8192
    v_cvt_pk_bf16_f32 v6, v36, v37
    v_cvt_pk_bf16_f32 v7, v38, v39
    ds_write_b64 v13, v[6:7] offset:8192
    s_waitcnt lgkmcnt(12)
    v_mfma_f32_16x16x32_bf16 v[16:19], v[48:51], v[64:67], 0
    v_add_u32 v14, 32768, v3
    v_mfma_f32_16x16x32_bf16 v[20:23], v[48:51], v[68:71], 0
    ds_read_b64_tr_b16 v[4:5], v14 offset:0
    v_mfma_f32_16x16x32_bf16 v[24:27], v[48:51], v[72:75], 0
    ds_read_b64_tr_b16 v[6:7], v14 offset:512
    s_waitcnt lgkmcnt(12)
    v_mfma_f32_16x16x32_bf16 v[28:31], v[52:55], v[64:67], 0
    v_add_u32 v15, 32768, v12
    v_mfma_f32_16x16x32_bf16 v[32:35], v[52:55], v[68:71], 0
    ds_read_b64_tr_b16 v[8:9], v15 offset:0
    v_mfma_f32_16x16x32_bf16 v[36:39], v[52:55], v[72:75], 0
    ds_read_b64_tr_b16 v[10:11], v15 offset:512
    s_waitcnt lgkmcnt(12)
    v_mfma_f32_16x16x32_bf16 v[16:19], v[56:59], v[76:79], v[16:19]
    ds_read_b64_tr_b16 v[48:49], v14 offset:4096
    v_mfma_f32_16x16x32_bf16 v[20:23], v[56:59], v[80:83], v[20:23]
    ds_read_b64_tr_b16 v[50:51], v14 offset:4608
    v_mfma_f32_16x16x32_bf16 v[24:27], v[56:59], v[84:87], v[24:27]
    ds_read_b64_tr_b16 v[52:53], v15 offset:4096
    s_waitcnt lgkmcnt(13)
    v_mfma_f32_16x16x32_bf16 v[28:31], v[60:63], v[76:79], v[28:31]
    ds_read_b64_tr_b16 v[54:55], v15 offset:4608
    v_mfma_f32_16x16x32_bf16 v[32:35], v[60:63], v[80:83], v[32:35]
    v_mfma_f32_16x16x32_bf16 v[36:39], v[60:63], v[84:87], v[36:39]
    s_waitcnt vmcnt(6) lgkmcnt(0)
    s_barrier
    v_mfma_f32_16x16x32_bf16 v[16:19], v[4:7], v[88:91], v[16:19]
    v_add_u32 v14, 40960, v3
    v_mfma_f32_16x16x32_bf16 v[20:23], v[4:7], v[92:95], v[20:23]
    ds_read_b64_tr_b16 v[56:57], v14 offset:0
    v_mfma_f32_16x16x32_bf16 v[24:27], v[4:7], v[96:99], v[24:27]
    ds_read_b64_tr_b16 v[58:59], v14 offset:512
    v_mfma_f32_16x16x32_bf16 v[28:31], v[8:11], v[88:91], v[28:31]
    v_add_u32 v15, 40960, v12
    v_mfma_f32_16x16x32_bf16 v[32:35], v[8:11], v[92:95], v[32:35]
    ds_read_b64_tr_b16 v[60:61], v15 offset:0
    v_mfma_f32_16x16x32_bf16 v[36:39], v[8:11], v[96:99], v[36:39]
    ds_read_b64_tr_b16 v[62:63], v15 offset:512
    v_mfma_f32_16x16x32_bf16 v[16:19], v[48:51], v[100:103], v[16:19]
    ds_read_b64_tr_b16 v[4:5], v14 offset:4096
    v_mfma_f32_16x16x32_bf16 v[20:23], v[48:51], v[104:107], v[20:23]
    ds_read_b64_tr_b16 v[6:7], v14 offset:4608
    v_mfma_f32_16x16x32_bf16 v[24:27], v[48:51], v[108:111], v[24:27]
    ds_read_b64_tr_b16 v[8:9], v15 offset:4096
    v_mfma_f32_16x16x32_bf16 v[28:31], v[52:55], v[100:103], v[28:31]
    ds_read_b64_tr_b16 v[10:11], v15 offset:4608
    v_mfma_f32_16x16x32_bf16 v[32:35], v[52:55], v[104:107], v[32:35]
    v_mfma_f32_16x16x32_bf16 v[36:39], v[52:55], v[108:111], v[36:39]
    s_waitcnt lgkmcnt(6)
    v_mfma_f32_16x16x32_bf16 v[16:19], v[56:59], v[112:115], v[16:19]
    v_add_u32 v14, 65536, v3
    v_mfma_f32_16x16x32_bf16 v[20:23], v[56:59], v[116:119], v[20:23]
    ds_read_b64_tr_b16 v[48:49], v14 offset:0
    v_mfma_f32_16x16x32_bf16 v[24:27], v[56:59], v[120:123], v[24:27]
    ds_read_b64_tr_b16 v[50:51], v14 offset:512
    s_waitcnt lgkmcnt(6)
    v_mfma_f32_16x16x32_bf16 v[28:31], v[60:63], v[112:115], v[28:31]
    v_add_u32 v15, 65536, v12
    v_mfma_f32_16x16x32_bf16 v[32:35], v[60:63], v[116:119], v[32:35]
    ds_read_b64_tr_b16 v[52:53], v15 offset:0
    v_mfma_f32_16x16x32_bf16 v[36:39], v[60:63], v[120:123], v[36:39]
    ds_read_b64_tr_b16 v[54:55], v15 offset:512
    s_waitcnt lgkmcnt(6)
    v_mfma_f32_16x16x32_bf16 v[16:19], v[4:7], v[124:127], v[16:19]
    ds_read_b64_tr_b16 v[56:57], v14 offset:4096
    v_mfma_f32_16x16x32_bf16 v[20:23], v[4:7], v[128:131], v[20:23]
    ds_read_b64_tr_b16 v[58:59], v14 offset:4608
    v_mfma_f32_16x16x32_bf16 v[24:27], v[4:7], v[132:135], v[24:27]
    ds_read_b64_tr_b16 v[60:61], v15 offset:4096
    s_waitcnt lgkmcnt(7)
    v_mfma_f32_16x16x32_bf16 v[28:31], v[8:11], v[124:127], v[28:31]
    ds_read_b64_tr_b16 v[62:63], v15 offset:4608
    v_mfma_f32_16x16x32_bf16 v[32:35], v[8:11], v[128:131], v[32:35]
    v_mfma_f32_16x16x32_bf16 v[36:39], v[8:11], v[132:135], v[36:39]
    s_waitcnt vmcnt(2) lgkmcnt(0)
    s_barrier
    v_mfma_f32_16x16x32_bf16 v[16:19], v[48:51], v[136:139], v[16:19]
    v_add_u32 v14, 73728, v3
    v_mfma_f32_16x16x32_bf16 v[20:23], v[48:51], v[140:143], v[20:23]
    ds_read_b64_tr_b16 v[4:5], v14 offset:0
    v_mfma_f32_16x16x32_bf16 v[24:27], v[48:51], v[144:147], v[24:27]
    ds_read_b64_tr_b16 v[6:7], v14 offset:512
    v_mfma_f32_16x16x32_bf16 v[28:31], v[52:55], v[136:139], v[28:31]
    v_add_u32 v15, 73728, v12
    v_mfma_f32_16x16x32_bf16 v[32:35], v[52:55], v[140:143], v[32:35]
    ds_read_b64_tr_b16 v[8:9], v15 offset:0
    v_mfma_f32_16x16x32_bf16 v[36:39], v[52:55], v[144:147], v[36:39]
    ds_read_b64_tr_b16 v[10:11], v15 offset:512
    v_mfma_f32_16x16x32_bf16 v[16:19], v[56:59], v[148:151], v[16:19]
    ds_read_b64_tr_b16 v[48:49], v14 offset:4096
    v_mfma_f32_16x16x32_bf16 v[20:23], v[56:59], v[152:155], v[20:23]
    ds_read_b64_tr_b16 v[50:51], v14 offset:4608
    v_mfma_f32_16x16x32_bf16 v[24:27], v[56:59], v[156:159], v[24:27]
    ds_read_b64_tr_b16 v[52:53], v15 offset:4096
    v_mfma_f32_16x16x32_bf16 v[28:31], v[60:63], v[148:151], v[28:31]
    ds_read_b64_tr_b16 v[54:55], v15 offset:4608
    v_mfma_f32_16x16x32_bf16 v[32:35], v[60:63], v[152:155], v[32:35]
    v_mfma_f32_16x16x32_bf16 v[36:39], v[60:63], v[156:159], v[36:39]
    s_waitcnt lgkmcnt(6)
    v_mfma_f32_16x16x32_bf16 v[16:19], v[4:7], v[160:163], v[16:19]
    v_add_u32 v14, 49152, v3
    v_mfma_f32_16x16x32_bf16 v[20:23], v[4:7], v[164:167], v[20:23]
    ds_read_b64_tr_b16 v[56:57], v14 offset:0
    v_mfma_f32_16x16x32_bf16 v[24:27], v[4:7], v[168:171], v[24:27]
    ds_read_b64_tr_b16 v[58:59], v14 offset:512
    s_waitcnt lgkmcnt(6)
    v_mfma_f32_16x16x32_bf16 v[28:31], v[8:11], v[160:163], v[28:31]
    v_add_u32 v15, 49152, v12
    v_mfma_f32_16x16x32_bf16 v[32:35], v[8:11], v[164:167], v[32:35]
    ds_read_b64_tr_b16 v[60:61], v15 offset:0
    v_mfma_f32_16x16x32_bf16 v[36:39], v[8:11], v[168:171], v[36:39]
    ds_read_b64_tr_b16 v[62:63], v15 offset:512
    s_waitcnt lgkmcnt(6)
    v_mfma_f32_16x16x32_bf16 v[16:19], v[48:51], v[172:175], v[16:19]
    ds_read_b64_tr_b16 v[4:5], v14 offset:4096
    v_mfma_f32_16x16x32_bf16 v[20:23], v[48:51], v[176:179], v[20:23]
    ds_read_b64_tr_b16 v[6:7], v14 offset:4608
    v_mfma_f32_16x16x32_bf16 v[24:27], v[48:51], v[180:183], v[24:27]
    ds_read_b64_tr_b16 v[8:9], v15 offset:4096
    s_waitcnt lgkmcnt(7)
    v_mfma_f32_16x16x32_bf16 v[28:31], v[52:55], v[172:175], v[28:31]
    ds_read_b64_tr_b16 v[10:11], v15 offset:4608
    v_mfma_f32_16x16x32_bf16 v[32:35], v[52:55], v[176:179], v[32:35]
    v_mfma_f32_16x16x32_bf16 v[36:39], v[52:55], v[180:183], v[36:39]
    s_waitcnt vmcnt(0) lgkmcnt(0)
    s_barrier
    v_mfma_f32_16x16x32_bf16 v[16:19], v[56:59], v[184:187], v[16:19]
    v_add_u32 v14, 81920, v3
    v_mfma_f32_16x16x32_bf16 v[20:23], v[56:59], v[188:191], v[20:23]
    ds_read_b64_tr_b16 v[48:49], v14 offset:0
    v_mfma_f32_16x16x32_bf16 v[24:27], v[56:59], v[192:195], v[24:27]
    ds_read_b64_tr_b16 v[50:51], v14 offset:512
    v_mfma_f32_16x16x32_bf16 v[28:31], v[60:63], v[184:187], v[28:31]
    v_add_u32 v15, 81920, v12
    v_mfma_f32_16x16x32_bf16 v[32:35], v[60:63], v[188:191], v[32:35]
    ds_read_b64_tr_b16 v[52:53], v15 offset:0
    v_mfma_f32_16x16x32_bf16 v[36:39], v[60:63], v[192:195], v[36:39]
    ds_read_b64_tr_b16 v[54:55], v15 offset:512
    v_mfma_f32_16x16x32_bf16 v[16:19], v[4:7], v[196:199], v[16:19]
    ds_read_b64_tr_b16 v[56:57], v14 offset:4096
    v_mfma_f32_16x16x32_bf16 v[20:23], v[4:7], v[200:203], v[20:23]
    ds_read_b64_tr_b16 v[58:59], v14 offset:4608
    v_mfma_f32_16x16x32_bf16 v[24:27], v[4:7], v[204:207], v[24:27]
    ds_read_b64_tr_b16 v[60:61], v15 offset:4096
    v_mfma_f32_16x16x32_bf16 v[28:31], v[8:11], v[196:199], v[28:31]
    ds_read_b64_tr_b16 v[62:63], v15 offset:4608
    v_mfma_f32_16x16x32_bf16 v[32:35], v[8:11], v[200:203], v[32:35]
    v_mfma_f32_16x16x32_bf16 v[36:39], v[8:11], v[204:207], v[36:39]
    s_waitcnt lgkmcnt(6)
    v_mfma_f32_16x16x32_bf16 v[16:19], v[48:51], v[208:211], v[16:19]
    v_mfma_f32_16x16x32_bf16 v[20:23], v[48:51], v[212:215], v[20:23]
    v_mfma_f32_16x16x32_bf16 v[24:27], v[48:51], v[216:219], v[24:27]
    s_waitcnt lgkmcnt(4)
    v_mfma_f32_16x16x32_bf16 v[28:31], v[52:55], v[208:211], v[28:31]
    v_mfma_f32_16x16x32_bf16 v[32:35], v[52:55], v[212:215], v[32:35]
    v_mfma_f32_16x16x32_bf16 v[36:39], v[52:55], v[216:219], v[36:39]
    s_waitcnt lgkmcnt(2)
    v_mfma_f32_16x16x32_bf16 v[16:19], v[56:59], v[220:223], v[16:19]
    v_mfma_f32_16x16x32_bf16 v[20:23], v[56:59], v[224:227], v[20:23]
    v_mfma_f32_16x16x32_bf16 v[24:27], v[56:59], v[228:231], v[24:27]
    s_waitcnt lgkmcnt(0)
    v_mfma_f32_16x16x32_bf16 v[28:31], v[60:63], v[220:223], v[28:31]
    v_mfma_f32_16x16x32_bf16 v[32:35], v[60:63], v[224:227], v[32:35]
    v_mfma_f32_16x16x32_bf16 v[36:39], v[60:63], v[228:231], v[36:39]
    s_nop 1
    v_cvt_pk_bf16_f32 v56, v16, v17
    v_cvt_pk_bf16_f32 v57, v18, v19
    ds_write_b64 v45, v[56:57] offset:12288
    s_nop 0
    v_cvt_pk_bf16_f32 v58, v28, v29
    v_cvt_pk_bf16_f32 v59, v30, v31
    ds_write_b64 v13, v[58:59] offset:12288
    v_cvt_pk_bf16_f32 v60, v20, v21
    v_cvt_pk_bf16_f32 v61, v22, v23
    ds_write_b64 v45, v[60:61] offset:16384
    v_cvt_pk_bf16_f32 v62, v32, v33
    v_cvt_pk_bf16_f32 v63, v34, v35
    ds_write_b64 v13, v[62:63] offset:16384
    v_cvt_pk_bf16_f32 v56, v24, v25
    v_cvt_pk_bf16_f32 v57, v26, v27
    ds_write_b64 v45, v[56:57] offset:20480
    v_cvt_pk_bf16_f32 v58, v36, v37
    v_cvt_pk_bf16_f32 v59, v38, v39
    ds_write_b64 v13, v[58:59] offset:20480
    s_waitcnt lgkmcnt(0)
    s_barrier
    s_load_dwordx4 s[44:47], s[0:1], 80
    s_lshl_b32 s63, s21, 3
    s_add_u32 s63, s63, s23
    s_mul_i32 s19, s63, 8448
    s_add_u32 s19, s19, 33554432
    s_add_u32 s36, s60, s19
    s_addc_u32 s37, s61, 0
    s_mov_b32 s38, 8192
    s_mov_b32 s39, 0x20000
    s_lshl_b32 s63, s63, 4
    s_waitcnt lgkmcnt(0)
    s_mov_b64 s[40:41], s[46:47]
    s_mov_b32 s42, 256
    s_mov_b32 s43, 0x20000
    v_bfe_u32 v14, v0, 2, 4
    v_lshlrev_b32 v3, 7, v14
    v_bfe_u32 v14, v0, 3, 2
    v_bfe_u32 v15, v0, 6, 1
    v_lshlrev_b32 v15, 1, v15
    v_xor_b32 v14, v14, v15
    v_lshl_add_u32 v3, v14, 5, v3
    v_and_b32 v14, 3, v0
    v_lshl_add_u32 v3, v14, 3, v3
    v_xor_b32 v12, 32, v3
    v_and_b32 v14, 63, v0
    v_lshlrev_b32 v43, 4, v14
    v_bfe_u32 v14, v0, 7, 1
    v_lshl_add_u32 v43, v14, 10, v43
    v_bfe_u32 v15, v0, 6, 1
    v_mul_u32_u24 v15, 6144, v15
    v_add_u32 v13, v43, v15
    v_and_b32 v15, 15, v0
    v_lshl_add_u32 v14, v14, 4, v15
    v_lshlrev_b32 v14, 6, v14
    v_add_u32 v44, 157696, v14
    s_barrier
    v_bfe_u32 v46, v0, 4, 2
    v_lshlrev_b32 v46, 1, v46
    v_and_b32 v47, 7, v0
    v_xor_b32 v46, v46, v47
    v_lshlrev_b32 v46, 4, v46
    v_lshrrev_b32 v1, 3, v0
    v_lshl_add_u32 v1, v1, 9, v46
    s_add_u32 m0, s17, 49152
    s_add_u32 s18, s32, 0
    buffer_load_dwordx4 v1, s[12:15], s18 offen nt lds
    s_add_u32 m0, s17, 53248
    s_add_u32 s18, s32, 16384
    buffer_load_dwordx4 v1, s[12:15], s18 offen nt lds
    s_add_u32 m0, s17, 57344
    s_add_u32 s18, s32, 32768
    buffer_load_dwordx4 v1, s[12:15], s18 offen nt lds
    s_add_u32 m0, s17, 61440
    s_add_u32 s18, s32, 49152
    buffer_load_dwordx4 v1, s[12:15], s18 offen nt lds
    s_barrier
    s_add_u32 m0, s17, 65536
    s_add_u32 s18, s32, 65536
    buffer_load_dwordx4 v1, s[12:15], s18 offen nt lds
    s_add_u32 m0, s17, 69632
    s_add_u32 s18, s32, 81920
    buffer_load_dwordx4 v1, s[12:15], s18 offen nt lds
    s_add_u32 m0, s17, 73728
    s_add_u32 s18, s32, 98304
    buffer_load_dwordx4 v1, s[12:15], s18 offen nt lds
    s_add_u32 m0, s17, 77824
    s_add_u32 s18, s32, 114688
    buffer_load_dwordx4 v1, s[12:15], s18 offen nt lds
    s_barrier
    s_add_u32 m0, s17, 81920
    s_add_u32 s18, s32, 131072
    buffer_load_dwordx4 v1, s[12:15], s18 offen nt lds
    s_add_u32 m0, s17, 86016
    s_add_u32 s18, s32, 147456
    buffer_load_dwordx4 v1, s[12:15], s18 offen nt lds
    s_add_u32 m0, s17, 90112
    s_add_u32 s18, s32, 163840
    buffer_load_dwordx4 v1, s[12:15], s18 offen nt lds
    s_add_u32 m0, s17, 94208
    s_add_u32 s18, s32, 180224
    buffer_load_dwordx4 v1, s[12:15], s18 offen nt lds
    s_add_u32 m0, s17, 98304
    s_add_u32 s18, s32, 196608
    buffer_load_dwordx4 v1, s[12:15], s18 offen nt lds
    s_add_u32 m0, s17, 102400
    s_add_u32 s18, s32, 212992
    buffer_load_dwordx4 v1, s[12:15], s18 offen nt lds
    s_waitcnt vmcnt(10)
    s_barrier
    ds_read_b128 v[64:67], v43 offset:0
    ds_read_b128 v[68:71], v43 offset:2048
    ds_read_b128 v[72:75], v43 offset:4096
    ds_read_b128 v[76:79], v43 offset:6144
    ds_read_b128 v[80:83], v43 offset:8192
    ds_read_b128 v[84:87], v43 offset:10240
    ds_read_b128 v[88:91], v43 offset:12288
    ds_read_b128 v[92:95], v43 offset:14336
    ds_read_b128 v[96:99], v43 offset:16384
    ds_read_b128 v[100:103], v43 offset:18432
    ds_read_b128 v[104:107], v43 offset:20480
    ds_read_b128 v[108:111], v43 offset:22528
    v_add_u32 v14, 49152, v3
    ds_read_b64_tr_b16 v[4:5], v14 offset:0
    ds_read_b64_tr_b16 v[6:7], v14 offset:2048
    v_add_u32 v15, 49152, v12
    ds_read_b64_tr_b16 v[8:9], v15 offset:0
    ds_read_b64_tr_b16 v[10:11], v15 offset:2048
    s_add_u32 m0, s17, 106496
    s_add_u32 s18, s32, 229376
    buffer_load_dwordx4 v1, s[12:15], s18 offen nt lds
    ds_read_b64_tr_b16 v[48:49], v14 offset:4096
    ds_read_b64_tr_b16 v[50:51], v14 offset:6144
    ds_read_b64_tr_b16 v[52:53], v15 offset:4096
    ds_read_b64_tr_b16 v[54:55], v15 offset:6144
    s_add_u32 m0, s17, 110592
    s_add_u32 s18, s32, 245760
    buffer_load_dwordx4 v1, s[12:15], s18 offen nt lds
    s_add_u32 s32, s32, 128
    s_and_b32 s32, s32, 511
    s_waitcnt lgkmcnt(6)
    v_mfma_f32_16x16x32_bf16 v[16:19], v[4:7], v[64:67], 0
    v_add_u32 v14, 57344, v3
    v_mfma_f32_16x16x32_bf16 v[20:23], v[4:7], v[68:71], 0
    ds_read_b64_tr_b16 v[56:57], v14 offset:0
    v_mfma_f32_16x16x32_bf16 v[24:27], v[4:7], v[72:75], 0
    ds_read_b64_tr_b16 v[58:59], v14 offset:2048
    s_waitcnt lgkmcnt(6)
    v_mfma_f32_16x16x32_bf16 v[28:31], v[8:11], v[64:67], 0
    v_add_u32 v15, 57344, v12
    v_mfma_f32_16x16x32_bf16 v[32:35], v[8:11], v[68:71], 0
    ds_read_b64_tr_b16 v[60:61], v15 offset:0
    v_mfma_f32_16x16x32_bf16 v[36:39], v[8:11], v[72:75], 0
    ds_read_b64_tr_b16 v[62:63], v15 offset:2048
    s_waitcnt lgkmcnt(6)
    v_mfma_f32_16x16x32_bf16 v[16:19], v[48:51], v[76:79], v[16:19]
    ds_read_b64_tr_b16 v[4:5], v14 offset:4096
    v_mfma_f32_16x16x32_bf16 v[20:23], v[48:51], v[80:83], v[20:23]
    ds_read_b64_tr_b16 v[6:7], v14 offset:6144
    v_mfma_f32_16x16x32_bf16 v[24:27], v[48:51], v[84:87], v[24:27]
    ds_read_b64_tr_b16 v[8:9], v15 offset:4096
    s_waitcnt lgkmcnt(7)
    v_mfma_f32_16x16x32_bf16 v[28:31], v[52:55], v[76:79], v[28:31]
    ds_read_b64_tr_b16 v[10:11], v15 offset:6144
    v_mfma_f32_16x16x32_bf16 v[32:35], v[52:55], v[80:83], v[32:35]
    s_add_u32 m0, s17, 114688
    s_add_u32 s18, s32, 0
    buffer_load_dwordx4 v1, s[12:15], s18 offen nt lds
    v_mfma_f32_16x16x32_bf16 v[36:39], v[52:55], v[84:87], v[36:39]
    s_add_u32 m0, s17, 118784
    s_add_u32 s18, s32, 16384
    buffer_load_dwordx4 v1, s[12:15], s18 offen nt lds
    s_waitcnt vmcnt(10) lgkmcnt(0)
    s_barrier
    ds_read_b128 v[112:115], v43 offset:24576
    ds_read_b128 v[116:119], v43 offset:26624
    ds_read_b128 v[120:123], v43 offset:28672
    ds_read_b128 v[124:127], v43 offset:30720
    ds_read_b128 v[128:131], v43 offset:32768
    ds_read_b128 v[132:135], v43 offset:34816
    ds_read_b128 v[136:139], v43 offset:36864
    ds_read_b128 v[140:143], v43 offset:38912
    ds_read_b128 v[144:147], v43 offset:40960
    ds_read_b128 v[148:151], v43 offset:43008
    ds_read_b128 v[152:155], v43 offset:45056
    ds_read_b128 v[156:159], v43 offset:47104
    v_mfma_f32_16x16x32_bf16 v[16:19], v[56:59], v[88:91], v[16:19]
    v_add_u32 v14, 65536, v3
    v_mfma_f32_16x16x32_bf16 v[20:23], v[56:59], v[92:95], v[20:23]
    ds_read_b64_tr_b16 v[48:49], v14 offset:0
    v_mfma_f32_16x16x32_bf16 v[24:27], v[56:59], v[96:99], v[24:27]
    ds_read_b64_tr_b16 v[50:51], v14 offset:2048
    v_mfma_f32_16x16x32_bf16 v[28:31], v[60:63], v[88:91], v[28:31]
    v_add_u32 v15, 65536, v12
    v_mfma_f32_16x16x32_bf16 v[32:35], v[60:63], v[92:95], v[32:35]
    ds_read_b64_tr_b16 v[52:53], v15 offset:0
    v_mfma_f32_16x16x32_bf16 v[36:39], v[60:63], v[96:99], v[36:39]
    ds_read_b64_tr_b16 v[54:55], v15 offset:2048
    v_mfma_f32_16x16x32_bf16 v[16:19], v[4:7], v[100:103], v[16:19]
    ds_read_b64_tr_b16 v[56:57], v14 offset:4096
    v_mfma_f32_16x16x32_bf16 v[20:23], v[4:7], v[104:107], v[20:23]
    ds_read_b64_tr_b16 v[58:59], v14 offset:6144
    v_mfma_f32_16x16x32_bf16 v[24:27], v[4:7], v[108:111], v[24:27]
    ds_read_b64_tr_b16 v[60:61], v15 offset:4096
    v_mfma_f32_16x16x32_bf16 v[28:31], v[8:11], v[100:103], v[28:31]
    ds_read_b64_tr_b16 v[62:63], v15 offset:6144
    v_mfma_f32_16x16x32_bf16 v[32:35], v[8:11], v[104:107], v[32:35]
    s_add_u32 m0, s17, 49152
    s_add_u32 s18, s32, 32768
    buffer_load_dwordx4 v1, s[12:15], s18 offen nt lds
    v_mfma_f32_16x16x32_bf16 v[36:39], v[8:11], v[108:111], v[36:39]
    s_waitcnt lgkmcnt(6)
    v_mfma_f32_16x16x32_bf16 v[16:19], v[48:51], v[112:115], v[16:19]
    v_add_u32 v14, 73728, v3
    v_mfma_f32_16x16x32_bf16 v[20:23], v[48:51], v[116:119], v[20:23]
    ds_read_b64_tr_b16 v[4:5], v14 offset:0
    v_mfma_f32_16x16x32_bf16 v[24:27], v[48:51], v[120:123], v[24:27]
    ds_read_b64_tr_b16 v[6:7], v14 offset:2048
    s_waitcnt lgkmcnt(6)
    v_mfma_f32_16x16x32_bf16 v[28:31], v[52:55], v[112:115], v[28:31]
    v_add_u32 v15, 73728, v12
    v_mfma_f32_16x16x32_bf16 v[32:35], v[52:55], v[116:119], v[32:35]
    ds_read_b64_tr_b16 v[8:9], v15 offset:0
    v_mfma_f32_16x16x32_bf16 v[36:39], v[52:55], v[120:123], v[36:39]
    ds_read_b64_tr_b16 v[10:11], v15 offset:2048
    s_waitcnt lgkmcnt(6)
    v_mfma_f32_16x16x32_bf16 v[16:19], v[56:59], v[124:127], v[16:19]
    ds_read_b64_tr_b16 v[48:49], v14 offset:4096
    v_mfma_f32_16x16x32_bf16 v[20:23], v[56:59], v[128:131], v[20:23]
    ds_read_b64_tr_b16 v[50:51], v14 offset:6144
    v_mfma_f32_16x16x32_bf16 v[24:27], v[56:59], v[132:135], v[24:27]
    ds_read_b64_tr_b16 v[52:53], v15 offset:4096
    s_waitcnt lgkmcnt(7)
    v_mfma_f32_16x16x32_bf16 v[28:31], v[60:63], v[124:127], v[28:31]
    ds_read_b64_tr_b16 v[54:55], v15 offset:6144
    v_mfma_f32_16x16x32_bf16 v[32:35], v[60:63], v[128:131], v[32:35]
    s_add_u32 m0, s17, 53248
    s_add_u32 s18, s32, 49152
    buffer_load_dwordx4 v1, s[12:15], s18 offen nt lds
    v_mfma_f32_16x16x32_bf16 v[36:39], v[60:63], v[132:135], v[36:39]
    s_add_u32 m0, s17, 57344
    s_add_u32 s18, s32, 65536
    buffer_load_dwordx4 v1, s[12:15], s18 offen nt lds
    s_add_u32 m0, s17, 61440
    s_add_u32 s18, s32, 81920
    buffer_load_dwordx4 v1, s[12:15], s18 offen nt lds
    s_waitcnt vmcnt(10) lgkmcnt(0)
    s_barrier
    ds_read_b128 v[160:163], v43 offset:0
    ds_read_b128 v[164:167], v43 offset:2048
    ds_read_b128 v[168:171], v43 offset:4096
    ds_read_b128 v[172:175], v43 offset:6144
    ds_read_b128 v[176:179], v43 offset:8192
    ds_read_b128 v[180:183], v43 offset:10240
    ds_read_b128 v[184:187], v43 offset:12288
    ds_read_b128 v[188:191], v43 offset:14336
    ds_read_b128 v[192:195], v43 offset:16384
    ds_read_b128 v[196:199], v43 offset:18432
    ds_read_b128 v[200:203], v43 offset:20480
    ds_read_b128 v[204:207], v43 offset:22528
    v_mfma_f32_16x16x32_bf16 v[16:19], v[4:7], v[136:139], v[16:19]
    v_add_u32 v14, 81920, v3
    v_mfma_f32_16x16x32_bf16 v[20:23], v[4:7], v[140:143], v[20:23]
    ds_read_b64_tr_b16 v[56:57], v14 offset:0
    v_mfma_f32_16x16x32_bf16 v[24:27], v[4:7], v[144:147], v[24:27]
    ds_read_b64_tr_b16 v[58:59], v14 offset:2048
    v_mfma_f32_16x16x32_bf16 v[28:31], v[8:11], v[136:139], v[28:31]
    v_add_u32 v15, 81920, v12
    v_mfma_f32_16x16x32_bf16 v[32:35], v[8:11], v[140:143], v[32:35]
    ds_read_b64_tr_b16 v[60:61], v15 offset:0
    v_mfma_f32_16x16x32_bf16 v[36:39], v[8:11], v[144:147], v[36:39]
    ds_read_b64_tr_b16 v[62:63], v15 offset:2048
    v_mfma_f32_16x16x32_bf16 v[16:19], v[48:51], v[148:151], v[16:19]
    ds_read_b64_tr_b16 v[4:5], v14 offset:4096
    v_mfma_f32_16x16x32_bf16 v[20:23], v[48:51], v[152:155], v[20:23]
    ds_read_b64_tr_b16 v[6:7], v14 offset:6144
    v_mfma_f32_16x16x32_bf16 v[24:27], v[48:51], v[156:159], v[24:27]
    ds_read_b64_tr_b16 v[8:9], v15 offset:4096
    v_mfma_f32_16x16x32_bf16 v[28:31], v[52:55], v[148:151], v[28:31]
    ds_read_b64_tr_b16 v[10:11], v15 offset:6144
    v_mfma_f32_16x16x32_bf16 v[32:35], v[52:55], v[152:155], v[32:35]
    s_add_u32 m0, s17, 65536
    s_add_u32 s18, s32, 98304
    buffer_load_dwordx4 v1, s[12:15], s18 offen nt lds
    v_mfma_f32_16x16x32_bf16 v[36:39], v[52:55], v[156:159], v[36:39]
    s_waitcnt lgkmcnt(6)
    v_mfma_f32_16x16x32_bf16 v[16:19], v[56:59], v[160:163], v[16:19]
    v_add_u32 v14, 90112, v3
    v_mfma_f32_16x16x32_bf16 v[20:23], v[56:59], v[164:167], v[20:23]
    ds_read_b64_tr_b16 v[48:49], v14 offset:0
    v_mfma_f32_16x16x32_bf16 v[24:27], v[56:59], v[168:171], v[24:27]
    ds_read_b64_tr_b16 v[50:51], v14 offset:2048
    s_waitcnt lgkmcnt(6)
    v_mfma_f32_16x16x32_bf16 v[28:31], v[60:63], v[160:163], v[28:31]
    v_add_u32 v15, 90112, v12
    v_mfma_f32_16x16x32_bf16 v[32:35], v[60:63], v[164:167], v[32:35]
    ds_read_b64_tr_b16 v[52:53], v15 offset:0
    v_mfma_f32_16x16x32_bf16 v[36:39], v[60:63], v[168:171], v[36:39]
    ds_read_b64_tr_b16 v[54:55], v15 offset:2048
    s_waitcnt lgkmcnt(6)
    v_mfma_f32_16x16x32_bf16 v[16:19], v[4:7], v[172:175], v[16:19]
    ds_read_b64_tr_b16 v[56:57], v14 offset:4096
    v_mfma_f32_16x16x32_bf16 v[20:23], v[4:7], v[176:179], v[20:23]
    ds_read_b64_tr_b16 v[58:59], v14 offset:6144
    v_mfma_f32_16x16x32_bf16 v[24:27], v[4:7], v[180:183], v[24:27]
    ds_read_b64_tr_b16 v[60:61], v15 offset:4096
    s_waitcnt lgkmcnt(7)
    v_mfma_f32_16x16x32_bf16 v[28:31], v[8:11], v[172:175], v[28:31]
    ds_read_b64_tr_b16 v[62:63], v15 offset:6144
    v_mfma_f32_16x16x32_bf16 v[32:35], v[8:11], v[176:179], v[32:35]
    s_add_u32 m0, s17, 69632
    s_add_u32 s18, s32, 114688
    buffer_load_dwordx4 v1, s[12:15], s18 offen nt lds
    v_mfma_f32_16x16x32_bf16 v[36:39], v[8:11], v[180:183], v[36:39]
    s_add_u32 m0, s17, 73728
    s_add_u32 s18, s32, 131072
    buffer_load_dwordx4 v1, s[12:15], s18 offen nt lds
    s_add_u32 m0, s17, 77824
    s_add_u32 s18, s32, 147456
    buffer_load_dwordx4 v1, s[12:15], s18 offen nt lds
    s_waitcnt vmcnt(10) lgkmcnt(0)
    s_barrier
    ds_read_b128 v[208:211], v43 offset:24576
    ds_read_b128 v[212:215], v43 offset:26624
    ds_read_b128 v[216:219], v43 offset:28672
    ds_read_b128 v[220:223], v43 offset:30720
    ds_read_b128 v[224:227], v43 offset:32768
    ds_read_b128 v[228:231], v43 offset:34816
    ds_read_b128 v[232:235], v43 offset:36864
    ds_read_b128 v[236:239], v43 offset:38912
    ds_read_b128 v[240:243], v43 offset:40960
    ds_read_b128 v[244:247], v43 offset:43008
    ds_read_b128 v[248:251], v43 offset:45056
    ds_read_b128 v[252:255], v43 offset:47104
    v_mfma_f32_16x16x32_bf16 v[16:19], v[48:51], v[184:187], v[16:19]
    v_add_u32 v14, 98304, v3
    v_mfma_f32_16x16x32_bf16 v[20:23], v[48:51], v[188:191], v[20:23]
    ds_read_b64_tr_b16 v[4:5], v14 offset:0
    v_mfma_f32_16x16x32_bf16 v[24:27], v[48:51], v[192:195], v[24:27]
    ds_read_b64_tr_b16 v[6:7], v14 offset:2048
    v_mfma_f32_16x16x32_bf16 v[28:31], v[52:55], v[184:187], v[28:31]
    v_add_u32 v15, 98304, v12
    v_mfma_f32_16x16x32_bf16 v[32:35], v[52:55], v[188:191], v[32:35]
    ds_read_b64_tr_b16 v[8:9], v15 offset:0
    v_mfma_f32_16x16x32_bf16 v[36:39], v[52:55], v[192:195], v[36:39]
    ds_read_b64_tr_b16 v[10:11], v15 offset:2048
    v_mfma_f32_16x16x32_bf16 v[16:19], v[56:59], v[196:199], v[16:19]
    ds_read_b64_tr_b16 v[48:49], v14 offset:4096
    v_mfma_f32_16x16x32_bf16 v[20:23], v[56:59], v[200:203], v[20:23]
    ds_read_b64_tr_b16 v[50:51], v14 offset:6144
    v_mfma_f32_16x16x32_bf16 v[24:27], v[56:59], v[204:207], v[24:27]
    ds_read_b64_tr_b16 v[52:53], v15 offset:4096
    v_mfma_f32_16x16x32_bf16 v[28:31], v[60:63], v[196:199], v[28:31]
    ds_read_b64_tr_b16 v[54:55], v15 offset:6144
    v_mfma_f32_16x16x32_bf16 v[32:35], v[60:63], v[200:203], v[32:35]
    s_add_u32 m0, s17, 81920
    s_add_u32 s18, s32, 163840
    buffer_load_dwordx4 v1, s[12:15], s18 offen nt lds
    v_mfma_f32_16x16x32_bf16 v[36:39], v[60:63], v[204:207], v[36:39]
    s_waitcnt lgkmcnt(6)
    v_mfma_f32_16x16x32_bf16 v[16:19], v[4:7], v[208:211], v[16:19]
    v_add_u32 v14, 106496, v3
    v_mfma_f32_16x16x32_bf16 v[20:23], v[4:7], v[212:215], v[20:23]
    ds_read_b64_tr_b16 v[56:57], v14 offset:0
    v_mfma_f32_16x16x32_bf16 v[24:27], v[4:7], v[216:219], v[24:27]
    ds_read_b64_tr_b16 v[58:59], v14 offset:2048
    s_waitcnt lgkmcnt(6)
    v_mfma_f32_16x16x32_bf16 v[28:31], v[8:11], v[208:211], v[28:31]
    v_add_u32 v15, 106496, v12
    v_mfma_f32_16x16x32_bf16 v[32:35], v[8:11], v[212:215], v[32:35]
    ds_read_b64_tr_b16 v[60:61], v15 offset:0
    v_mfma_f32_16x16x32_bf16 v[36:39], v[8:11], v[216:219], v[36:39]
    ds_read_b64_tr_b16 v[62:63], v15 offset:2048
    s_waitcnt lgkmcnt(6)
    v_mfma_f32_16x16x32_bf16 v[16:19], v[48:51], v[220:223], v[16:19]
    ds_read_b64_tr_b16 v[4:5], v14 offset:4096
    v_mfma_f32_16x16x32_bf16 v[20:23], v[48:51], v[224:227], v[20:23]
    ds_read_b64_tr_b16 v[6:7], v14 offset:6144
    v_mfma_f32_16x16x32_bf16 v[24:27], v[48:51], v[228:231], v[24:27]
    ds_read_b64_tr_b16 v[8:9], v15 offset:4096
    s_waitcnt lgkmcnt(7)
    v_mfma_f32_16x16x32_bf16 v[28:31], v[52:55], v[220:223], v[28:31]
    ds_read_b64_tr_b16 v[10:11], v15 offset:6144
    v_mfma_f32_16x16x32_bf16 v[32:35], v[52:55], v[224:227], v[32:35]
    s_add_u32 m0, s17, 86016
    s_add_u32 s18, s32, 180224
    buffer_load_dwordx4 v1, s[12:15], s18 offen nt lds
    v_mfma_f32_16x16x32_bf16 v[36:39], v[52:55], v[228:231], v[36:39]
    s_waitcnt lgkmcnt(6)
    v_mfma_f32_16x16x32_bf16 v[16:19], v[56:59], v[232:235], v[16:19]
    s_add_u32 m0, s17, 90112
    s_add_u32 s18, s32, 196608
    buffer_load_dwordx4 v1, s[12:15], s18 offen nt lds
    v_mfma_f32_16x16x32_bf16 v[20:23], v[56:59], v[236:239], v[20:23]
    s_add_u32 m0, s17, 94208
    s_add_u32 s18, s32, 212992
    buffer_load_dwordx4 v1, s[12:15], s18 offen nt lds
    v_mfma_f32_16x16x32_bf16 v[24:27], v[56:59], v[240:243], v[24:27]
    s_waitcnt lgkmcnt(4)
    v_mfma_f32_16x16x32_bf16 v[28:31], v[60:63], v[232:235], v[28:31]
    v_mfma_f32_16x16x32_bf16 v[32:35], v[60:63], v[236:239], v[32:35]
    v_mfma_f32_16x16x32_bf16 v[36:39], v[60:63], v[240:243], v[36:39]
    s_waitcnt lgkmcnt(2)
    v_mfma_f32_16x16x32_bf16 v[16:19], v[4:7], v[244:247], v[16:19]
    v_mfma_f32_16x16x32_bf16 v[20:23], v[4:7], v[248:251], v[20:23]
    v_mfma_f32_16x16x32_bf16 v[24:27], v[4:7], v[252:255], v[24:27]
    s_waitcnt lgkmcnt(0)
    v_mfma_f32_16x16x32_bf16 v[28:31], v[8:11], v[244:247], v[28:31]
    v_mfma_f32_16x16x32_bf16 v[32:35], v[8:11], v[248:251], v[32:35]
    v_mfma_f32_16x16x32_bf16 v[36:39], v[8:11], v[252:255], v[36:39]
    ds_read_b128 v[4:7], v44 offset:0
    ds_read_b128 v[8:11], v44 offset:16
    s_waitcnt lgkmcnt(0)
    v_pk_add_f32 v[4:5], v[4:5], v[8:9]
    v_pk_add_f32 v[6:7], v[6:7], v[10:11]
    v_pk_add_f32 v[4:5], v[4:5], v[6:7]
    v_add_f32 v40, v4, v5
    ds_read_b128 v[4:7], v44 offset:32
    ds_read_b128 v[8:11], v44 offset:48
    s_waitcnt lgkmcnt(0)
    v_pk_add_f32 v[4:5], v[4:5], v[8:9]
    v_pk_add_f32 v[6:7], v[6:7], v[10:11]
    v_pk_add_f32 v[4:5], v[4:5], v[6:7]
    v_add_f32 v4, v4, v5
    v_add_f32 v40, v40, v4
    v_rcp_f32 v40, v40
    ds_read_b128 v[4:7], v44 offset:2048
    ds_read_b128 v[8:11], v44 offset:2064
    s_waitcnt lgkmcnt(0)
    v_pk_add_f32 v[4:5], v[4:5], v[8:9]
    v_pk_add_f32 v[6:7], v[6:7], v[10:11]
    v_pk_add_f32 v[4:5], v[4:5], v[6:7]
    v_add_f32 v41, v4, v5
    ds_read_b128 v[4:7], v44 offset:2080
    ds_read_b128 v[8:11], v44 offset:2096
    s_waitcnt lgkmcnt(0)
    v_pk_add_f32 v[4:5], v[4:5], v[8:9]
    v_pk_add_f32 v[6:7], v[6:7], v[10:11]
    v_pk_add_f32 v[4:5], v[4:5], v[6:7]
    v_add_f32 v4, v4, v5
    v_add_f32 v41, v41, v4
    v_rcp_f32 v41, v41
    ds_read_b128 v[4:7], v44 offset:4096
    ds_read_b128 v[8:11], v44 offset:4112
    s_waitcnt lgkmcnt(0)
    v_pk_add_f32 v[4:5], v[4:5], v[8:9]
    v_pk_add_f32 v[6:7], v[6:7], v[10:11]
    v_pk_add_f32 v[4:5], v[4:5], v[6:7]
    v_add_f32 v42, v4, v5
    ds_read_b128 v[4:7], v44 offset:4128
    ds_read_b128 v[8:11], v44 offset:4144
    s_waitcnt lgkmcnt(0)
    v_pk_add_f32 v[4:5], v[4:5], v[8:9]
    v_pk_add_f32 v[6:7], v[6:7], v[10:11]
    v_pk_add_f32 v[4:5], v[4:5], v[6:7]
    v_add_f32 v4, v4, v5
    v_add_f32 v42, v42, v4
    v_rcp_f32 v42, v42
    v_mul_f32 v16, v40, v16
    v_mul_f32 v17, v40, v17
    v_mul_f32 v18, v40, v18
    v_mul_f32 v19, v40, v19
    v_cvt_pk_bf16_f32 v4, v16, v17
    v_cvt_pk_bf16_f32 v5, v18, v19
    v_mul_f32 v28, v40, v28
    v_mul_f32 v29, v40, v29
    v_mul_f32 v30, v40, v30
    v_mul_f32 v31, v40, v31
    v_cvt_pk_bf16_f32 v6, v28, v29
    v_cvt_pk_bf16_f32 v7, v30, v31
    ds_write_b128 v13, v[4:7] offset:0
    v_mul_f32 v20, v41, v20
    v_mul_f32 v21, v41, v21
    v_mul_f32 v22, v41, v22
    v_mul_f32 v23, v41, v23
    v_cvt_pk_bf16_f32 v8, v20, v21
    v_cvt_pk_bf16_f32 v9, v22, v23
    v_mul_f32 v32, v41, v32
    v_mul_f32 v33, v41, v33
    v_mul_f32 v34, v41, v34
    v_mul_f32 v35, v41, v35
    v_cvt_pk_bf16_f32 v10, v32, v33
    v_cvt_pk_bf16_f32 v11, v34, v35
    ds_write_b128 v13, v[8:11] offset:2048
    v_mul_f32 v24, v42, v24
    v_mul_f32 v25, v42, v25
    v_mul_f32 v26, v42, v26
    v_mul_f32 v27, v42, v27
    v_cvt_pk_bf16_f32 v4, v24, v25
    v_cvt_pk_bf16_f32 v5, v26, v27
    v_mul_f32 v36, v42, v36
    v_mul_f32 v37, v42, v37
    v_mul_f32 v38, v42, v38
    v_mul_f32 v39, v42, v39
    v_cvt_pk_bf16_f32 v6, v36, v37
    v_cvt_pk_bf16_f32 v7, v38, v39
    ds_write_b128 v13, v[4:7] offset:4096
    s_waitcnt vmcnt(10) lgkmcnt(0)
    s_barrier
    v_add_u32 v14, 114688, v3
    ds_read_b64_tr_b16 v[4:5], v14 offset:0
    ds_read_b64_tr_b16 v[6:7], v14 offset:2048
    v_add_u32 v15, 114688, v12
    ds_read_b64_tr_b16 v[8:9], v15 offset:0
    ds_read_b64_tr_b16 v[10:11], v15 offset:2048
    ds_read_b64_tr_b16 v[48:49], v14 offset:4096
    ds_read_b64_tr_b16 v[50:51], v14 offset:6144
    ds_read_b64_tr_b16 v[52:53], v15 offset:4096
    ds_read_b64_tr_b16 v[54:55], v15 offset:6144
    s_waitcnt lgkmcnt(6)
    v_mfma_f32_16x16x32_bf16 v[16:19], v[4:7], v[64:67], 0
    v_add_u32 v14, 49152, v3
    v_mfma_f32_16x16x32_bf16 v[20:23], v[4:7], v[68:71], 0
    ds_read_b64_tr_b16 v[56:57], v14 offset:0
    v_mfma_f32_16x16x32_bf16 v[24:27], v[4:7], v[72:75], 0
    ds_read_b64_tr_b16 v[58:59], v14 offset:2048
    s_waitcnt lgkmcnt(6)
    v_mfma_f32_16x16x32_bf16 v[28:31], v[8:11], v[64:67], 0
    v_add_u32 v15, 49152, v12
    v_mfma_f32_16x16x32_bf16 v[32:35], v[8:11], v[68:71], 0
    ds_read_b64_tr_b16 v[60:61], v15 offset:0
    v_mfma_f32_16x16x32_bf16 v[36:39], v[8:11], v[72:75], 0
    ds_read_b64_tr_b16 v[62:63], v15 offset:2048
    s_waitcnt lgkmcnt(6)
    v_mfma_f32_16x16x32_bf16 v[16:19], v[48:51], v[76:79], v[16:19]
    ds_read_b64_tr_b16 v[4:5], v14 offset:4096
    v_mfma_f32_16x16x32_bf16 v[20:23], v[48:51], v[80:83], v[20:23]
    ds_read_b64_tr_b16 v[6:7], v14 offset:6144
    v_mfma_f32_16x16x32_bf16 v[24:27], v[48:51], v[84:87], v[24:27]
    ds_read_b64_tr_b16 v[8:9], v15 offset:4096
    s_waitcnt lgkmcnt(7)
    v_mfma_f32_16x16x32_bf16 v[28:31], v[52:55], v[76:79], v[28:31]
    ds_read_b64_tr_b16 v[10:11], v15 offset:6144
    v_mfma_f32_16x16x32_bf16 v[32:35], v[52:55], v[80:83], v[32:35]
    v_mfma_f32_16x16x32_bf16 v[36:39], v[52:55], v[84:87], v[36:39]
    s_waitcnt vmcnt(6) lgkmcnt(0)
    s_barrier
    v_mfma_f32_16x16x32_bf16 v[16:19], v[56:59], v[88:91], v[16:19]
    v_add_u32 v14, 57344, v3
    v_mfma_f32_16x16x32_bf16 v[20:23], v[56:59], v[92:95], v[20:23]
    ds_read_b64_tr_b16 v[48:49], v14 offset:0
    v_mfma_f32_16x16x32_bf16 v[24:27], v[56:59], v[96:99], v[24:27]
    ds_read_b64_tr_b16 v[50:51], v14 offset:2048
    v_mfma_f32_16x16x32_bf16 v[28:31], v[60:63], v[88:91], v[28:31]
    v_add_u32 v15, 57344, v12
    v_mfma_f32_16x16x32_bf16 v[32:35], v[60:63], v[92:95], v[32:35]
    ds_read_b64_tr_b16 v[52:53], v15 offset:0
    v_mfma_f32_16x16x32_bf16 v[36:39], v[60:63], v[96:99], v[36:39]
    ds_read_b64_tr_b16 v[54:55], v15 offset:2048
    v_mfma_f32_16x16x32_bf16 v[16:19], v[4:7], v[100:103], v[16:19]
    ds_read_b64_tr_b16 v[56:57], v14 offset:4096
    v_mfma_f32_16x16x32_bf16 v[20:23], v[4:7], v[104:107], v[20:23]
    ds_read_b64_tr_b16 v[58:59], v14 offset:6144
    v_mfma_f32_16x16x32_bf16 v[24:27], v[4:7], v[108:111], v[24:27]
    ds_read_b64_tr_b16 v[60:61], v15 offset:4096
    v_mfma_f32_16x16x32_bf16 v[28:31], v[8:11], v[100:103], v[28:31]
    ds_read_b64_tr_b16 v[62:63], v15 offset:6144
    v_mfma_f32_16x16x32_bf16 v[32:35], v[8:11], v[104:107], v[32:35]
    s_add_u32 m0, s17, 24576
    s_add_u32 s18, s32, 229376
    buffer_load_dwordx4 v1, s[12:15], s18 offen nt lds
    v_mfma_f32_16x16x32_bf16 v[36:39], v[8:11], v[108:111], v[36:39]
    s_waitcnt lgkmcnt(6)
    v_mfma_f32_16x16x32_bf16 v[16:19], v[48:51], v[112:115], v[16:19]
    v_add_u32 v14, 65536, v3
    v_mfma_f32_16x16x32_bf16 v[20:23], v[48:51], v[116:119], v[20:23]
    ds_read_b64_tr_b16 v[4:5], v14 offset:0
    v_mfma_f32_16x16x32_bf16 v[24:27], v[48:51], v[120:123], v[24:27]
    ds_read_b64_tr_b16 v[6:7], v14 offset:2048
    s_waitcnt lgkmcnt(6)
    v_mfma_f32_16x16x32_bf16 v[28:31], v[52:55], v[112:115], v[28:31]
    v_add_u32 v15, 65536, v12
    v_mfma_f32_16x16x32_bf16 v[32:35], v[52:55], v[116:119], v[32:35]
    ds_read_b64_tr_b16 v[8:9], v15 offset:0
    v_mfma_f32_16x16x32_bf16 v[36:39], v[52:55], v[120:123], v[36:39]
    ds_read_b64_tr_b16 v[10:11], v15 offset:2048
    s_waitcnt lgkmcnt(6)
    v_mfma_f32_16x16x32_bf16 v[16:19], v[56:59], v[124:127], v[16:19]
    ds_read_b64_tr_b16 v[48:49], v14 offset:4096
    v_mfma_f32_16x16x32_bf16 v[20:23], v[56:59], v[128:131], v[20:23]
    ds_read_b64_tr_b16 v[50:51], v14 offset:6144
    v_mfma_f32_16x16x32_bf16 v[24:27], v[56:59], v[132:135], v[24:27]
    ds_read_b64_tr_b16 v[52:53], v15 offset:4096
    s_waitcnt lgkmcnt(7)
    v_mfma_f32_16x16x32_bf16 v[28:31], v[60:63], v[124:127], v[28:31]
    ds_read_b64_tr_b16 v[54:55], v15 offset:6144
    v_mfma_f32_16x16x32_bf16 v[32:35], v[60:63], v[128:131], v[32:35]
    s_add_u32 m0, s17, 28672
    s_add_u32 s18, s32, 245760
    buffer_load_dwordx4 v1, s[12:15], s18 offen nt lds
    s_add_u32 s32, s32, 128
    s_and_b32 s32, s32, 511
    v_mfma_f32_16x16x32_bf16 v[36:39], v[60:63], v[132:135], v[36:39]
    s_add_u32 m0, s17, 32768
    s_add_u32 s18, s32, 0
    buffer_load_dwordx4 v1, s[12:15], s18 offen nt lds
    s_add_u32 m0, s17, 36864
    s_add_u32 s18, s32, 16384
    buffer_load_dwordx4 v1, s[12:15], s18 offen nt lds
    s_waitcnt vmcnt(6) lgkmcnt(0)
    s_barrier
    v_mfma_f32_16x16x32_bf16 v[16:19], v[4:7], v[136:139], v[16:19]
    v_add_u32 v14, 73728, v3
    v_mfma_f32_16x16x32_bf16 v[20:23], v[4:7], v[140:143], v[20:23]
    ds_read_b64_tr_b16 v[56:57], v14 offset:0
    v_mfma_f32_16x16x32_bf16 v[24:27], v[4:7], v[144:147], v[24:27]
    ds_read_b64_tr_b16 v[58:59], v14 offset:2048
    v_mfma_f32_16x16x32_bf16 v[28:31], v[8:11], v[136:139], v[28:31]
    v_add_u32 v15, 73728, v12
    v_mfma_f32_16x16x32_bf16 v[32:35], v[8:11], v[140:143], v[32:35]
    ds_read_b64_tr_b16 v[60:61], v15 offset:0
    v_mfma_f32_16x16x32_bf16 v[36:39], v[8:11], v[144:147], v[36:39]
    ds_read_b64_tr_b16 v[62:63], v15 offset:2048
    v_mfma_f32_16x16x32_bf16 v[16:19], v[48:51], v[148:151], v[16:19]
    ds_read_b64_tr_b16 v[4:5], v14 offset:4096
    v_mfma_f32_16x16x32_bf16 v[20:23], v[48:51], v[152:155], v[20:23]
    ds_read_b64_tr_b16 v[6:7], v14 offset:6144
    v_mfma_f32_16x16x32_bf16 v[24:27], v[48:51], v[156:159], v[24:27]
    ds_read_b64_tr_b16 v[8:9], v15 offset:4096
    v_mfma_f32_16x16x32_bf16 v[28:31], v[52:55], v[148:151], v[28:31]
    ds_read_b64_tr_b16 v[10:11], v15 offset:6144
    v_mfma_f32_16x16x32_bf16 v[32:35], v[52:55], v[152:155], v[32:35]
    s_add_u32 m0, s17, 40960
    s_add_u32 s18, s32, 32768
    buffer_load_dwordx4 v1, s[12:15], s18 offen nt lds
    v_mfma_f32_16x16x32_bf16 v[36:39], v[52:55], v[156:159], v[36:39]
    s_waitcnt lgkmcnt(6)
    v_mfma_f32_16x16x32_bf16 v[16:19], v[56:59], v[160:163], v[16:19]
    v_add_u32 v14, 81920, v3
    v_mfma_f32_16x16x32_bf16 v[20:23], v[56:59], v[164:167], v[20:23]
    ds_read_b64_tr_b16 v[48:49], v14 offset:0
    v_mfma_f32_16x16x32_bf16 v[24:27], v[56:59], v[168:171], v[24:27]
    ds_read_b64_tr_b16 v[50:51], v14 offset:2048
    s_waitcnt lgkmcnt(6)
    v_mfma_f32_16x16x32_bf16 v[28:31], v[60:63], v[160:163], v[28:31]
    v_add_u32 v15, 81920, v12
    v_mfma_f32_16x16x32_bf16 v[32:35], v[60:63], v[164:167], v[32:35]
    ds_read_b64_tr_b16 v[52:53], v15 offset:0
    v_mfma_f32_16x16x32_bf16 v[36:39], v[60:63], v[168:171], v[36:39]
    ds_read_b64_tr_b16 v[54:55], v15 offset:2048
    s_waitcnt lgkmcnt(6)
    v_mfma_f32_16x16x32_bf16 v[16:19], v[4:7], v[172:175], v[16:19]
    ds_read_b64_tr_b16 v[56:57], v14 offset:4096
    v_mfma_f32_16x16x32_bf16 v[20:23], v[4:7], v[176:179], v[20:23]
    ds_read_b64_tr_b16 v[58:59], v14 offset:6144
    v_mfma_f32_16x16x32_bf16 v[24:27], v[4:7], v[180:183], v[24:27]
    ds_read_b64_tr_b16 v[60:61], v15 offset:4096
    s_waitcnt lgkmcnt(7)
    v_mfma_f32_16x16x32_bf16 v[28:31], v[8:11], v[172:175], v[28:31]
    ds_read_b64_tr_b16 v[62:63], v15 offset:6144
    v_mfma_f32_16x16x32_bf16 v[32:35], v[8:11], v[176:179], v[32:35]
    s_add_u32 m0, s17, 45056
    s_add_u32 s18, s32, 49152
    buffer_load_dwordx4 v1, s[12:15], s18 offen nt lds
    v_mfma_f32_16x16x32_bf16 v[36:39], v[8:11], v[180:183], v[36:39]
    s_add_u32 m0, s17, 49152
    s_add_u32 s18, s32, 65536
    buffer_load_dwordx4 v1, s[12:15], s18 offen nt lds
    s_add_u32 m0, s17, 53248
    s_add_u32 s18, s32, 81920
    buffer_load_dwordx4 v1, s[12:15], s18 offen nt lds
    s_waitcnt vmcnt(6) lgkmcnt(0)
    s_barrier
    v_mfma_f32_16x16x32_bf16 v[16:19], v[48:51], v[184:187], v[16:19]
    v_add_u32 v14, 90112, v3
    v_mfma_f32_16x16x32_bf16 v[20:23], v[48:51], v[188:191], v[20:23]
    ds_read_b64_tr_b16 v[4:5], v14 offset:0
    v_mfma_f32_16x16x32_bf16 v[24:27], v[48:51], v[192:195], v[24:27]
    ds_read_b64_tr_b16 v[6:7], v14 offset:2048
    v_mfma_f32_16x16x32_bf16 v[28:31], v[52:55], v[184:187], v[28:31]
    v_add_u32 v15, 90112, v12
    v_mfma_f32_16x16x32_bf16 v[32:35], v[52:55], v[188:191], v[32:35]
    ds_read_b64_tr_b16 v[8:9], v15 offset:0
    v_mfma_f32_16x16x32_bf16 v[36:39], v[52:55], v[192:195], v[36:39]
    ds_read_b64_tr_b16 v[10:11], v15 offset:2048
    v_mfma_f32_16x16x32_bf16 v[16:19], v[56:59], v[196:199], v[16:19]
    ds_read_b64_tr_b16 v[48:49], v14 offset:4096
    v_mfma_f32_16x16x32_bf16 v[20:23], v[56:59], v[200:203], v[20:23]
    ds_read_b64_tr_b16 v[50:51], v14 offset:6144
    v_mfma_f32_16x16x32_bf16 v[24:27], v[56:59], v[204:207], v[24:27]
    ds_read_b64_tr_b16 v[52:53], v15 offset:4096
    v_mfma_f32_16x16x32_bf16 v[28:31], v[60:63], v[196:199], v[28:31]
    ds_read_b64_tr_b16 v[54:55], v15 offset:6144
    v_mfma_f32_16x16x32_bf16 v[32:35], v[60:63], v[200:203], v[32:35]
    s_add_u32 m0, s17, 57344
    s_add_u32 s18, s32, 98304
    buffer_load_dwordx4 v1, s[12:15], s18 offen nt lds
    v_mfma_f32_16x16x32_bf16 v[36:39], v[60:63], v[204:207], v[36:39]
    s_waitcnt lgkmcnt(6)
    v_mfma_f32_16x16x32_bf16 v[16:19], v[4:7], v[208:211], v[16:19]
    v_add_u32 v14, 24576, v3
    v_mfma_f32_16x16x32_bf16 v[20:23], v[4:7], v[212:215], v[20:23]
    ds_read_b64_tr_b16 v[56:57], v14 offset:0
    v_mfma_f32_16x16x32_bf16 v[24:27], v[4:7], v[216:219], v[24:27]
    ds_read_b64_tr_b16 v[58:59], v14 offset:2048
    s_waitcnt lgkmcnt(6)
    v_mfma_f32_16x16x32_bf16 v[28:31], v[8:11], v[208:211], v[28:31]
    v_add_u32 v15, 24576, v12
    v_mfma_f32_16x16x32_bf16 v[32:35], v[8:11], v[212:215], v[32:35]
    ds_read_b64_tr_b16 v[60:61], v15 offset:0
    v_mfma_f32_16x16x32_bf16 v[36:39], v[8:11], v[216:219], v[36:39]
    ds_read_b64_tr_b16 v[62:63], v15 offset:2048
    s_waitcnt lgkmcnt(6)
    v_mfma_f32_16x16x32_bf16 v[16:19], v[48:51], v[220:223], v[16:19]
    ds_read_b64_tr_b16 v[4:5], v14 offset:4096
    v_mfma_f32_16x16x32_bf16 v[20:23], v[48:51], v[224:227], v[20:23]
    ds_read_b64_tr_b16 v[6:7], v14 offset:6144
    v_mfma_f32_16x16x32_bf16 v[24:27], v[48:51], v[228:231], v[24:27]
    ds_read_b64_tr_b16 v[8:9], v15 offset:4096
    s_waitcnt lgkmcnt(7)
    v_mfma_f32_16x16x32_bf16 v[28:31], v[52:55], v[220:223], v[28:31]
    ds_read_b64_tr_b16 v[10:11], v15 offset:6144
    v_mfma_f32_16x16x32_bf16 v[32:35], v[52:55], v[224:227], v[32:35]
    s_add_u32 m0, s17, 61440
    s_add_u32 s18, s32, 114688
    buffer_load_dwordx4 v1, s[12:15], s18 offen nt lds
    v_mfma_f32_16x16x32_bf16 v[36:39], v[52:55], v[228:231], v[36:39]
    s_add_u32 m0, s17, 65536
    s_add_u32 s18, s32, 131072
    buffer_load_dwordx4 v1, s[12:15], s18 offen nt lds
    s_add_u32 m0, s17, 69632
    s_add_u32 s18, s32, 147456
    buffer_load_dwordx4 v1, s[12:15], s18 offen nt lds
    s_waitcnt vmcnt(6) lgkmcnt(0)
    s_barrier
    v_mfma_f32_16x16x32_bf16 v[16:19], v[56:59], v[232:235], v[16:19]
    v_add_u32 v14, 32768, v3
    v_mfma_f32_16x16x32_bf16 v[20:23], v[56:59], v[236:239], v[20:23]
    ds_read_b64_tr_b16 v[48:49], v14 offset:0
    v_mfma_f32_16x16x32_bf16 v[24:27], v[56:59], v[240:243], v[24:27]
    ds_read_b64_tr_b16 v[50:51], v14 offset:2048
    v_mfma_f32_16x16x32_bf16 v[28:31], v[60:63], v[232:235], v[28:31]
    v_add_u32 v15, 32768, v12
    v_mfma_f32_16x16x32_bf16 v[32:35], v[60:63], v[236:239], v[32:35]
    ds_read_b64_tr_b16 v[52:53], v15 offset:0
    v_mfma_f32_16x16x32_bf16 v[36:39], v[60:63], v[240:243], v[36:39]
    ds_read_b64_tr_b16 v[54:55], v15 offset:2048
    v_mfma_f32_16x16x32_bf16 v[16:19], v[4:7], v[244:247], v[16:19]
    ds_read_b64_tr_b16 v[56:57], v14 offset:4096
    v_mfma_f32_16x16x32_bf16 v[20:23], v[4:7], v[248:251], v[20:23]
    ds_read_b64_tr_b16 v[58:59], v14 offset:6144
    v_mfma_f32_16x16x32_bf16 v[24:27], v[4:7], v[252:255], v[24:27]
    ds_read_b64_tr_b16 v[60:61], v15 offset:4096
    v_mfma_f32_16x16x32_bf16 v[28:31], v[8:11], v[244:247], v[28:31]
    ds_read_b64_tr_b16 v[62:63], v15 offset:6144
    v_mfma_f32_16x16x32_bf16 v[32:35], v[8:11], v[248:251], v[32:35]
    s_add_u32 m0, s17, 24576
    s_add_u32 s18, s32, 163840
    buffer_load_dwordx4 v1, s[12:15], s18 offen nt lds
    v_mfma_f32_16x16x32_bf16 v[36:39], v[8:11], v[252:255], v[36:39]
    v_mul_f32 v16, v40, v16
    v_mul_f32 v17, v40, v17
    v_mul_f32 v18, v40, v18
    v_mul_f32 v19, v40, v19
    v_cvt_pk_bf16_f32 v4, v16, v17
    v_cvt_pk_bf16_f32 v5, v18, v19
    v_mul_f32 v28, v40, v28
    v_mul_f32 v29, v40, v29
    v_mul_f32 v30, v40, v30
    v_mul_f32 v31, v40, v31
    v_cvt_pk_bf16_f32 v6, v28, v29
    v_cvt_pk_bf16_f32 v7, v30, v31
    ds_write_b128 v13, v[4:7] offset:12288
    v_mul_f32 v20, v41, v20
    v_mul_f32 v21, v41, v21
    v_mul_f32 v22, v41, v22
    v_mul_f32 v23, v41, v23
    v_cvt_pk_bf16_f32 v8, v20, v21
    v_cvt_pk_bf16_f32 v9, v22, v23
    v_mul_f32 v32, v41, v32
    v_mul_f32 v33, v41, v33
    v_mul_f32 v34, v41, v34
    v_mul_f32 v35, v41, v35
    v_cvt_pk_bf16_f32 v10, v32, v33
    v_cvt_pk_bf16_f32 v11, v34, v35
    ds_write_b128 v13, v[8:11] offset:14336
    v_mul_f32 v24, v42, v24
    v_mul_f32 v25, v42, v25
    v_mul_f32 v26, v42, v26
    v_mul_f32 v27, v42, v27
    v_cvt_pk_bf16_f32 v4, v24, v25
    v_cvt_pk_bf16_f32 v5, v26, v27
    v_mul_f32 v36, v42, v36
    v_mul_f32 v37, v42, v37
    v_mul_f32 v38, v42, v38
    v_mul_f32 v39, v42, v39
    v_cvt_pk_bf16_f32 v6, v36, v37
    v_cvt_pk_bf16_f32 v7, v38, v39
    ds_write_b128 v13, v[4:7] offset:16384
    s_waitcnt lgkmcnt(9)
    v_mfma_f32_16x16x32_bf16 v[16:19], v[48:51], v[64:67], 0
    v_add_u32 v14, 40960, v3
    v_mfma_f32_16x16x32_bf16 v[20:23], v[48:51], v[68:71], 0
    ds_read_b64_tr_b16 v[4:5], v14 offset:0
    v_mfma_f32_16x16x32_bf16 v[24:27], v[48:51], v[72:75], 0
    ds_read_b64_tr_b16 v[6:7], v14 offset:2048
    s_waitcnt lgkmcnt(9)
    v_mfma_f32_16x16x32_bf16 v[28:31], v[52:55], v[64:67], 0
    v_add_u32 v15, 40960, v12
    v_mfma_f32_16x16x32_bf16 v[32:35], v[52:55], v[68:71], 0
    ds_read_b64_tr_b16 v[8:9], v15 offset:0
    v_mfma_f32_16x16x32_bf16 v[36:39], v[52:55], v[72:75], 0
    ds_read_b64_tr_b16 v[10:11], v15 offset:2048
    s_waitcnt lgkmcnt(9)
    v_mfma_f32_16x16x32_bf16 v[16:19], v[56:59], v[76:79], v[16:19]
    ds_read_b64_tr_b16 v[48:49], v14 offset:4096
    v_mfma_f32_16x16x32_bf16 v[20:23], v[56:59], v[80:83], v[20:23]
    ds_read_b64_tr_b16 v[50:51], v14 offset:6144
    v_mfma_f32_16x16x32_bf16 v[24:27], v[56:59], v[84:87], v[24:27]
    ds_read_b64_tr_b16 v[52:53], v15 offset:4096
    s_waitcnt lgkmcnt(10)
    v_mfma_f32_16x16x32_bf16 v[28:31], v[60:63], v[76:79], v[28:31]
    ds_read_b64_tr_b16 v[54:55], v15 offset:6144
    v_mfma_f32_16x16x32_bf16 v[32:35], v[60:63], v[80:83], v[32:35]
    s_add_u32 m0, s17, 28672
    s_add_u32 s18, s32, 180224
    buffer_load_dwordx4 v1, s[12:15], s18 offen nt lds
    v_mfma_f32_16x16x32_bf16 v[36:39], v[60:63], v[84:87], v[36:39]
    s_add_u32 m0, s17, 73728
    s_add_u32 s18, s32, 196608
    buffer_load_dwordx4 v1, s[12:15], s18 offen nt lds
    s_add_u32 m0, s17, 77824
    s_add_u32 s18, s32, 212992
    buffer_load_dwordx4 v1, s[12:15], s18 offen nt lds
    s_waitcnt vmcnt(6) lgkmcnt(0)
    s_barrier
    v_mfma_f32_16x16x32_bf16 v[16:19], v[4:7], v[88:91], v[16:19]
    v_add_u32 v14, 49152, v3
    v_mfma_f32_16x16x32_bf16 v[20:23], v[4:7], v[92:95], v[20:23]
    ds_read_b64_tr_b16 v[56:57], v14 offset:0
    v_mfma_f32_16x16x32_bf16 v[24:27], v[4:7], v[96:99], v[24:27]
    ds_read_b64_tr_b16 v[58:59], v14 offset:2048
    v_mfma_f32_16x16x32_bf16 v[28:31], v[8:11], v[88:91], v[28:31]
    v_add_u32 v15, 49152, v12
    v_mfma_f32_16x16x32_bf16 v[32:35], v[8:11], v[92:95], v[32:35]
    ds_read_b64_tr_b16 v[60:61], v15 offset:0
    v_mfma_f32_16x16x32_bf16 v[36:39], v[8:11], v[96:99], v[36:39]
    ds_read_b64_tr_b16 v[62:63], v15 offset:2048
    v_mfma_f32_16x16x32_bf16 v[16:19], v[48:51], v[100:103], v[16:19]
    ds_read_b64_tr_b16 v[4:5], v14 offset:4096
    v_mfma_f32_16x16x32_bf16 v[20:23], v[48:51], v[104:107], v[20:23]
    ds_read_b64_tr_b16 v[6:7], v14 offset:6144
    v_mfma_f32_16x16x32_bf16 v[24:27], v[48:51], v[108:111], v[24:27]
    ds_read_b64_tr_b16 v[8:9], v15 offset:4096
    v_mfma_f32_16x16x32_bf16 v[28:31], v[52:55], v[100:103], v[28:31]
    ds_read_b64_tr_b16 v[10:11], v15 offset:6144
    v_mfma_f32_16x16x32_bf16 v[32:35], v[52:55], v[104:107], v[32:35]
    s_add_u32 m0, s17, 32768
    s_add_u32 s18, s32, 229376
    buffer_load_dwordx4 v1, s[12:15], s18 offen nt lds
    v_mfma_f32_16x16x32_bf16 v[36:39], v[52:55], v[108:111], v[36:39]
    s_waitcnt lgkmcnt(6)
    v_mfma_f32_16x16x32_bf16 v[16:19], v[56:59], v[112:115], v[16:19]
    v_add_u32 v14, 57344, v3
    v_mfma_f32_16x16x32_bf16 v[20:23], v[56:59], v[116:119], v[20:23]
    ds_read_b64_tr_b16 v[48:49], v14 offset:0
    v_mfma_f32_16x16x32_bf16 v[24:27], v[56:59], v[120:123], v[24:27]
    ds_read_b64_tr_b16 v[50:51], v14 offset:2048
    s_waitcnt lgkmcnt(6)
    v_mfma_f32_16x16x32_bf16 v[28:31], v[60:63], v[112:115], v[28:31]
    v_add_u32 v15, 57344, v12
    v_mfma_f32_16x16x32_bf16 v[32:35], v[60:63], v[116:119], v[32:35]
    ds_read_b64_tr_b16 v[52:53], v15 offset:0
    v_mfma_f32_16x16x32_bf16 v[36:39], v[60:63], v[120:123], v[36:39]
    ds_read_b64_tr_b16 v[54:55], v15 offset:2048
    s_waitcnt lgkmcnt(6)
    v_mfma_f32_16x16x32_bf16 v[16:19], v[4:7], v[124:127], v[16:19]
    ds_read_b64_tr_b16 v[56:57], v14 offset:4096
    v_mfma_f32_16x16x32_bf16 v[20:23], v[4:7], v[128:131], v[20:23]
    ds_read_b64_tr_b16 v[58:59], v14 offset:6144
    v_mfma_f32_16x16x32_bf16 v[24:27], v[4:7], v[132:135], v[24:27]
    ds_read_b64_tr_b16 v[60:61], v15 offset:4096
    s_waitcnt lgkmcnt(7)
    v_mfma_f32_16x16x32_bf16 v[28:31], v[8:11], v[124:127], v[28:31]
    ds_read_b64_tr_b16 v[62:63], v15 offset:6144
    v_mfma_f32_16x16x32_bf16 v[32:35], v[8:11], v[128:131], v[32:35]
    s_add_u32 m0, s17, 36864
    s_add_u32 s18, s32, 245760
    buffer_load_dwordx4 v1, s[12:15], s18 offen nt lds
    s_add_u32 s32, s32, 128
    s_and_b32 s32, s32, 511
    v_mfma_f32_16x16x32_bf16 v[36:39], v[8:11], v[132:135], v[36:39]
    s_add_u32 m0, s17, 40960
    s_add_u32 s18, s32, 0
    buffer_load_dwordx4 v1, s[12:15], s18 offen nt lds
    s_add_u32 m0, s17, 45056
    s_add_u32 s18, s32, 16384
    buffer_load_dwordx4 v1, s[12:15], s18 offen nt lds
    s_waitcnt vmcnt(6) lgkmcnt(0)
    s_barrier
    v_mfma_f32_16x16x32_bf16 v[16:19], v[48:51], v[136:139], v[16:19]
    v_add_u32 v14, 65536, v3
    v_mfma_f32_16x16x32_bf16 v[20:23], v[48:51], v[140:143], v[20:23]
    ds_read_b64_tr_b16 v[4:5], v14 offset:0
    v_mfma_f32_16x16x32_bf16 v[24:27], v[48:51], v[144:147], v[24:27]
    ds_read_b64_tr_b16 v[6:7], v14 offset:2048
    v_mfma_f32_16x16x32_bf16 v[28:31], v[52:55], v[136:139], v[28:31]
    v_add_u32 v15, 65536, v12
    v_mfma_f32_16x16x32_bf16 v[32:35], v[52:55], v[140:143], v[32:35]
    ds_read_b64_tr_b16 v[8:9], v15 offset:0
    v_mfma_f32_16x16x32_bf16 v[36:39], v[52:55], v[144:147], v[36:39]
    ds_read_b64_tr_b16 v[10:11], v15 offset:2048
    v_mfma_f32_16x16x32_bf16 v[16:19], v[56:59], v[148:151], v[16:19]
    ds_read_b64_tr_b16 v[48:49], v14 offset:4096
    v_mfma_f32_16x16x32_bf16 v[20:23], v[56:59], v[152:155], v[20:23]
    ds_read_b64_tr_b16 v[50:51], v14 offset:6144
    v_mfma_f32_16x16x32_bf16 v[24:27], v[56:59], v[156:159], v[24:27]
    ds_read_b64_tr_b16 v[52:53], v15 offset:4096
    v_mfma_f32_16x16x32_bf16 v[28:31], v[60:63], v[148:151], v[28:31]
    ds_read_b64_tr_b16 v[54:55], v15 offset:6144
    v_mfma_f32_16x16x32_bf16 v[32:35], v[60:63], v[152:155], v[32:35]
    s_add_u32 m0, s17, 49152
    s_add_u32 s18, s32, 32768
    buffer_load_dwordx4 v1, s[12:15], s18 offen nt lds
    v_mfma_f32_16x16x32_bf16 v[36:39], v[60:63], v[156:159], v[36:39]
    s_waitcnt lgkmcnt(6)
    v_mfma_f32_16x16x32_bf16 v[16:19], v[4:7], v[160:163], v[16:19]
    v_add_u32 v14, 24576, v3
    v_mfma_f32_16x16x32_bf16 v[20:23], v[4:7], v[164:167], v[20:23]
    ds_read_b64_tr_b16 v[56:57], v14 offset:0
    v_mfma_f32_16x16x32_bf16 v[24:27], v[4:7], v[168:171], v[24:27]
    ds_read_b64_tr_b16 v[58:59], v14 offset:2048
    s_waitcnt lgkmcnt(6)
    v_mfma_f32_16x16x32_bf16 v[28:31], v[8:11], v[160:163], v[28:31]
    v_add_u32 v15, 24576, v12
    v_mfma_f32_16x16x32_bf16 v[32:35], v[8:11], v[164:167], v[32:35]
    ds_read_b64_tr_b16 v[60:61], v15 offset:0
    v_mfma_f32_16x16x32_bf16 v[36:39], v[8:11], v[168:171], v[36:39]
    ds_read_b64_tr_b16 v[62:63], v15 offset:2048
    s_waitcnt lgkmcnt(6)
    v_mfma_f32_16x16x32_bf16 v[16:19], v[48:51], v[172:175], v[16:19]
    ds_read_b64_tr_b16 v[4:5], v14 offset:4096
    v_mfma_f32_16x16x32_bf16 v[20:23], v[48:51], v[176:179], v[20:23]
    ds_read_b64_tr_b16 v[6:7], v14 offset:6144
    v_mfma_f32_16x16x32_bf16 v[24:27], v[48:51], v[180:183], v[24:27]
    ds_read_b64_tr_b16 v[8:9], v15 offset:4096
    s_waitcnt lgkmcnt(7)
    v_mfma_f32_16x16x32_bf16 v[28:31], v[52:55], v[172:175], v[28:31]
    ds_read_b64_tr_b16 v[10:11], v15 offset:6144
    v_mfma_f32_16x16x32_bf16 v[32:35], v[52:55], v[176:179], v[32:35]
    s_add_u32 m0, s17, 53248
    s_add_u32 s18, s32, 49152
    buffer_load_dwordx4 v1, s[12:15], s18 offen nt lds
    v_mfma_f32_16x16x32_bf16 v[36:39], v[52:55], v[180:183], v[36:39]
    s_add_u32 m0, s17, 57344
    s_add_u32 s18, s32, 65536
    buffer_load_dwordx4 v1, s[12:15], s18 offen nt lds
    s_add_u32 m0, s17, 61440
    s_add_u32 s18, s32, 81920
    buffer_load_dwordx4 v1, s[12:15], s18 offen nt lds
    s_waitcnt vmcnt(6) lgkmcnt(0)
    s_barrier
    v_mfma_f32_16x16x32_bf16 v[16:19], v[56:59], v[184:187], v[16:19]
    v_add_u32 v14, 73728, v3
    v_mfma_f32_16x16x32_bf16 v[20:23], v[56:59], v[188:191], v[20:23]
    ds_read_b64_tr_b16 v[48:49], v14 offset:0
    v_mfma_f32_16x16x32_bf16 v[24:27], v[56:59], v[192:195], v[24:27]
    ds_read_b64_tr_b16 v[50:51], v14 offset:2048
    v_mfma_f32_16x16x32_bf16 v[28:31], v[60:63], v[184:187], v[28:31]
    v_add_u32 v15, 73728, v12
    v_mfma_f32_16x16x32_bf16 v[32:35], v[60:63], v[188:191], v[32:35]
    ds_read_b64_tr_b16 v[52:53], v15 offset:0
    v_mfma_f32_16x16x32_bf16 v[36:39], v[60:63], v[192:195], v[36:39]
    ds_read_b64_tr_b16 v[54:55], v15 offset:2048
    v_mfma_f32_16x16x32_bf16 v[16:19], v[4:7], v[196:199], v[16:19]
    ds_read_b64_tr_b16 v[56:57], v14 offset:4096
    v_mfma_f32_16x16x32_bf16 v[20:23], v[4:7], v[200:203], v[20:23]
    ds_read_b64_tr_b16 v[58:59], v14 offset:6144
    v_mfma_f32_16x16x32_bf16 v[24:27], v[4:7], v[204:207], v[24:27]
    ds_read_b64_tr_b16 v[60:61], v15 offset:4096
    v_mfma_f32_16x16x32_bf16 v[28:31], v[8:11], v[196:199], v[28:31]
    ds_read_b64_tr_b16 v[62:63], v15 offset:6144
    v_mfma_f32_16x16x32_bf16 v[32:35], v[8:11], v[200:203], v[32:35]
    s_add_u32 m0, s17, 24576
    s_add_u32 s18, s32, 98304
    buffer_load_dwordx4 v1, s[12:15], s18 offen nt lds
    v_mfma_f32_16x16x32_bf16 v[36:39], v[8:11], v[204:207], v[36:39]
    s_waitcnt lgkmcnt(6)
    v_mfma_f32_16x16x32_bf16 v[16:19], v[48:51], v[208:211], v[16:19]
    v_add_u32 v14, 32768, v3
    v_mfma_f32_16x16x32_bf16 v[20:23], v[48:51], v[212:215], v[20:23]
    ds_read_b64_tr_b16 v[4:5], v14 offset:0
    v_mfma_f32_16x16x32_bf16 v[24:27], v[48:51], v[216:219], v[24:27]
    ds_read_b64_tr_b16 v[6:7], v14 offset:2048
    s_waitcnt lgkmcnt(6)
    v_mfma_f32_16x16x32_bf16 v[28:31], v[52:55], v[208:211], v[28:31]
    v_add_u32 v15, 32768, v12
    v_mfma_f32_16x16x32_bf16 v[32:35], v[52:55], v[212:215], v[32:35]
    ds_read_b64_tr_b16 v[8:9], v15 offset:0
    v_mfma_f32_16x16x32_bf16 v[36:39], v[52:55], v[216:219], v[36:39]
    ds_read_b64_tr_b16 v[10:11], v15 offset:2048
    s_waitcnt lgkmcnt(6)
    v_mfma_f32_16x16x32_bf16 v[16:19], v[56:59], v[220:223], v[16:19]
    ds_read_b64_tr_b16 v[48:49], v14 offset:4096
    v_mfma_f32_16x16x32_bf16 v[20:23], v[56:59], v[224:227], v[20:23]
    ds_read_b64_tr_b16 v[50:51], v14 offset:6144
    v_mfma_f32_16x16x32_bf16 v[24:27], v[56:59], v[228:231], v[24:27]
    ds_read_b64_tr_b16 v[52:53], v15 offset:4096
    s_waitcnt lgkmcnt(7)
    v_mfma_f32_16x16x32_bf16 v[28:31], v[60:63], v[220:223], v[28:31]
    ds_read_b64_tr_b16 v[54:55], v15 offset:6144
    v_mfma_f32_16x16x32_bf16 v[32:35], v[60:63], v[224:227], v[32:35]
    s_add_u32 m0, s17, 28672
    s_add_u32 s18, s32, 114688
    buffer_load_dwordx4 v1, s[12:15], s18 offen nt lds
    v_mfma_f32_16x16x32_bf16 v[36:39], v[60:63], v[228:231], v[36:39]
    s_add_u32 m0, s17, 65536
    s_add_u32 s18, s32, 131072
    buffer_load_dwordx4 v1, s[12:15], s18 offen nt lds
    s_add_u32 m0, s17, 69632
    s_add_u32 s18, s32, 147456
    buffer_load_dwordx4 v1, s[12:15], s18 offen nt lds
    s_waitcnt vmcnt(6) lgkmcnt(0)
    s_barrier
    v_mfma_f32_16x16x32_bf16 v[16:19], v[4:7], v[232:235], v[16:19]
    v_add_u32 v14, 40960, v3
    v_mfma_f32_16x16x32_bf16 v[20:23], v[4:7], v[236:239], v[20:23]
    ds_read_b64_tr_b16 v[56:57], v14 offset:0
    v_mfma_f32_16x16x32_bf16 v[24:27], v[4:7], v[240:243], v[24:27]
    ds_read_b64_tr_b16 v[58:59], v14 offset:2048
    v_mfma_f32_16x16x32_bf16 v[28:31], v[8:11], v[232:235], v[28:31]
    v_add_u32 v15, 40960, v12
    v_mfma_f32_16x16x32_bf16 v[32:35], v[8:11], v[236:239], v[32:35]
    ds_read_b64_tr_b16 v[60:61], v15 offset:0
    v_mfma_f32_16x16x32_bf16 v[36:39], v[8:11], v[240:243], v[36:39]
    ds_read_b64_tr_b16 v[62:63], v15 offset:2048
    v_mfma_f32_16x16x32_bf16 v[16:19], v[48:51], v[244:247], v[16:19]
    ds_read_b64_tr_b16 v[4:5], v14 offset:4096
    v_mfma_f32_16x16x32_bf16 v[20:23], v[48:51], v[248:251], v[20:23]
    ds_read_b64_tr_b16 v[6:7], v14 offset:6144
    v_mfma_f32_16x16x32_bf16 v[24:27], v[48:51], v[252:255], v[24:27]
    ds_read_b64_tr_b16 v[8:9], v15 offset:4096
    v_mfma_f32_16x16x32_bf16 v[28:31], v[52:55], v[244:247], v[28:31]
    ds_read_b64_tr_b16 v[10:11], v15 offset:6144
    v_mfma_f32_16x16x32_bf16 v[32:35], v[52:55], v[248:251], v[32:35]
    s_add_u32 m0, s17, 32768
    s_add_u32 s18, s32, 163840
    buffer_load_dwordx4 v1, s[12:15], s18 offen nt lds
    v_mfma_f32_16x16x32_bf16 v[36:39], v[52:55], v[252:255], v[36:39]
    v_mul_f32 v16, v40, v16
    v_mul_f32 v17, v40, v17
    v_mul_f32 v18, v40, v18
    v_mul_f32 v19, v40, v19
    v_cvt_pk_bf16_f32 v48, v16, v17
    v_cvt_pk_bf16_f32 v49, v18, v19
    v_mul_f32 v28, v40, v28
    v_mul_f32 v29, v40, v29
    v_mul_f32 v30, v40, v30
    v_mul_f32 v31, v40, v31
    v_cvt_pk_bf16_f32 v50, v28, v29
    v_cvt_pk_bf16_f32 v51, v30, v31
    ds_write_b128 v13, v[48:51] offset:0
    v_mul_f32 v20, v41, v20
    v_mul_f32 v21, v41, v21
    v_mul_f32 v22, v41, v22
    v_mul_f32 v23, v41, v23
    v_cvt_pk_bf16_f32 v52, v20, v21
    v_cvt_pk_bf16_f32 v53, v22, v23
    v_mul_f32 v32, v41, v32
    v_mul_f32 v33, v41, v33
    v_mul_f32 v34, v41, v34
    v_mul_f32 v35, v41, v35
    v_cvt_pk_bf16_f32 v54, v32, v33
    v_cvt_pk_bf16_f32 v55, v34, v35
    ds_write_b128 v13, v[52:55] offset:2048
    v_mul_f32 v24, v42, v24
    v_mul_f32 v25, v42, v25
    v_mul_f32 v26, v42, v26
    v_mul_f32 v27, v42, v27
    v_cvt_pk_bf16_f32 v48, v24, v25
    v_cvt_pk_bf16_f32 v49, v26, v27
    v_mul_f32 v36, v42, v36
    v_mul_f32 v37, v42, v37
    v_mul_f32 v38, v42, v38
    v_mul_f32 v39, v42, v39
    v_cvt_pk_bf16_f32 v50, v36, v37
    v_cvt_pk_bf16_f32 v51, v38, v39
    ds_write_b128 v13, v[48:51] offset:4096
    s_waitcnt lgkmcnt(9)
    v_mfma_f32_16x16x32_bf16 v[16:19], v[56:59], v[64:67], 0
    v_add_u32 v14, 49152, v3
    v_mfma_f32_16x16x32_bf16 v[20:23], v[56:59], v[68:71], 0
    ds_read_b64_tr_b16 v[48:49], v14 offset:0
    v_mfma_f32_16x16x32_bf16 v[24:27], v[56:59], v[72:75], 0
    ds_read_b64_tr_b16 v[50:51], v14 offset:2048
    s_waitcnt lgkmcnt(9)
    v_mfma_f32_16x16x32_bf16 v[28:31], v[60:63], v[64:67], 0
    v_add_u32 v15, 49152, v12
    v_mfma_f32_16x16x32_bf16 v[32:35], v[60:63], v[68:71], 0
    ds_read_b64_tr_b16 v[52:53], v15 offset:0
    v_mfma_f32_16x16x32_bf16 v[36:39], v[60:63], v[72:75], 0
    ds_read_b64_tr_b16 v[54:55], v15 offset:2048
    s_waitcnt lgkmcnt(9)
    v_mfma_f32_16x16x32_bf16 v[16:19], v[4:7], v[76:79], v[16:19]
    ds_read_b64_tr_b16 v[56:57], v14 offset:4096
    v_mfma_f32_16x16x32_bf16 v[20:23], v[4:7], v[80:83], v[20:23]
    ds_read_b64_tr_b16 v[58:59], v14 offset:6144
    v_mfma_f32_16x16x32_bf16 v[24:27], v[4:7], v[84:87], v[24:27]
    ds_read_b64_tr_b16 v[60:61], v15 offset:4096
    s_waitcnt lgkmcnt(10)
    v_mfma_f32_16x16x32_bf16 v[28:31], v[8:11], v[76:79], v[28:31]
    ds_read_b64_tr_b16 v[62:63], v15 offset:6144
    v_mfma_f32_16x16x32_bf16 v[32:35], v[8:11], v[80:83], v[32:35]
    s_add_u32 m0, s17, 36864
    s_add_u32 s18, s32, 180224
    buffer_load_dwordx4 v1, s[12:15], s18 offen nt lds
    v_mfma_f32_16x16x32_bf16 v[36:39], v[8:11], v[84:87], v[36:39]
    s_add_u32 m0, s17, 73728
    s_add_u32 s18, s32, 196608
    buffer_load_dwordx4 v1, s[12:15], s18 offen nt lds
    s_add_u32 m0, s17, 77824
    s_add_u32 s18, s32, 212992
    buffer_load_dwordx4 v1, s[12:15], s18 offen nt lds
    s_waitcnt vmcnt(6) lgkmcnt(0)
    s_barrier
    v_mfma_f32_16x16x32_bf16 v[16:19], v[48:51], v[88:91], v[16:19]
    v_add_u32 v14, 57344, v3
    v_mfma_f32_16x16x32_bf16 v[20:23], v[48:51], v[92:95], v[20:23]
    ds_read_b64_tr_b16 v[4:5], v14 offset:0
    v_mfma_f32_16x16x32_bf16 v[24:27], v[48:51], v[96:99], v[24:27]
    ds_read_b64_tr_b16 v[6:7], v14 offset:2048
    v_mfma_f32_16x16x32_bf16 v[28:31], v[52:55], v[88:91], v[28:31]
    v_add_u32 v15, 57344, v12
    v_mfma_f32_16x16x32_bf16 v[32:35], v[52:55], v[92:95], v[32:35]
    ds_read_b64_tr_b16 v[8:9], v15 offset:0
    v_mfma_f32_16x16x32_bf16 v[36:39], v[52:55], v[96:99], v[36:39]
    ds_read_b64_tr_b16 v[10:11], v15 offset:2048
    v_mfma_f32_16x16x32_bf16 v[16:19], v[56:59], v[100:103], v[16:19]
    ds_read_b64_tr_b16 v[48:49], v14 offset:4096
    v_mfma_f32_16x16x32_bf16 v[20:23], v[56:59], v[104:107], v[20:23]
    ds_read_b64_tr_b16 v[50:51], v14 offset:6144
    v_mfma_f32_16x16x32_bf16 v[24:27], v[56:59], v[108:111], v[24:27]
    ds_read_b64_tr_b16 v[52:53], v15 offset:4096
    v_mfma_f32_16x16x32_bf16 v[28:31], v[60:63], v[100:103], v[28:31]
    ds_read_b64_tr_b16 v[54:55], v15 offset:6144
    v_mfma_f32_16x16x32_bf16 v[32:35], v[60:63], v[104:107], v[32:35]
    s_add_u32 m0, s17, 40960
    s_add_u32 s18, s32, 229376
    buffer_load_dwordx4 v1, s[12:15], s18 offen nt lds
    v_mfma_f32_16x16x32_bf16 v[36:39], v[60:63], v[108:111], v[36:39]
    s_waitcnt lgkmcnt(6)
    v_mfma_f32_16x16x32_bf16 v[16:19], v[4:7], v[112:115], v[16:19]
    v_add_u32 v14, 24576, v3
    v_mfma_f32_16x16x32_bf16 v[20:23], v[4:7], v[116:119], v[20:23]
    ds_read_b64_tr_b16 v[56:57], v14 offset:0
    v_mfma_f32_16x16x32_bf16 v[24:27], v[4:7], v[120:123], v[24:27]
    ds_read_b64_tr_b16 v[58:59], v14 offset:2048
    s_waitcnt lgkmcnt(6)
    v_mfma_f32_16x16x32_bf16 v[28:31], v[8:11], v[112:115], v[28:31]
    v_add_u32 v15, 24576, v12
    v_mfma_f32_16x16x32_bf16 v[32:35], v[8:11], v[116:119], v[32:35]
    ds_read_b64_tr_b16 v[60:61], v15 offset:0
    v_mfma_f32_16x16x32_bf16 v[36:39], v[8:11], v[120:123], v[36:39]
    ds_read_b64_tr_b16 v[62:63], v15 offset:2048
    s_waitcnt lgkmcnt(6)
    v_mfma_f32_16x16x32_bf16 v[16:19], v[48:51], v[124:127], v[16:19]
    ds_read_b64_tr_b16 v[4:5], v14 offset:4096
    v_mfma_f32_16x16x32_bf16 v[20:23], v[48:51], v[128:131], v[20:23]
    ds_read_b64_tr_b16 v[6:7], v14 offset:6144
    v_mfma_f32_16x16x32_bf16 v[24:27], v[48:51], v[132:135], v[24:27]
    ds_read_b64_tr_b16 v[8:9], v15 offset:4096
    s_waitcnt lgkmcnt(7)
    v_mfma_f32_16x16x32_bf16 v[28:31], v[52:55], v[124:127], v[28:31]
    ds_read_b64_tr_b16 v[10:11], v15 offset:6144
    v_mfma_f32_16x16x32_bf16 v[32:35], v[52:55], v[128:131], v[32:35]
    s_add_u32 m0, s17, 45056
    s_add_u32 s18, s32, 245760
    buffer_load_dwordx4 v1, s[12:15], s18 offen nt lds
    s_add_u32 s32, s32, 128
    s_and_b32 s32, s32, 511
    v_mfma_f32_16x16x32_bf16 v[36:39], v[52:55], v[132:135], v[36:39]
    s_waitcnt vmcnt(4) lgkmcnt(0)
    s_barrier
    v_mfma_f32_16x16x32_bf16 v[16:19], v[56:59], v[136:139], v[16:19]
    v_add_u32 v14, 65536, v3
    v_mfma_f32_16x16x32_bf16 v[20:23], v[56:59], v[140:143], v[20:23]
    ds_read_b64_tr_b16 v[48:49], v14 offset:0
    v_mfma_f32_16x16x32_bf16 v[24:27], v[56:59], v[144:147], v[24:27]
    ds_read_b64_tr_b16 v[50:51], v14 offset:2048
    v_mfma_f32_16x16x32_bf16 v[28:31], v[60:63], v[136:139], v[28:31]
    v_add_u32 v15, 65536, v12
    v_mfma_f32_16x16x32_bf16 v[32:35], v[60:63], v[140:143], v[32:35]
    ds_read_b64_tr_b16 v[52:53], v15 offset:0
    v_mfma_f32_16x16x32_bf16 v[36:39], v[60:63], v[144:147], v[36:39]
    ds_read_b64_tr_b16 v[54:55], v15 offset:2048
    v_mfma_f32_16x16x32_bf16 v[16:19], v[4:7], v[148:151], v[16:19]
    ds_read_b64_tr_b16 v[56:57], v14 offset:4096
    v_mfma_f32_16x16x32_bf16 v[20:23], v[4:7], v[152:155], v[20:23]
    ds_read_b64_tr_b16 v[58:59], v14 offset:6144
    v_mfma_f32_16x16x32_bf16 v[24:27], v[4:7], v[156:159], v[24:27]
    ds_read_b64_tr_b16 v[60:61], v15 offset:4096
    v_mfma_f32_16x16x32_bf16 v[28:31], v[8:11], v[148:151], v[28:31]
    ds_read_b64_tr_b16 v[62:63], v15 offset:6144
    v_mfma_f32_16x16x32_bf16 v[32:35], v[8:11], v[152:155], v[32:35]
    v_mfma_f32_16x16x32_bf16 v[36:39], v[8:11], v[156:159], v[36:39]
    s_waitcnt lgkmcnt(6)
    v_mfma_f32_16x16x32_bf16 v[16:19], v[48:51], v[160:163], v[16:19]
    v_add_u32 v14, 32768, v3
    v_mfma_f32_16x16x32_bf16 v[20:23], v[48:51], v[164:167], v[20:23]
    ds_read_b64_tr_b16 v[4:5], v14 offset:0
    v_mfma_f32_16x16x32_bf16 v[24:27], v[48:51], v[168:171], v[24:27]
    ds_read_b64_tr_b16 v[6:7], v14 offset:2048
    s_waitcnt lgkmcnt(6)
    v_mfma_f32_16x16x32_bf16 v[28:31], v[52:55], v[160:163], v[28:31]
    v_add_u32 v15, 32768, v12
    v_mfma_f32_16x16x32_bf16 v[32:35], v[52:55], v[164:167], v[32:35]
    ds_read_b64_tr_b16 v[8:9], v15 offset:0
    v_mfma_f32_16x16x32_bf16 v[36:39], v[52:55], v[168:171], v[36:39]
    ds_read_b64_tr_b16 v[10:11], v15 offset:2048
    s_waitcnt lgkmcnt(6)
    v_mfma_f32_16x16x32_bf16 v[16:19], v[56:59], v[172:175], v[16:19]
    ds_read_b64_tr_b16 v[48:49], v14 offset:4096
    v_mfma_f32_16x16x32_bf16 v[20:23], v[56:59], v[176:179], v[20:23]
    ds_read_b64_tr_b16 v[50:51], v14 offset:6144
    v_mfma_f32_16x16x32_bf16 v[24:27], v[56:59], v[180:183], v[24:27]
    ds_read_b64_tr_b16 v[52:53], v15 offset:4096
    s_waitcnt lgkmcnt(7)
    v_mfma_f32_16x16x32_bf16 v[28:31], v[60:63], v[172:175], v[28:31]
    ds_read_b64_tr_b16 v[54:55], v15 offset:6144
    v_mfma_f32_16x16x32_bf16 v[32:35], v[60:63], v[176:179], v[32:35]
    v_mfma_f32_16x16x32_bf16 v[36:39], v[60:63], v[180:183], v[36:39]
    s_waitcnt vmcnt(2) lgkmcnt(0)
    s_barrier
    v_mfma_f32_16x16x32_bf16 v[16:19], v[4:7], v[184:187], v[16:19]
    v_add_u32 v14, 73728, v3
    v_mfma_f32_16x16x32_bf16 v[20:23], v[4:7], v[188:191], v[20:23]
    ds_read_b64_tr_b16 v[56:57], v14 offset:0
    v_mfma_f32_16x16x32_bf16 v[24:27], v[4:7], v[192:195], v[24:27]
    ds_read_b64_tr_b16 v[58:59], v14 offset:2048
    v_mfma_f32_16x16x32_bf16 v[28:31], v[8:11], v[184:187], v[28:31]
    v_add_u32 v15, 73728, v12
    v_mfma_f32_16x16x32_bf16 v[32:35], v[8:11], v[188:191], v[32:35]
    ds_read_b64_tr_b16 v[60:61], v15 offset:0
    v_mfma_f32_16x16x32_bf16 v[36:39], v[8:11], v[192:195], v[36:39]
    ds_read_b64_tr_b16 v[62:63], v15 offset:2048
    v_mfma_f32_16x16x32_bf16 v[16:19], v[48:51], v[196:199], v[16:19]
    ds_read_b64_tr_b16 v[4:5], v14 offset:4096
    v_mfma_f32_16x16x32_bf16 v[20:23], v[48:51], v[200:203], v[20:23]
    ds_read_b64_tr_b16 v[6:7], v14 offset:6144
    v_mfma_f32_16x16x32_bf16 v[24:27], v[48:51], v[204:207], v[24:27]
    ds_read_b64_tr_b16 v[8:9], v15 offset:4096
    v_mfma_f32_16x16x32_bf16 v[28:31], v[52:55], v[196:199], v[28:31]
    ds_read_b64_tr_b16 v[10:11], v15 offset:6144
    v_mfma_f32_16x16x32_bf16 v[32:35], v[52:55], v[200:203], v[32:35]
    v_mfma_f32_16x16x32_bf16 v[36:39], v[52:55], v[204:207], v[36:39]
    s_waitcnt vmcnt(0) lgkmcnt(0)
    s_barrier
    v_mfma_f32_16x16x32_bf16 v[16:19], v[56:59], v[208:211], v[16:19]
    v_add_u32 v14, 40960, v3
    v_mfma_f32_16x16x32_bf16 v[20:23], v[56:59], v[212:215], v[20:23]
    ds_read_b64_tr_b16 v[48:49], v14 offset:0
    v_mfma_f32_16x16x32_bf16 v[24:27], v[56:59], v[216:219], v[24:27]
    ds_read_b64_tr_b16 v[50:51], v14 offset:2048
    v_mfma_f32_16x16x32_bf16 v[28:31], v[60:63], v[208:211], v[28:31]
    v_add_u32 v15, 40960, v12
    v_mfma_f32_16x16x32_bf16 v[32:35], v[60:63], v[212:215], v[32:35]
    ds_read_b64_tr_b16 v[52:53], v15 offset:0
    v_mfma_f32_16x16x32_bf16 v[36:39], v[60:63], v[216:219], v[36:39]
    ds_read_b64_tr_b16 v[54:55], v15 offset:2048
    v_mfma_f32_16x16x32_bf16 v[16:19], v[4:7], v[220:223], v[16:19]
    ds_read_b64_tr_b16 v[56:57], v14 offset:4096
    v_mfma_f32_16x16x32_bf16 v[20:23], v[4:7], v[224:227], v[20:23]
    ds_read_b64_tr_b16 v[58:59], v14 offset:6144
    v_mfma_f32_16x16x32_bf16 v[24:27], v[4:7], v[228:231], v[24:27]
    ds_read_b64_tr_b16 v[60:61], v15 offset:4096
    v_mfma_f32_16x16x32_bf16 v[28:31], v[8:11], v[220:223], v[28:31]
    ds_read_b64_tr_b16 v[62:63], v15 offset:6144
    v_mfma_f32_16x16x32_bf16 v[32:35], v[8:11], v[224:227], v[32:35]
    v_mfma_f32_16x16x32_bf16 v[36:39], v[8:11], v[228:231], v[36:39]
    s_waitcnt lgkmcnt(6)
    v_mfma_f32_16x16x32_bf16 v[16:19], v[48:51], v[232:235], v[16:19]
    v_mfma_f32_16x16x32_bf16 v[20:23], v[48:51], v[236:239], v[20:23]
    v_mfma_f32_16x16x32_bf16 v[24:27], v[48:51], v[240:243], v[24:27]
    s_waitcnt lgkmcnt(4)
    v_mfma_f32_16x16x32_bf16 v[28:31], v[52:55], v[232:235], v[28:31]
    v_mfma_f32_16x16x32_bf16 v[32:35], v[52:55], v[236:239], v[32:35]
    v_mfma_f32_16x16x32_bf16 v[36:39], v[52:55], v[240:243], v[36:39]
    s_waitcnt lgkmcnt(2)
    v_mfma_f32_16x16x32_bf16 v[16:19], v[56:59], v[244:247], v[16:19]
    v_mfma_f32_16x16x32_bf16 v[20:23], v[56:59], v[248:251], v[20:23]
    v_mfma_f32_16x16x32_bf16 v[24:27], v[56:59], v[252:255], v[24:27]
    s_waitcnt lgkmcnt(0)
    v_mfma_f32_16x16x32_bf16 v[28:31], v[60:63], v[244:247], v[28:31]
    v_mfma_f32_16x16x32_bf16 v[32:35], v[60:63], v[248:251], v[32:35]
    v_mfma_f32_16x16x32_bf16 v[36:39], v[60:63], v[252:255], v[36:39]
    s_nop 1
    v_mul_f32 v16, v40, v16
    v_mul_f32 v17, v40, v17
    v_mul_f32 v18, v40, v18
    v_mul_f32 v19, v40, v19
    v_cvt_pk_bf16_f32 v56, v16, v17
    v_cvt_pk_bf16_f32 v57, v18, v19
    v_mul_f32 v28, v40, v28
    v_mul_f32 v29, v40, v29
    v_mul_f32 v30, v40, v30
    v_mul_f32 v31, v40, v31
    v_cvt_pk_bf16_f32 v58, v28, v29
    v_cvt_pk_bf16_f32 v59, v30, v31
    ds_write_b128 v13, v[56:59] offset:12288
    v_mul_f32 v20, v41, v20
    v_mul_f32 v21, v41, v21
    v_mul_f32 v22, v41, v22
    v_mul_f32 v23, v41, v23
    v_cvt_pk_bf16_f32 v60, v20, v21
    v_cvt_pk_bf16_f32 v61, v22, v23
    v_mul_f32 v32, v41, v32
    v_mul_f32 v33, v41, v33
    v_mul_f32 v34, v41, v34
    v_mul_f32 v35, v41, v35
    v_cvt_pk_bf16_f32 v62, v32, v33
    v_cvt_pk_bf16_f32 v63, v34, v35
    ds_write_b128 v13, v[60:63] offset:14336
    v_mul_f32 v24, v42, v24
    v_mul_f32 v25, v42, v25
    v_mul_f32 v26, v42, v26
    v_mul_f32 v27, v42, v27
    v_cvt_pk_bf16_f32 v56, v24, v25
    v_cvt_pk_bf16_f32 v57, v26, v27
    v_mul_f32 v36, v42, v36
    v_mul_f32 v37, v42, v37
    v_mul_f32 v38, v42, v38
    v_mul_f32 v39, v42, v39
    v_cvt_pk_bf16_f32 v58, v36, v37
    v_cvt_pk_bf16_f32 v59, v38, v39
    ds_write_b128 v13, v[56:59] offset:16384
    s_waitcnt lgkmcnt(0)
    s_barrier
    s_cmp_lg_u32 s16, 0
    s_cbranch_scc1 L_red
    v_mov_b32 v6, 0
    s_mov_b32 s51, 0
L_pc:
    buffer_load_dword v10, v6, s[40:43], s63 offen sc1
    s_waitcnt vmcnt(0)
    v_cmp_le_u32 vcc, 1, v10
    s_add_u32 s51, s51, 1
    s_cmp_eq_u64 vcc, -1
    s_cbranch_scc1 L_pc_ok
    s_cmp_ge_u32 s51, 200000
    s_cbranch_scc1 L_pc_ok
    s_branch L_pc
L_pc_ok:
    s_branch L_red
L_roleB:
    v_bfe_u32 v14, v0, 3, 3
    v_lshrrev_b32 v15, 6, v0
    v_lshl_add_u32 v14, v15, 5, v14
    v_and_b32 v12, 7, v0
    v_bfe_u32 v15, v0, 4, 2
    v_xor_b32 v13, v12, v15
    v_lshlrev_b32 v13, 4, v13
    v_lshl_add_u32 v1, v14, 9, v13
    v_xor_b32 v2, 64, v1
    s_lshl_b32 s29, s27, 7
    s_mul_i32 s30, s27, 57344
    s_lshl_b32 s31, s28, 7
    s_lshl_b32 s32, s25, 12
    s_mul_i32 s33, s28, 12288
    s_mov_b32 s6, 262144
    s_mov_b32 s10, 229376
    s_mov_b32 s14, 86016
    s_mul_i32 s36, s22, 229376
    s_lshl_b32 s37, s21, 7
    s_add_u32 s37, s37, s34
    s_mul_i32 s37, s37, 86016
    s_cmp_eq_u32 s21, 0
    s_waitcnt lgkmcnt(0)
    s_cselect_b64 s[4:5], s[42:43], s[52:53]
    s_cselect_b64 s[8:9], s[48:49], s[58:59]
    s_mov_b64 s[12:13], s[60:61]
    s_add_u32 s4, s4, s35
    s_addc_u32 s5, s5, 0
    s_add_u32 s8, s8, s36
    s_addc_u32 s9, s9, 0
    s_add_u32 s12, s12, s37
    s_addc_u32 s13, s13, 0
    s_setprio 1
    s_add_u32 m0, s32, 90112
    s_add_u32 s18, s29, 0
    buffer_load_dwordx4 v1, s[4:7], s18 offen nt lds
    s_add_u32 m0, s32, 91136
    s_add_u32 s18, s29, 4096
    buffer_load_dwordx4 v2, s[4:7], s18 offen nt lds
    s_add_u32 m0, s32, 92160
    s_add_u32 s18, s29, 8192
    buffer_load_dwordx4 v1, s[4:7], s18 offen nt lds
    s_add_u32 m0, s32, 93184
    s_add_u32 s18, s29, 12288
    buffer_load_dwordx4 v2, s[4:7], s18 offen nt lds
    s_mov_b32 s20, 0x3db8aa3b
    s_getpc_b64 s[92:93]
L_pc0:
    s_sub_u32 s92, s92, L_pc0-concat_heads__mha_block_cached__mha_block_cached__near_ridge_kernel
    s_subb_u32 s93, s93, 0
    s_lshr_b32 s94, s2, 3
    s_cmp_ge_u32 s94, 24
    s_cselect_b32 s95, 24, 0
    s_sub_u32 s94, s94, s95
    s_cmp_ge_u32 s94, 12
    s_cselect_b32 s95, 12, 0
    s_sub_u32 s94, s94, s95
    s_lshl_b32 s94, s94, 12
    v_lshlrev_b32 v62, 4, v0
    v_add_u32 v62, s94, v62
    global_load_dword v63, v62, s[92:93]
    s_load_dwordx4 s[44:47], s[0:1], 80
    s_lshl_b32 s63, s21, 3
    s_add_u32 s63, s63, s23
    s_mul_i32 s19, s63, 8448
    s_add_u32 s19, s19, 33554432
    s_add_u32 s36, s60, s19
    s_addc_u32 s37, s61, 0
    s_mov_b32 s38, 8192
    s_mov_b32 s39, 0x20000
    s_lshl_b32 s63, s63, 4
    s_waitcnt lgkmcnt(0)
    s_mov_b64 s[40:41], s[46:47]
    s_mov_b32 s42, 256
    s_mov_b32 s43, 0x20000
    s_lshl_b32 s19, s22, 13
    v_lshlrev_b32 v62, 12, v0
    v_mov_b32 v61, 0
    buffer_store_dword v61, v62, s[36:39], s19 offen sc1
    v_lshlrev_b32 v15, 1, v15
    v_xor_b32 v15, v15, v12
    v_lshlrev_b32 v15, 4, v15
    v_lshrrev_b32 v3, 3, v0
    v_mul_u32_u24 v3, 896, v3
    v_add_u32 v3, v3, v15
    v_and_b32 v14, 15, v0
    v_bfe_u32 v15, v0, 1, 3
    v_bfe_u32 v12, v0, 4, 2
    v_xor_b32 v15, v15, v12
    v_lshlrev_b32 v15, 4, v15
    v_lshl_add_u32 v8, v14, 7, v15
    v_xor_b32 v9, 64, v8
    s_add_u32 s19, s32, 90112
    v_add_u32 v4, s19, v8
    v_add_u32 v5, s19, v9
    v_lshlrev_b32 v13, 2, v14
    v_add_u32 v13, 155648, v13
    v_lshlrev_b32 v14, 6, v14
    v_lshrrev_b32 v15, 4, v0
    v_lshl_add_u32 v12, v15, 2, v14
    v_add_u32 v12, 157696, v12
    v_and_b32 v14, 63, v0
    s_mul_i32 s19, s25, 6144
    v_lshlrev_b32 v10, 4, v14
    v_add_u32 v10, s19, v10
    s_barrier
    s_barrier
    s_barrier
    s_barrier
    s_add_u32 m0, s32, 106496
    s_add_u32 s18, s29, 65536
    buffer_load_dwordx4 v1, s[4:7], s18 offen nt lds
    s_add_u32 m0, s32, 107520
    s_add_u32 s18, s29, 69632
    buffer_load_dwordx4 v2, s[4:7], s18 offen nt lds
    s_add_u32 m0, s32, 108544
    s_add_u32 s18, s29, 73728
    buffer_load_dwordx4 v1, s[4:7], s18 offen nt lds
    s_add_u32 m0, s32, 109568
    s_add_u32 s18, s29, 77824
    buffer_load_dwordx4 v2, s[4:7], s18 offen nt lds
    s_barrier
    s_barrier
    s_add_u32 m0, s32, 122880
    s_add_u32 s18, s29, 131072
    buffer_load_dwordx4 v1, s[4:7], s18 offen nt lds
    s_add_u32 m0, s32, 123904
    s_add_u32 s18, s29, 135168
    buffer_load_dwordx4 v2, s[4:7], s18 offen nt lds
    s_add_u32 m0, s32, 124928
    s_add_u32 s18, s29, 139264
    buffer_load_dwordx4 v1, s[4:7], s18 offen nt lds
    s_add_u32 m0, s32, 125952
    s_add_u32 s18, s29, 143360
    buffer_load_dwordx4 v2, s[4:7], s18 offen nt lds
    s_barrier
    s_waitcnt vmcnt(10)
    ds_read_b128 v[16:19], v4 offset:0
    ds_read_b128 v[20:23], v4 offset:2048
    ds_read_b128 v[24:27], v5 offset:0
    ds_read_b128 v[28:31], v5 offset:2048
    s_add_u32 m0, s32, 139264
    s_add_u32 s18, s29, 196608
    buffer_load_dwordx4 v1, s[4:7], s18 offen nt lds
    s_add_u32 m0, s32, 140288
    s_add_u32 s18, s29, 200704
    buffer_load_dwordx4 v2, s[4:7], s18 offen nt lds
    s_add_u32 m0, s32, 141312
    s_add_u32 s18, s29, 204800
    buffer_load_dwordx4 v1, s[4:7], s18 offen nt lds
    s_add_u32 m0, s32, 142336
    s_add_u32 s18, s29, 208896
    buffer_load_dwordx4 v2, s[4:7], s18 offen nt lds
    s_add_u32 s29, s29, 128
    s_and_b32 s29, s29, 511
    s_barrier
    ds_read_b128 v[32:35], v8 offset:0
    ds_read_b128 v[36:39], v8 offset:2048
    ds_read_b128 v[40:43], v8 offset:4096
    ds_read_b128 v[44:47], v8 offset:6144
    ds_read_b128 v[48:51], v8 offset:8192
    ds_read_b128 v[52:55], v8 offset:10240
    s_waitcnt lgkmcnt(5)
    v_mfma_f32_16x16x32_bf16 v[64:67], v[16:19], v[32:35], 0
    v_mfma_f32_16x16x32_bf16 v[68:71], v[20:23], v[32:35], 0
    ds_read_b128 v[32:35], v9 offset:0
    s_waitcnt lgkmcnt(5)
    v_mfma_f32_16x16x32_bf16 v[72:75], v[16:19], v[36:39], 0
    s_add_u32 m0, s32, 90112
    s_add_u32 s18, s29, 0
    buffer_load_dwordx4 v1, s[4:7], s18 offen nt lds
    v_mfma_f32_16x16x32_bf16 v[76:79], v[20:23], v[36:39], 0
    ds_read_b128 v[36:39], v9 offset:2048
    s_waitcnt lgkmcnt(5)
    v_mfma_f32_16x16x32_bf16 v[80:83], v[16:19], v[40:43], 0
    v_mfma_f32_16x16x32_bf16 v[84:87], v[20:23], v[40:43], 0
    ds_read_b128 v[40:43], v9 offset:4096
    s_waitcnt lgkmcnt(5)
    v_mfma_f32_16x16x32_bf16 v[88:91], v[16:19], v[44:47], 0
    s_add_u32 m0, s32, 91136
    s_add_u32 s18, s29, 4096
    buffer_load_dwordx4 v2, s[4:7], s18 offen nt lds
    v_mfma_f32_16x16x32_bf16 v[92:95], v[20:23], v[44:47], 0
    ds_read_b128 v[44:47], v9 offset:6144
    s_waitcnt lgkmcnt(5)
    v_mfma_f32_16x16x32_bf16 v[96:99], v[16:19], v[48:51], 0
    v_mfma_f32_16x16x32_bf16 v[100:103], v[20:23], v[48:51], 0
    ds_read_b128 v[48:51], v9 offset:8192
    s_waitcnt lgkmcnt(5)
    v_mfma_f32_16x16x32_bf16 v[104:107], v[16:19], v[52:55], 0
    s_add_u32 m0, s32, 92160
    s_add_u32 s18, s29, 8192
    buffer_load_dwordx4 v1, s[4:7], s18 offen nt lds
    v_mfma_f32_16x16x32_bf16 v[108:111], v[20:23], v[52:55], 0
    ds_read_b128 v[52:55], v9 offset:10240
    s_waitcnt vmcnt(11)
    ds_read_b128 v[16:19], v4 offset:16384
    ds_read_b128 v[20:23], v4 offset:18432
    s_waitcnt lgkmcnt(7)
    v_mfma_f32_16x16x32_bf16 v[64:67], v[24:27], v[32:35], v[64:67]
    v_mfma_f32_16x16x32_bf16 v[68:71], v[28:31], v[32:35], v[68:71]
    ds_read_b128 v[32:35], v8 offset:0
    s_waitcnt lgkmcnt(7)
    v_mfma_f32_16x16x32_bf16 v[72:75], v[24:27], v[36:39], v[72:75]
    s_add_u32 m0, s32, 93184
    s_add_u32 s18, s29, 12288
    buffer_load_dwordx4 v2, s[4:7], s18 offen nt lds
    v_mfma_f32_16x16x32_bf16 v[76:79], v[28:31], v[36:39], v[76:79]
    ds_read_b128 v[36:39], v8 offset:2048
    s_waitcnt lgkmcnt(7)
    v_mfma_f32_16x16x32_bf16 v[80:83], v[24:27], v[40:43], v[80:83]
    v_mfma_f32_16x16x32_bf16 v[84:87], v[28:31], v[40:43], v[84:87]
    ds_read_b128 v[40:43], v8 offset:4096
    s_waitcnt lgkmcnt(7)
    v_mfma_f32_16x16x32_bf16 v[88:91], v[24:27], v[44:47], v[88:91]
    v_mfma_f32_16x16x32_bf16 v[92:95], v[28:31], v[44:47], v[92:95]
    ds_read_b128 v[44:47], v8 offset:6144
    s_waitcnt lgkmcnt(7)
    v_mfma_f32_16x16x32_bf16 v[96:99], v[24:27], v[48:51], v[96:99]
    v_mfma_f32_16x16x32_bf16 v[100:103], v[28:31], v[48:51], v[100:103]
    ds_read_b128 v[48:51], v8 offset:8192
    s_waitcnt lgkmcnt(7)
    v_mfma_f32_16x16x32_bf16 v[104:107], v[24:27], v[52:55], v[104:107]
    v_mfma_f32_16x16x32_bf16 v[108:111], v[28:31], v[52:55], v[108:111]
    ds_read_b128 v[52:55], v8 offset:10240
    ds_read_b128 v[24:27], v5 offset:16384
    ds_read_b128 v[28:31], v5 offset:18432
    s_barrier
    s_lshl_b32 s19, s22, 8
    s_add_u32 s19, s19, s63
    v_lshlrev_b32 v62, 8, v0
    v_mov_b32 v63, 1
    buffer_atomic_add v63, v62, s[40:43], s19 offen
    s_waitcnt lgkmcnt(7)
    v_mfma_f32_16x16x32_bf16 v[112:115], v[16:19], v[32:35], 0
    v_mfma_f32_16x16x32_bf16 v[116:119], v[20:23], v[32:35], 0
    ds_read_b128 v[32:35], v9 offset:0
    s_waitcnt lgkmcnt(1)
    v_mfma_f32_16x16x32_bf16 v[120:123], v[16:19], v[36:39], 0
    s_add_u32 m0, s32, 106496
    s_add_u32 s18, s29, 65536
    buffer_load_dwordx4 v1, s[4:7], s18 offen nt lds
    v_mfma_f32_16x16x32_bf16 v[124:127], v[20:23], v[36:39], 0
    ds_read_b128 v[36:39], v9 offset:2048
    v_mfma_f32_16x16x32_bf16 v[128:131], v[16:19], v[40:43], 0
    v_mfma_f32_16x16x32_bf16 v[132:135], v[20:23], v[40:43], 0
    ds_read_b128 v[40:43], v9 offset:4096
    v_mfma_f32_16x16x32_bf16 v[136:139], v[16:19], v[44:47], 0
    s_add_u32 m0, s32, 107520
    s_add_u32 s18, s29, 69632
    buffer_load_dwordx4 v2, s[4:7], s18 offen nt lds
    v_mfma_f32_16x16x32_bf16 v[140:143], v[20:23], v[44:47], 0
    ds_read_b128 v[44:47], v9 offset:6144
    v_mfma_f32_16x16x32_bf16 v[144:147], v[16:19], v[48:51], 0
    v_mfma_f32_16x16x32_bf16 v[148:151], v[20:23], v[48:51], 0
    ds_read_b128 v[48:51], v9 offset:8192
    v_mfma_f32_16x16x32_bf16 v[152:155], v[16:19], v[52:55], 0
    s_add_u32 m0, s32, 108544
    s_add_u32 s18, s29, 73728
    buffer_load_dwordx4 v1, s[4:7], s18 offen nt lds
    v_mfma_f32_16x16x32_bf16 v[156:159], v[20:23], v[52:55], 0
    ds_read_b128 v[52:55], v9 offset:10240
    s_waitcnt vmcnt(12)
    ds_read_b128 v[16:19], v4 offset:32768
    ds_read_b128 v[20:23], v4 offset:34816
    s_waitcnt lgkmcnt(7)
    v_mfma_f32_16x16x32_bf16 v[112:115], v[24:27], v[32:35], v[112:115]
    v_mfma_f32_16x16x32_bf16 v[116:119], v[28:31], v[32:35], v[116:119]
    ds_read_b128 v[32:35], v8 offset:0
    s_waitcnt lgkmcnt(7)
    v_mfma_f32_16x16x32_bf16 v[120:123], v[24:27], v[36:39], v[120:123]
    s_add_u32 m0, s32, 109568
    s_add_u32 s18, s29, 77824
    buffer_load_dwordx4 v2, s[4:7], s18 offen nt lds
    v_mfma_f32_16x16x32_bf16 v[124:127], v[28:31], v[36:39], v[124:127]
    ds_read_b128 v[36:39], v8 offset:2048
    s_waitcnt lgkmcnt(7)
    v_mfma_f32_16x16x32_bf16 v[128:131], v[24:27], v[40:43], v[128:131]
    v_mfma_f32_16x16x32_bf16 v[132:135], v[28:31], v[40:43], v[132:135]
    ds_read_b128 v[40:43], v8 offset:4096
    s_waitcnt lgkmcnt(7)
    v_mfma_f32_16x16x32_bf16 v[136:139], v[24:27], v[44:47], v[136:139]
    v_mfma_f32_16x16x32_bf16 v[140:143], v[28:31], v[44:47], v[140:143]
    ds_read_b128 v[44:47], v8 offset:6144
    s_waitcnt lgkmcnt(7)
    v_mfma_f32_16x16x32_bf16 v[144:147], v[24:27], v[48:51], v[144:147]
    v_mfma_f32_16x16x32_bf16 v[148:151], v[28:31], v[48:51], v[148:151]
    ds_read_b128 v[48:51], v8 offset:8192
    s_waitcnt lgkmcnt(7)
    v_mfma_f32_16x16x32_bf16 v[152:155], v[24:27], v[52:55], v[152:155]
    v_mfma_f32_16x16x32_bf16 v[156:159], v[28:31], v[52:55], v[156:159]
    ds_read_b128 v[52:55], v8 offset:10240
    ds_read_b128 v[24:27], v5 offset:32768
    ds_read_b128 v[28:31], v5 offset:34816
    s_barrier
    s_waitcnt lgkmcnt(7)
    v_mfma_f32_16x16x32_bf16 v[160:163], v[16:19], v[32:35], 0
    v_mfma_f32_16x16x32_bf16 v[164:167], v[20:23], v[32:35], 0
    ds_read_b128 v[32:35], v9 offset:0
    s_waitcnt lgkmcnt(1)
    v_mfma_f32_16x16x32_bf16 v[168:171], v[16:19], v[36:39], 0
    s_add_u32 m0, s32, 122880
    s_add_u32 s18, s29, 131072
    buffer_load_dwordx4 v1, s[4:7], s18 offen nt lds
    v_mfma_f32_16x16x32_bf16 v[172:175], v[20:23], v[36:39], 0
    ds_read_b128 v[36:39], v9 offset:2048
    v_mfma_f32_16x16x32_bf16 v[176:179], v[16:19], v[40:43], 0
    v_mfma_f32_16x16x32_bf16 v[180:183], v[20:23], v[40:43], 0
    ds_read_b128 v[40:43], v9 offset:4096
    v_mfma_f32_16x16x32_bf16 v[184:187], v[16:19], v[44:47], 0
    s_add_u32 m0, s32, 123904
    s_add_u32 s18, s29, 135168
    buffer_load_dwordx4 v2, s[4:7], s18 offen nt lds
    v_mfma_f32_16x16x32_bf16 v[188:191], v[20:23], v[44:47], 0
    ds_read_b128 v[44:47], v9 offset:6144
    v_mfma_f32_16x16x32_bf16 v[192:195], v[16:19], v[48:51], 0
    v_mfma_f32_16x16x32_bf16 v[196:199], v[20:23], v[48:51], 0
    ds_read_b128 v[48:51], v9 offset:8192
    v_mfma_f32_16x16x32_bf16 v[200:203], v[16:19], v[52:55], 0
    s_add_u32 m0, s32, 124928
    s_add_u32 s18, s29, 139264
    buffer_load_dwordx4 v1, s[4:7], s18 offen nt lds
    v_mfma_f32_16x16x32_bf16 v[204:207], v[20:23], v[52:55], 0
    ds_read_b128 v[52:55], v9 offset:10240
    s_waitcnt vmcnt(12)
    ds_read_b128 v[16:19], v4 offset:49152
    ds_read_b128 v[20:23], v4 offset:51200
    s_waitcnt lgkmcnt(7)
    v_mfma_f32_16x16x32_bf16 v[160:163], v[24:27], v[32:35], v[160:163]
    v_mfma_f32_16x16x32_bf16 v[164:167], v[28:31], v[32:35], v[164:167]
    ds_read_b128 v[32:35], v8 offset:0
    s_waitcnt lgkmcnt(7)
    v_mfma_f32_16x16x32_bf16 v[168:171], v[24:27], v[36:39], v[168:171]
    s_add_u32 m0, s32, 125952
    s_add_u32 s18, s29, 143360
    buffer_load_dwordx4 v2, s[4:7], s18 offen nt lds
    v_mfma_f32_16x16x32_bf16 v[172:175], v[28:31], v[36:39], v[172:175]
    ds_read_b128 v[36:39], v8 offset:2048
    s_waitcnt lgkmcnt(7)
    v_mfma_f32_16x16x32_bf16 v[176:179], v[24:27], v[40:43], v[176:179]
    v_mfma_f32_16x16x32_bf16 v[180:183], v[28:31], v[40:43], v[180:183]
    ds_read_b128 v[40:43], v8 offset:4096
    s_waitcnt lgkmcnt(7)
    v_mfma_f32_16x16x32_bf16 v[184:187], v[24:27], v[44:47], v[184:187]
    v_mfma_f32_16x16x32_bf16 v[188:191], v[28:31], v[44:47], v[188:191]
    ds_read_b128 v[44:47], v8 offset:6144
    s_waitcnt lgkmcnt(7)
    v_mfma_f32_16x16x32_bf16 v[192:195], v[24:27], v[48:51], v[192:195]
    v_mfma_f32_16x16x32_bf16 v[196:199], v[28:31], v[48:51], v[196:199]
    ds_read_b128 v[48:51], v8 offset:8192
    s_waitcnt lgkmcnt(7)
    v_mfma_f32_16x16x32_bf16 v[200:203], v[24:27], v[52:55], v[200:203]
    v_mfma_f32_16x16x32_bf16 v[204:207], v[28:31], v[52:55], v[204:207]
    ds_read_b128 v[52:55], v8 offset:10240
    ds_read_b128 v[24:27], v5 offset:49152
    ds_read_b128 v[28:31], v5 offset:51200
    s_barrier
    s_waitcnt lgkmcnt(7)
    v_mfma_f32_16x16x32_bf16 v[208:211], v[16:19], v[32:35], 0
    v_mfma_f32_16x16x32_bf16 v[212:215], v[20:23], v[32:35], 0
    ds_read_b128 v[32:35], v9 offset:0
    s_waitcnt lgkmcnt(1)
    v_mfma_f32_16x16x32_bf16 v[216:219], v[16:19], v[36:39], 0
    s_add_u32 m0, s32, 139264
    s_add_u32 s18, s29, 196608
    buffer_load_dwordx4 v1, s[4:7], s18 offen nt lds
    v_mfma_f32_16x16x32_bf16 v[220:223], v[20:23], v[36:39], 0
    ds_read_b128 v[36:39], v9 offset:2048
    v_mfma_f32_16x16x32_bf16 v[224:227], v[16:19], v[40:43], 0
    v_mfma_f32_16x16x32_bf16 v[228:231], v[20:23], v[40:43], 0
    ds_read_b128 v[40:43], v9 offset:4096
    v_mfma_f32_16x16x32_bf16 v[232:235], v[16:19], v[44:47], 0
    s_add_u32 m0, s32, 140288
    s_add_u32 s18, s29, 200704
    buffer_load_dwordx4 v2, s[4:7], s18 offen nt lds
    v_mfma_f32_16x16x32_bf16 v[236:239], v[20:23], v[44:47], 0
    ds_read_b128 v[44:47], v9 offset:6144
    v_mfma_f32_16x16x32_bf16 v[240:243], v[16:19], v[48:51], 0
    v_mfma_f32_16x16x32_bf16 v[244:247], v[20:23], v[48:51], 0
    ds_read_b128 v[48:51], v9 offset:8192
    v_mfma_f32_16x16x32_bf16 v[248:251], v[16:19], v[52:55], 0
    s_add_u32 m0, s32, 141312
    s_add_u32 s18, s29, 204800
    buffer_load_dwordx4 v1, s[4:7], s18 offen nt lds
    v_mfma_f32_16x16x32_bf16 v[252:255], v[20:23], v[52:55], 0
    ds_read_b128 v[52:55], v9 offset:10240
    s_waitcnt vmcnt(12)
    ds_read_b128 v[16:19], v4 offset:0
    ds_read_b128 v[20:23], v4 offset:2048
    s_waitcnt lgkmcnt(7)
    v_mfma_f32_16x16x32_bf16 v[208:211], v[24:27], v[32:35], v[208:211]
    v_mfma_f32_16x16x32_bf16 v[212:215], v[28:31], v[32:35], v[212:215]
    s_waitcnt lgkmcnt(6)
    v_mfma_f32_16x16x32_bf16 v[216:219], v[24:27], v[36:39], v[216:219]
    s_add_u32 m0, s32, 142336
    s_add_u32 s18, s29, 208896
    buffer_load_dwordx4 v2, s[4:7], s18 offen nt lds
    s_add_u32 s29, s29, 128
    s_and_b32 s29, s29, 511
    v_mfma_f32_16x16x32_bf16 v[220:223], v[28:31], v[36:39], v[220:223]
    s_waitcnt lgkmcnt(5)
    v_mfma_f32_16x16x32_bf16 v[224:227], v[24:27], v[40:43], v[224:227]
    v_mfma_f32_16x16x32_bf16 v[228:231], v[28:31], v[40:43], v[228:231]
    s_waitcnt lgkmcnt(4)
    v_mfma_f32_16x16x32_bf16 v[232:235], v[24:27], v[44:47], v[232:235]
    v_mfma_f32_16x16x32_bf16 v[236:239], v[28:31], v[44:47], v[236:239]
    s_waitcnt lgkmcnt(3)
    v_mfma_f32_16x16x32_bf16 v[240:243], v[24:27], v[48:51], v[240:243]
    v_mfma_f32_16x16x32_bf16 v[244:247], v[28:31], v[48:51], v[244:247]
    s_waitcnt lgkmcnt(2)
    v_mfma_f32_16x16x32_bf16 v[248:251], v[24:27], v[52:55], v[248:251]
    v_mfma_f32_16x16x32_bf16 v[252:255], v[28:31], v[52:55], v[252:255]
    ds_read_b128 v[24:27], v5 offset:0
    ds_read_b128 v[28:31], v5 offset:2048
    s_barrier
    ds_read_b128 v[32:35], v8 offset:12288
    ds_read_b128 v[36:39], v8 offset:14336
    ds_read_b128 v[40:43], v8 offset:16384
    ds_read_b128 v[44:47], v8 offset:18432
    ds_read_b128 v[48:51], v8 offset:20480
    ds_read_b128 v[52:55], v8 offset:22528
    s_waitcnt lgkmcnt(5)
    v_mfma_f32_16x16x32_bf16 v[64:67], v[16:19], v[32:35], v[64:67]
    v_mfma_f32_16x16x32_bf16 v[68:71], v[20:23], v[32:35], v[68:71]
    ds_read_b128 v[32:35], v9 offset:12288
    s_waitcnt lgkmcnt(5)
    v_mfma_f32_16x16x32_bf16 v[72:75], v[16:19], v[36:39], v[72:75]
    s_add_u32 m0, s32, 90112
    s_add_u32 s18, s29, 0
    buffer_load_dwordx4 v1, s[4:7], s18 offen nt lds
    v_mfma_f32_16x16x32_bf16 v[76:79], v[20:23], v[36:39], v[76:79]
    ds_read_b128 v[36:39], v9 offset:14336
    s_waitcnt lgkmcnt(5)
    v_mfma_f32_16x16x32_bf16 v[80:83], v[16:19], v[40:43], v[80:83]
    v_mfma_f32_16x16x32_bf16 v[84:87], v[20:23], v[40:43], v[84:87]
    ds_read_b128 v[40:43], v9 offset:16384
    s_waitcnt lgkmcnt(5)
    v_mfma_f32_16x16x32_bf16 v[88:91], v[16:19], v[44:47], v[88:91]
    s_add_u32 m0, s32, 91136
    s_add_u32 s18, s29, 4096
    buffer_load_dwordx4 v2, s[4:7], s18 offen nt lds
    v_mfma_f32_16x16x32_bf16 v[92:95], v[20:23], v[44:47], v[92:95]
    ds_read_b128 v[44:47], v9 offset:18432
    s_waitcnt lgkmcnt(5)
    v_mfma_f32_16x16x32_bf16 v[96:99], v[16:19], v[48:51], v[96:99]
    v_mfma_f32_16x16x32_bf16 v[100:103], v[20:23], v[48:51], v[100:103]
    ds_read_b128 v[48:51], v9 offset:20480
    s_waitcnt lgkmcnt(5)
    v_mfma_f32_16x16x32_bf16 v[104:107], v[16:19], v[52:55], v[104:107]
    s_add_u32 m0, s32, 92160
    s_add_u32 s18, s29, 8192
    buffer_load_dwordx4 v1, s[4:7], s18 offen nt lds
    v_mfma_f32_16x16x32_bf16 v[108:111], v[20:23], v[52:55], v[108:111]
    ds_read_b128 v[52:55], v9 offset:22528
    s_waitcnt vmcnt(11)
    ds_read_b128 v[16:19], v4 offset:16384
    ds_read_b128 v[20:23], v4 offset:18432
    s_waitcnt lgkmcnt(7)
    v_mfma_f32_16x16x32_bf16 v[64:67], v[24:27], v[32:35], v[64:67]
    v_mfma_f32_16x16x32_bf16 v[68:71], v[28:31], v[32:35], v[68:71]
    ds_read_b128 v[32:35], v8 offset:12288
    s_waitcnt lgkmcnt(7)
    v_mfma_f32_16x16x32_bf16 v[72:75], v[24:27], v[36:39], v[72:75]
    s_add_u32 m0, s32, 93184
    s_add_u32 s18, s29, 12288
    buffer_load_dwordx4 v2, s[4:7], s18 offen nt lds
    v_mfma_f32_16x16x32_bf16 v[76:79], v[28:31], v[36:39], v[76:79]
    ds_read_b128 v[36:39], v8 offset:14336
    s_waitcnt lgkmcnt(7)
    v_mfma_f32_16x16x32_bf16 v[80:83], v[24:27], v[40:43], v[80:83]
    v_mfma_f32_16x16x32_bf16 v[84:87], v[28:31], v[40:43], v[84:87]
    ds_read_b128 v[40:43], v8 offset:16384
    s_waitcnt lgkmcnt(7)
    v_mfma_f32_16x16x32_bf16 v[88:91], v[24:27], v[44:47], v[88:91]
    v_mfma_f32_16x16x32_bf16 v[92:95], v[28:31], v[44:47], v[92:95]
    ds_read_b128 v[44:47], v8 offset:18432
    s_waitcnt lgkmcnt(7)
    v_mfma_f32_16x16x32_bf16 v[96:99], v[24:27], v[48:51], v[96:99]
    v_mfma_f32_16x16x32_bf16 v[100:103], v[28:31], v[48:51], v[100:103]
    ds_read_b128 v[48:51], v8 offset:20480
    s_waitcnt lgkmcnt(7)
    v_mfma_f32_16x16x32_bf16 v[104:107], v[24:27], v[52:55], v[104:107]
    v_mfma_f32_16x16x32_bf16 v[108:111], v[28:31], v[52:55], v[108:111]
    ds_read_b128 v[52:55], v8 offset:22528
    ds_read_b128 v[24:27], v5 offset:16384
    ds_read_b128 v[28:31], v5 offset:18432
    s_barrier
    s_waitcnt lgkmcnt(7)
    v_mfma_f32_16x16x32_bf16 v[112:115], v[16:19], v[32:35], v[112:115]
    v_mfma_f32_16x16x32_bf16 v[116:119], v[20:23], v[32:35], v[116:119]
    ds_read_b128 v[32:35], v9 offset:12288
    s_waitcnt lgkmcnt(1)
    v_mfma_f32_16x16x32_bf16 v[120:123], v[16:19], v[36:39], v[120:123]
    s_add_u32 m0, s32, 106496
    s_add_u32 s18, s29, 65536
    buffer_load_dwordx4 v1, s[4:7], s18 offen nt lds
    v_mfma_f32_16x16x32_bf16 v[124:127], v[20:23], v[36:39], v[124:127]
    ds_read_b128 v[36:39], v9 offset:14336
    v_mfma_f32_16x16x32_bf16 v[128:131], v[16:19], v[40:43], v[128:131]
    v_mfma_f32_16x16x32_bf16 v[132:135], v[20:23], v[40:43], v[132:135]
    ds_read_b128 v[40:43], v9 offset:16384
    v_mfma_f32_16x16x32_bf16 v[136:139], v[16:19], v[44:47], v[136:139]
    s_add_u32 m0, s32, 107520
    s_add_u32 s18, s29, 69632
    buffer_load_dwordx4 v2, s[4:7], s18 offen nt lds
    v_mfma_f32_16x16x32_bf16 v[140:143], v[20:23], v[44:47], v[140:143]
    ds_read_b128 v[44:47], v9 offset:18432
    v_mfma_f32_16x16x32_bf16 v[144:147], v[16:19], v[48:51], v[144:147]
    v_mfma_f32_16x16x32_bf16 v[148:151], v[20:23], v[48:51], v[148:151]
    ds_read_b128 v[48:51], v9 offset:20480
    v_mfma_f32_16x16x32_bf16 v[152:155], v[16:19], v[52:55], v[152:155]
    s_add_u32 m0, s32, 108544
    s_add_u32 s18, s29, 73728
    buffer_load_dwordx4 v1, s[4:7], s18 offen nt lds
    v_mfma_f32_16x16x32_bf16 v[156:159], v[20:23], v[52:55], v[156:159]
    ds_read_b128 v[52:55], v9 offset:22528
    s_waitcnt vmcnt(11)
    ds_read_b128 v[16:19], v4 offset:32768
    ds_read_b128 v[20:23], v4 offset:34816
    s_waitcnt lgkmcnt(7)
    v_mfma_f32_16x16x32_bf16 v[112:115], v[24:27], v[32:35], v[112:115]
    v_mfma_f32_16x16x32_bf16 v[116:119], v[28:31], v[32:35], v[116:119]
    ds_read_b128 v[32:35], v8 offset:12288
    s_waitcnt lgkmcnt(7)
    v_mfma_f32_16x16x32_bf16 v[120:123], v[24:27], v[36:39], v[120:123]
    s_add_u32 m0, s32, 109568
    s_add_u32 s18, s29, 77824
    buffer_load_dwordx4 v2, s[4:7], s18 offen nt lds
    v_mfma_f32_16x16x32_bf16 v[124:127], v[28:31], v[36:39], v[124:127]
    ds_read_b128 v[36:39], v8 offset:14336
    s_waitcnt lgkmcnt(7)
    v_mfma_f32_16x16x32_bf16 v[128:131], v[24:27], v[40:43], v[128:131]
    v_mfma_f32_16x16x32_bf16 v[132:135], v[28:31], v[40:43], v[132:135]
    ds_read_b128 v[40:43], v8 offset:16384
    s_waitcnt lgkmcnt(7)
    v_mfma_f32_16x16x32_bf16 v[136:139], v[24:27], v[44:47], v[136:139]
    v_mfma_f32_16x16x32_bf16 v[140:143], v[28:31], v[44:47], v[140:143]
    ds_read_b128 v[44:47], v8 offset:18432
    s_waitcnt lgkmcnt(7)
    v_mfma_f32_16x16x32_bf16 v[144:147], v[24:27], v[48:51], v[144:147]
    v_mfma_f32_16x16x32_bf16 v[148:151], v[28:31], v[48:51], v[148:151]
    ds_read_b128 v[48:51], v8 offset:20480
    s_waitcnt lgkmcnt(7)
    v_mfma_f32_16x16x32_bf16 v[152:155], v[24:27], v[52:55], v[152:155]
    v_mfma_f32_16x16x32_bf16 v[156:159], v[28:31], v[52:55], v[156:159]
    ds_read_b128 v[52:55], v8 offset:22528
    ds_read_b128 v[24:27], v5 offset:32768
    ds_read_b128 v[28:31], v5 offset:34816
    s_barrier
    s_waitcnt lgkmcnt(7)
    v_mfma_f32_16x16x32_bf16 v[160:163], v[16:19], v[32:35], v[160:163]
    v_mfma_f32_16x16x32_bf16 v[164:167], v[20:23], v[32:35], v[164:167]
    ds_read_b128 v[32:35], v9 offset:12288
    s_waitcnt lgkmcnt(1)
    v_mfma_f32_16x16x32_bf16 v[168:171], v[16:19], v[36:39], v[168:171]
    s_add_u32 m0, s32, 122880
    s_add_u32 s18, s29, 131072
    buffer_load_dwordx4 v1, s[4:7], s18 offen nt lds
    v_mfma_f32_16x16x32_bf16 v[172:175], v[20:23], v[36:39], v[172:175]
    ds_read_b128 v[36:39], v9 offset:14336
    v_mfma_f32_16x16x32_bf16 v[176:179], v[16:19], v[40:43], v[176:179]
    v_mfma_f32_16x16x32_bf16 v[180:183], v[20:23], v[40:43], v[180:183]
    ds_read_b128 v[40:43], v9 offset:16384
    v_mfma_f32_16x16x32_bf16 v[184:187], v[16:19], v[44:47], v[184:187]
    s_add_u32 m0, s32, 123904
    s_add_u32 s18, s29, 135168
    buffer_load_dwordx4 v2, s[4:7], s18 offen nt lds
    v_mfma_f32_16x16x32_bf16 v[188:191], v[20:23], v[44:47], v[188:191]
    ds_read_b128 v[44:47], v9 offset:18432
    v_mfma_f32_16x16x32_bf16 v[192:195], v[16:19], v[48:51], v[192:195]
    v_mfma_f32_16x16x32_bf16 v[196:199], v[20:23], v[48:51], v[196:199]
    ds_read_b128 v[48:51], v9 offset:20480
    v_mfma_f32_16x16x32_bf16 v[200:203], v[16:19], v[52:55], v[200:203]
    s_add_u32 m0, s32, 124928
    s_add_u32 s18, s29, 139264
    buffer_load_dwordx4 v1, s[4:7], s18 offen nt lds
    v_mfma_f32_16x16x32_bf16 v[204:207], v[20:23], v[52:55], v[204:207]
    ds_read_b128 v[52:55], v9 offset:22528
    s_waitcnt vmcnt(11)
    ds_read_b128 v[16:19], v4 offset:49152
    ds_read_b128 v[20:23], v4 offset:51200
    s_waitcnt lgkmcnt(7)
    v_mfma_f32_16x16x32_bf16 v[160:163], v[24:27], v[32:35], v[160:163]
    v_mfma_f32_16x16x32_bf16 v[164:167], v[28:31], v[32:35], v[164:167]
    ds_read_b128 v[32:35], v8 offset:12288
    s_waitcnt lgkmcnt(7)
    v_mfma_f32_16x16x32_bf16 v[168:171], v[24:27], v[36:39], v[168:171]
    s_add_u32 m0, s32, 125952
    s_add_u32 s18, s29, 143360
    buffer_load_dwordx4 v2, s[4:7], s18 offen nt lds
    v_mfma_f32_16x16x32_bf16 v[172:175], v[28:31], v[36:39], v[172:175]
    ds_read_b128 v[36:39], v8 offset:14336
    s_waitcnt lgkmcnt(7)
    v_mfma_f32_16x16x32_bf16 v[176:179], v[24:27], v[40:43], v[176:179]
    v_mfma_f32_16x16x32_bf16 v[180:183], v[28:31], v[40:43], v[180:183]
    ds_read_b128 v[40:43], v8 offset:16384
    s_waitcnt lgkmcnt(7)
    v_mfma_f32_16x16x32_bf16 v[184:187], v[24:27], v[44:47], v[184:187]
    v_mfma_f32_16x16x32_bf16 v[188:191], v[28:31], v[44:47], v[188:191]
    ds_read_b128 v[44:47], v8 offset:18432
    s_waitcnt lgkmcnt(7)
    v_mfma_f32_16x16x32_bf16 v[192:195], v[24:27], v[48:51], v[192:195]
    v_mfma_f32_16x16x32_bf16 v[196:199], v[28:31], v[48:51], v[196:199]
    ds_read_b128 v[48:51], v8 offset:20480
    s_waitcnt lgkmcnt(7)
    v_mfma_f32_16x16x32_bf16 v[200:203], v[24:27], v[52:55], v[200:203]
    v_mfma_f32_16x16x32_bf16 v[204:207], v[28:31], v[52:55], v[204:207]
    ds_read_b128 v[52:55], v8 offset:22528
    ds_read_b128 v[24:27], v5 offset:49152
    ds_read_b128 v[28:31], v5 offset:51200
    s_barrier
    s_waitcnt lgkmcnt(7)
    v_mfma_f32_16x16x32_bf16 v[208:211], v[16:19], v[32:35], v[208:211]
    v_mfma_f32_16x16x32_bf16 v[212:215], v[20:23], v[32:35], v[212:215]
    ds_read_b128 v[32:35], v9 offset:12288
    s_waitcnt lgkmcnt(1)
    v_mfma_f32_16x16x32_bf16 v[216:219], v[16:19], v[36:39], v[216:219]
    s_add_u32 m0, s32, 139264
    s_add_u32 s18, s29, 196608
    buffer_load_dwordx4 v1, s[4:7], s18 offen nt lds
    v_mfma_f32_16x16x32_bf16 v[220:223], v[20:23], v[36:39], v[220:223]
    ds_read_b128 v[36:39], v9 offset:14336
    v_mfma_f32_16x16x32_bf16 v[224:227], v[16:19], v[40:43], v[224:227]
    v_mfma_f32_16x16x32_bf16 v[228:231], v[20:23], v[40:43], v[228:231]
    ds_read_b128 v[40:43], v9 offset:16384
    v_mfma_f32_16x16x32_bf16 v[232:235], v[16:19], v[44:47], v[232:235]
    s_add_u32 m0, s32, 140288
    s_add_u32 s18, s29, 200704
    buffer_load_dwordx4 v2, s[4:7], s18 offen nt lds
    v_mfma_f32_16x16x32_bf16 v[236:239], v[20:23], v[44:47], v[236:239]
    ds_read_b128 v[44:47], v9 offset:18432
    v_mfma_f32_16x16x32_bf16 v[240:243], v[16:19], v[48:51], v[240:243]
    v_mfma_f32_16x16x32_bf16 v[244:247], v[20:23], v[48:51], v[244:247]
    ds_read_b128 v[48:51], v9 offset:20480
    v_mfma_f32_16x16x32_bf16 v[248:251], v[16:19], v[52:55], v[248:251]
    s_add_u32 m0, s32, 141312
    s_add_u32 s18, s29, 204800
    buffer_load_dwordx4 v1, s[4:7], s18 offen nt lds
    v_mfma_f32_16x16x32_bf16 v[252:255], v[20:23], v[52:55], v[252:255]
    ds_read_b128 v[52:55], v9 offset:22528
    s_waitcnt vmcnt(11)
    ds_read_b128 v[16:19], v4 offset:0
    ds_read_b128 v[20:23], v4 offset:2048
    s_waitcnt lgkmcnt(7)
    v_mfma_f32_16x16x32_bf16 v[208:211], v[24:27], v[32:35], v[208:211]
    v_mfma_f32_16x16x32_bf16 v[212:215], v[28:31], v[32:35], v[212:215]
    s_waitcnt lgkmcnt(6)
    v_mfma_f32_16x16x32_bf16 v[216:219], v[24:27], v[36:39], v[216:219]
    s_add_u32 m0, s32, 142336
    s_add_u32 s18, s29, 208896
    buffer_load_dwordx4 v2, s[4:7], s18 offen nt lds
    s_add_u32 s29, s29, 128
    s_and_b32 s29, s29, 511
    v_mfma_f32_16x16x32_bf16 v[220:223], v[28:31], v[36:39], v[220:223]
    s_waitcnt lgkmcnt(5)
    v_mfma_f32_16x16x32_bf16 v[224:227], v[24:27], v[40:43], v[224:227]
    v_mfma_f32_16x16x32_bf16 v[228:231], v[28:31], v[40:43], v[228:231]
    s_waitcnt lgkmcnt(4)
    v_mfma_f32_16x16x32_bf16 v[232:235], v[24:27], v[44:47], v[232:235]
    v_mfma_f32_16x16x32_bf16 v[236:239], v[28:31], v[44:47], v[236:239]
    s_waitcnt lgkmcnt(3)
    v_mfma_f32_16x16x32_bf16 v[240:243], v[24:27], v[48:51], v[240:243]
    v_mfma_f32_16x16x32_bf16 v[244:247], v[28:31], v[48:51], v[244:247]
    s_waitcnt lgkmcnt(2)
    v_mfma_f32_16x16x32_bf16 v[248:251], v[24:27], v[52:55], v[248:251]
    v_mfma_f32_16x16x32_bf16 v[252:255], v[28:31], v[52:55], v[252:255]
    ds_read_b128 v[24:27], v5 offset:0
    ds_read_b128 v[28:31], v5 offset:2048
    s_barrier
    ds_read_b128 v[32:35], v8 offset:0
    ds_read_b128 v[36:39], v8 offset:2048
    ds_read_b128 v[40:43], v8 offset:4096
    ds_read_b128 v[44:47], v8 offset:6144
    ds_read_b128 v[48:51], v8 offset:8192
    ds_read_b128 v[52:55], v8 offset:10240
    s_waitcnt lgkmcnt(5)
    v_mfma_f32_16x16x32_bf16 v[64:67], v[16:19], v[32:35], v[64:67]
    v_mfma_f32_16x16x32_bf16 v[68:71], v[20:23], v[32:35], v[68:71]
    ds_read_b128 v[32:35], v9 offset:0
    s_waitcnt lgkmcnt(5)
    v_mfma_f32_16x16x32_bf16 v[72:75], v[16:19], v[36:39], v[72:75]
    s_add_u32 m0, s32, 90112
    s_add_u32 s18, s29, 0
    buffer_load_dwordx4 v1, s[4:7], s18 offen nt lds
    v_mfma_f32_16x16x32_bf16 v[76:79], v[20:23], v[36:39], v[76:79]
    ds_read_b128 v[36:39], v9 offset:2048
    s_waitcnt lgkmcnt(5)
    v_mfma_f32_16x16x32_bf16 v[80:83], v[16:19], v[40:43], v[80:83]
    v_mfma_f32_16x16x32_bf16 v[84:87], v[20:23], v[40:43], v[84:87]
    ds_read_b128 v[40:43], v9 offset:4096
    s_waitcnt lgkmcnt(5)
    v_mfma_f32_16x16x32_bf16 v[88:91], v[16:19], v[44:47], v[88:91]
    s_add_u32 m0, s32, 91136
    s_add_u32 s18, s29, 4096
    buffer_load_dwordx4 v2, s[4:7], s18 offen nt lds
    v_mfma_f32_16x16x32_bf16 v[92:95], v[20:23], v[44:47], v[92:95]
    ds_read_b128 v[44:47], v9 offset:6144
    s_waitcnt lgkmcnt(5)
    v_mfma_f32_16x16x32_bf16 v[96:99], v[16:19], v[48:51], v[96:99]
    v_mfma_f32_16x16x32_bf16 v[100:103], v[20:23], v[48:51], v[100:103]
    ds_read_b128 v[48:51], v9 offset:8192
    s_waitcnt lgkmcnt(5)
    v_mfma_f32_16x16x32_bf16 v[104:107], v[16:19], v[52:55], v[104:107]
    s_add_u32 m0, s32, 92160
    s_add_u32 s18, s29, 8192
    buffer_load_dwordx4 v1, s[4:7], s18 offen nt lds
    v_mfma_f32_16x16x32_bf16 v[108:111], v[20:23], v[52:55], v[108:111]
    ds_read_b128 v[52:55], v9 offset:10240
    s_waitcnt vmcnt(11)
    ds_read_b128 v[16:19], v4 offset:16384
    ds_read_b128 v[20:23], v4 offset:18432
    s_waitcnt lgkmcnt(7)
    v_mfma_f32_16x16x32_bf16 v[64:67], v[24:27], v[32:35], v[64:67]
    v_mfma_f32_16x16x32_bf16 v[68:71], v[28:31], v[32:35], v[68:71]
    ds_read_b128 v[32:35], v8 offset:0
    s_waitcnt lgkmcnt(7)
    v_mfma_f32_16x16x32_bf16 v[72:75], v[24:27], v[36:39], v[72:75]
    s_add_u32 m0, s32, 93184
    s_add_u32 s18, s29, 12288
    buffer_load_dwordx4 v2, s[4:7], s18 offen nt lds
    v_mfma_f32_16x16x32_bf16 v[76:79], v[28:31], v[36:39], v[76:79]
    ds_read_b128 v[36:39], v8 offset:2048
    s_waitcnt lgkmcnt(7)
    v_mfma_f32_16x16x32_bf16 v[80:83], v[24:27], v[40:43], v[80:83]
    v_mfma_f32_16x16x32_bf16 v[84:87], v[28:31], v[40:43], v[84:87]
    ds_read_b128 v[40:43], v8 offset:4096
    s_waitcnt lgkmcnt(7)
    v_mfma_f32_16x16x32_bf16 v[88:91], v[24:27], v[44:47], v[88:91]
    v_mfma_f32_16x16x32_bf16 v[92:95], v[28:31], v[44:47], v[92:95]
    ds_read_b128 v[44:47], v8 offset:6144
    s_waitcnt lgkmcnt(7)
    v_mfma_f32_16x16x32_bf16 v[96:99], v[24:27], v[48:51], v[96:99]
    v_mfma_f32_16x16x32_bf16 v[100:103], v[28:31], v[48:51], v[100:103]
    ds_read_b128 v[48:51], v8 offset:8192
    s_waitcnt lgkmcnt(7)
    v_mfma_f32_16x16x32_bf16 v[104:107], v[24:27], v[52:55], v[104:107]
    v_mfma_f32_16x16x32_bf16 v[108:111], v[28:31], v[52:55], v[108:111]
    ds_read_b128 v[52:55], v8 offset:10240
    ds_read_b128 v[24:27], v5 offset:16384
    ds_read_b128 v[28:31], v5 offset:18432
    s_barrier
    s_waitcnt lgkmcnt(7)
    v_mfma_f32_16x16x32_bf16 v[112:115], v[16:19], v[32:35], v[112:115]
    v_mfma_f32_16x16x32_bf16 v[116:119], v[20:23], v[32:35], v[116:119]
    ds_read_b128 v[32:35], v9 offset:0
    s_waitcnt lgkmcnt(1)
    v_mfma_f32_16x16x32_bf16 v[120:123], v[16:19], v[36:39], v[120:123]
    s_add_u32 m0, s32, 106496
    s_add_u32 s18, s29, 65536
    buffer_load_dwordx4 v1, s[4:7], s18 offen nt lds
    v_mfma_f32_16x16x32_bf16 v[124:127], v[20:23], v[36:39], v[124:127]
    ds_read_b128 v[36:39], v9 offset:2048
    v_mfma_f32_16x16x32_bf16 v[128:131], v[16:19], v[40:43], v[128:131]
    v_mfma_f32_16x16x32_bf16 v[132:135], v[20:23], v[40:43], v[132:135]
    ds_read_b128 v[40:43], v9 offset:4096
    v_mfma_f32_16x16x32_bf16 v[136:139], v[16:19], v[44:47], v[136:139]
    s_add_u32 m0, s32, 107520
    s_add_u32 s18, s29, 69632
    buffer_load_dwordx4 v2, s[4:7], s18 offen nt lds
    v_mfma_f32_16x16x32_bf16 v[140:143], v[20:23], v[44:47], v[140:143]
    ds_read_b128 v[44:47], v9 offset:6144
    v_mfma_f32_16x16x32_bf16 v[144:147], v[16:19], v[48:51], v[144:147]
    v_mfma_f32_16x16x32_bf16 v[148:151], v[20:23], v[48:51], v[148:151]
    ds_read_b128 v[48:51], v9 offset:8192
    v_mfma_f32_16x16x32_bf16 v[152:155], v[16:19], v[52:55], v[152:155]
    s_add_u32 m0, s32, 108544
    s_add_u32 s18, s29, 73728
    buffer_load_dwordx4 v1, s[4:7], s18 offen nt lds
    v_mfma_f32_16x16x32_bf16 v[156:159], v[20:23], v[52:55], v[156:159]
    ds_read_b128 v[52:55], v9 offset:10240
    s_waitcnt vmcnt(11)
    ds_read_b128 v[16:19], v4 offset:32768
    ds_read_b128 v[20:23], v4 offset:34816
    s_waitcnt lgkmcnt(7)
    v_mfma_f32_16x16x32_bf16 v[112:115], v[24:27], v[32:35], v[112:115]
    v_mfma_f32_16x16x32_bf16 v[116:119], v[28:31], v[32:35], v[116:119]
    ds_read_b128 v[32:35], v8 offset:0
    s_waitcnt lgkmcnt(7)
    v_mfma_f32_16x16x32_bf16 v[120:123], v[24:27], v[36:39], v[120:123]
    s_add_u32 m0, s32, 109568
    s_add_u32 s18, s29, 77824
    buffer_load_dwordx4 v2, s[4:7], s18 offen nt lds
    v_mfma_f32_16x16x32_bf16 v[124:127], v[28:31], v[36:39], v[124:127]
    ds_read_b128 v[36:39], v8 offset:2048
    s_waitcnt lgkmcnt(7)
    v_mfma_f32_16x16x32_bf16 v[128:131], v[24:27], v[40:43], v[128:131]
    v_mfma_f32_16x16x32_bf16 v[132:135], v[28:31], v[40:43], v[132:135]
    ds_read_b128 v[40:43], v8 offset:4096
    s_waitcnt lgkmcnt(7)
    v_mfma_f32_16x16x32_bf16 v[136:139], v[24:27], v[44:47], v[136:139]
    v_mfma_f32_16x16x32_bf16 v[140:143], v[28:31], v[44:47], v[140:143]
    ds_read_b128 v[44:47], v8 offset:6144
    s_waitcnt lgkmcnt(7)
    v_mfma_f32_16x16x32_bf16 v[144:147], v[24:27], v[48:51], v[144:147]
    v_mfma_f32_16x16x32_bf16 v[148:151], v[28:31], v[48:51], v[148:151]
    ds_read_b128 v[48:51], v8 offset:8192
    s_waitcnt lgkmcnt(7)
    v_mfma_f32_16x16x32_bf16 v[152:155], v[24:27], v[52:55], v[152:155]
    v_mfma_f32_16x16x32_bf16 v[156:159], v[28:31], v[52:55], v[156:159]
    ds_read_b128 v[52:55], v8 offset:10240
    ds_read_b128 v[24:27], v5 offset:32768
    ds_read_b128 v[28:31], v5 offset:34816
    s_barrier
    s_waitcnt lgkmcnt(7)
    v_mfma_f32_16x16x32_bf16 v[160:163], v[16:19], v[32:35], v[160:163]
    v_mfma_f32_16x16x32_bf16 v[164:167], v[20:23], v[32:35], v[164:167]
    ds_read_b128 v[32:35], v9 offset:0
    s_waitcnt lgkmcnt(1)
    v_mfma_f32_16x16x32_bf16 v[168:171], v[16:19], v[36:39], v[168:171]
    s_add_u32 m0, s32, 122880
    s_add_u32 s18, s29, 131072
    buffer_load_dwordx4 v1, s[4:7], s18 offen nt lds
    v_mfma_f32_16x16x32_bf16 v[172:175], v[20:23], v[36:39], v[172:175]
    ds_read_b128 v[36:39], v9 offset:2048
    v_mfma_f32_16x16x32_bf16 v[176:179], v[16:19], v[40:43], v[176:179]
    v_mfma_f32_16x16x32_bf16 v[180:183], v[20:23], v[40:43], v[180:183]
    ds_read_b128 v[40:43], v9 offset:4096
    v_mfma_f32_16x16x32_bf16 v[184:187], v[16:19], v[44:47], v[184:187]
    s_add_u32 m0, s32, 123904
    s_add_u32 s18, s29, 135168
    buffer_load_dwordx4 v2, s[4:7], s18 offen nt lds
    v_mfma_f32_16x16x32_bf16 v[188:191], v[20:23], v[44:47], v[188:191]
    ds_read_b128 v[44:47], v9 offset:6144
    v_mfma_f32_16x16x32_bf16 v[192:195], v[16:19], v[48:51], v[192:195]
    v_mfma_f32_16x16x32_bf16 v[196:199], v[20:23], v[48:51], v[196:199]
    ds_read_b128 v[48:51], v9 offset:8192
    v_mfma_f32_16x16x32_bf16 v[200:203], v[16:19], v[52:55], v[200:203]
    s_add_u32 m0, s32, 124928
    s_add_u32 s18, s29, 139264
    buffer_load_dwordx4 v1, s[4:7], s18 offen nt lds
    v_mfma_f32_16x16x32_bf16 v[204:207], v[20:23], v[52:55], v[204:207]
    ds_read_b128 v[52:55], v9 offset:10240
    s_waitcnt vmcnt(11)
    ds_read_b128 v[16:19], v4 offset:49152
    ds_read_b128 v[20:23], v4 offset:51200
    s_waitcnt lgkmcnt(7)
    v_mfma_f32_16x16x32_bf16 v[160:163], v[24:27], v[32:35], v[160:163]
    v_mfma_f32_16x16x32_bf16 v[164:167], v[28:31], v[32:35], v[164:167]
    ds_read_b128 v[32:35], v8 offset:0
    s_waitcnt lgkmcnt(7)
    v_mfma_f32_16x16x32_bf16 v[168:171], v[24:27], v[36:39], v[168:171]
    s_add_u32 m0, s32, 125952
    s_add_u32 s18, s29, 143360
    buffer_load_dwordx4 v2, s[4:7], s18 offen nt lds
    v_mfma_f32_16x16x32_bf16 v[172:175], v[28:31], v[36:39], v[172:175]
    ds_read_b128 v[36:39], v8 offset:2048
    s_waitcnt lgkmcnt(7)
    v_mfma_f32_16x16x32_bf16 v[176:179], v[24:27], v[40:43], v[176:179]
    v_mfma_f32_16x16x32_bf16 v[180:183], v[28:31], v[40:43], v[180:183]
    ds_read_b128 v[40:43], v8 offset:4096
    s_waitcnt lgkmcnt(7)
    v_mfma_f32_16x16x32_bf16 v[184:187], v[24:27], v[44:47], v[184:187]
    v_mfma_f32_16x16x32_bf16 v[188:191], v[28:31], v[44:47], v[188:191]
    ds_read_b128 v[44:47], v8 offset:6144
    s_waitcnt lgkmcnt(7)
    v_mfma_f32_16x16x32_bf16 v[192:195], v[24:27], v[48:51], v[192:195]
    v_mfma_f32_16x16x32_bf16 v[196:199], v[28:31], v[48:51], v[196:199]
    ds_read_b128 v[48:51], v8 offset:8192
    s_waitcnt lgkmcnt(7)
    v_mfma_f32_16x16x32_bf16 v[200:203], v[24:27], v[52:55], v[200:203]
    v_mfma_f32_16x16x32_bf16 v[204:207], v[28:31], v[52:55], v[204:207]
    ds_read_b128 v[52:55], v8 offset:10240
    ds_read_b128 v[24:27], v5 offset:49152
    ds_read_b128 v[28:31], v5 offset:51200
    s_barrier
    s_waitcnt lgkmcnt(7)
    v_mfma_f32_16x16x32_bf16 v[208:211], v[16:19], v[32:35], v[208:211]
    v_mfma_f32_16x16x32_bf16 v[212:215], v[20:23], v[32:35], v[212:215]
    ds_read_b128 v[32:35], v9 offset:0
    s_waitcnt lgkmcnt(1)
    v_mfma_f32_16x16x32_bf16 v[216:219], v[16:19], v[36:39], v[216:219]
    s_add_u32 m0, s32, 139264
    s_add_u32 s18, s29, 196608
    buffer_load_dwordx4 v1, s[4:7], s18 offen nt lds
    v_mfma_f32_16x16x32_bf16 v[220:223], v[20:23], v[36:39], v[220:223]
    ds_read_b128 v[36:39], v9 offset:2048
    v_mfma_f32_16x16x32_bf16 v[224:227], v[16:19], v[40:43], v[224:227]
    v_mfma_f32_16x16x32_bf16 v[228:231], v[20:23], v[40:43], v[228:231]
    ds_read_b128 v[40:43], v9 offset:4096
    v_mfma_f32_16x16x32_bf16 v[232:235], v[16:19], v[44:47], v[232:235]
    s_add_u32 m0, s32, 140288
    s_add_u32 s18, s29, 200704
    buffer_load_dwordx4 v2, s[4:7], s18 offen nt lds
    v_mfma_f32_16x16x32_bf16 v[236:239], v[20:23], v[44:47], v[236:239]
    ds_read_b128 v[44:47], v9 offset:6144
    v_mfma_f32_16x16x32_bf16 v[240:243], v[16:19], v[48:51], v[240:243]
    v_mfma_f32_16x16x32_bf16 v[244:247], v[20:23], v[48:51], v[244:247]
    ds_read_b128 v[48:51], v9 offset:8192
    v_mfma_f32_16x16x32_bf16 v[248:251], v[16:19], v[52:55], v[248:251]
    s_add_u32 m0, s32, 141312
    s_add_u32 s18, s29, 204800
    buffer_load_dwordx4 v1, s[4:7], s18 offen nt lds
    v_mfma_f32_16x16x32_bf16 v[252:255], v[20:23], v[52:55], v[252:255]
    ds_read_b128 v[52:55], v9 offset:10240
    s_waitcnt vmcnt(11)
    ds_read_b128 v[16:19], v4 offset:0
    ds_read_b128 v[20:23], v4 offset:2048
    s_waitcnt lgkmcnt(7)
    v_mfma_f32_16x16x32_bf16 v[208:211], v[24:27], v[32:35], v[208:211]
    v_mfma_f32_16x16x32_bf16 v[212:215], v[28:31], v[32:35], v[212:215]
    ds_read_b128 v[32:35], v8 offset:12288
    s_waitcnt lgkmcnt(7)
    v_mfma_f32_16x16x32_bf16 v[216:219], v[24:27], v[36:39], v[216:219]
    s_add_u32 m0, s32, 142336
    s_add_u32 s18, s29, 208896
    buffer_load_dwordx4 v2, s[4:7], s18 offen nt lds
    s_add_u32 s29, s29, 128
    s_and_b32 s29, s29, 511
    v_mfma_f32_16x16x32_bf16 v[220:223], v[28:31], v[36:39], v[220:223]
    ds_read_b128 v[36:39], v8 offset:14336
    s_waitcnt lgkmcnt(7)
    v_mfma_f32_16x16x32_bf16 v[224:227], v[24:27], v[40:43], v[224:227]
    v_mfma_f32_16x16x32_bf16 v[228:231], v[28:31], v[40:43], v[228:231]
    ds_read_b128 v[40:43], v8 offset:16384
    s_waitcnt lgkmcnt(7)
    v_mfma_f32_16x16x32_bf16 v[232:235], v[24:27], v[44:47], v[232:235]
    v_mfma_f32_16x16x32_bf16 v[236:239], v[28:31], v[44:47], v[236:239]
    ds_read_b128 v[44:47], v8 offset:18432
    s_waitcnt lgkmcnt(7)
    v_mfma_f32_16x16x32_bf16 v[240:243], v[24:27], v[48:51], v[240:243]
    v_mfma_f32_16x16x32_bf16 v[244:247], v[28:31], v[48:51], v[244:247]
    ds_read_b128 v[48:51], v8 offset:20480
    s_waitcnt lgkmcnt(7)
    v_mfma_f32_16x16x32_bf16 v[248:251], v[24:27], v[52:55], v[248:251]
    v_mfma_f32_16x16x32_bf16 v[252:255], v[28:31], v[52:55], v[252:255]
    ds_read_b128 v[52:55], v8 offset:22528
    ds_read_b128 v[24:27], v5 offset:0
    ds_read_b128 v[28:31], v5 offset:2048
    v_mov_b32 v11, 0xff800000
    ds_write_b32 v13, v11 offset:0
    ds_write_b32 v13, v11 offset:64
    ds_write_b32 v13, v11 offset:128
    ds_write_b32 v13, v11 offset:192
    ds_write_b32 v13, v11 offset:256
    ds_write_b32 v13, v11 offset:320
    s_waitcnt lgkmcnt(13)
    v_mfma_f32_16x16x32_bf16 v[64:67], v[16:19], v[32:35], v[64:67]
    v_mfma_f32_16x16x32_bf16 v[68:71], v[20:23], v[32:35], v[68:71]
    ds_read_b128 v[32:35], v9 offset:12288
    s_waitcnt lgkmcnt(13)
    v_mfma_f32_16x16x32_bf16 v[72:75], v[16:19], v[36:39], v[72:75]
    v_mfma_f32_16x16x32_bf16 v[76:79], v[20:23], v[36:39], v[76:79]
    ds_read_b128 v[36:39], v9 offset:14336
    s_waitcnt lgkmcnt(13)
    v_mfma_f32_16x16x32_bf16 v[80:83], v[16:19], v[40:43], v[80:83]
    v_mfma_f32_16x16x32_bf16 v[84:87], v[20:23], v[40:43], v[84:87]
    ds_read_b128 v[40:43], v9 offset:16384
    s_waitcnt lgkmcnt(13)
    v_mfma_f32_16x16x32_bf16 v[88:91], v[16:19], v[44:47], v[88:91]
    v_mfma_f32_16x16x32_bf16 v[92:95], v[20:23], v[44:47], v[92:95]
    ds_read_b128 v[44:47], v9 offset:18432
    s_waitcnt lgkmcnt(13)
    v_mfma_f32_16x16x32_bf16 v[96:99], v[16:19], v[48:51], v[96:99]
    v_mfma_f32_16x16x32_bf16 v[100:103], v[20:23], v[48:51], v[100:103]
    ds_read_b128 v[48:51], v9 offset:20480
    s_waitcnt lgkmcnt(13)
    v_mfma_f32_16x16x32_bf16 v[104:107], v[16:19], v[52:55], v[104:107]
    v_mfma_f32_16x16x32_bf16 v[108:111], v[20:23], v[52:55], v[108:111]
    ds_read_b128 v[52:55], v9 offset:22528
    s_waitcnt vmcnt(8)
    ds_read_b128 v[16:19], v4 offset:16384
    ds_read_b128 v[20:23], v4 offset:18432
    s_waitcnt lgkmcnt(7)
    v_mfma_f32_16x16x32_bf16 v[64:67], v[24:27], v[32:35], v[64:67]
    v_mfma_f32_16x16x32_bf16 v[68:71], v[28:31], v[32:35], v[68:71]
    ds_read_b128 v[32:35], v8 offset:12288
    s_waitcnt lgkmcnt(7)
    v_mfma_f32_16x16x32_bf16 v[72:75], v[24:27], v[36:39], v[72:75]
    v_mfma_f32_16x16x32_bf16 v[76:79], v[28:31], v[36:39], v[76:79]
    ds_read_b128 v[36:39], v8 offset:14336
    s_waitcnt lgkmcnt(7)
    v_mfma_f32_16x16x32_bf16 v[80:83], v[24:27], v[40:43], v[80:83]
    v_mfma_f32_16x16x32_bf16 v[84:87], v[28:31], v[40:43], v[84:87]
    ds_read_b128 v[40:43], v8 offset:16384
    s_waitcnt lgkmcnt(7)
    v_mfma_f32_16x16x32_bf16 v[88:91], v[24:27], v[44:47], v[88:91]
    v_mfma_f32_16x16x32_bf16 v[92:95], v[28:31], v[44:47], v[92:95]
    ds_read_b128 v[44:47], v8 offset:18432
    s_waitcnt lgkmcnt(7)
    v_mfma_f32_16x16x32_bf16 v[96:99], v[24:27], v[48:51], v[96:99]
    v_mfma_f32_16x16x32_bf16 v[100:103], v[28:31], v[48:51], v[100:103]
    ds_read_b128 v[48:51], v8 offset:20480
    s_waitcnt lgkmcnt(7)
    v_mfma_f32_16x16x32_bf16 v[104:107], v[24:27], v[52:55], v[104:107]
    v_mfma_f32_16x16x32_bf16 v[108:111], v[28:31], v[52:55], v[108:111]
    ds_read_b128 v[52:55], v8 offset:22528
    ds_read_b128 v[24:27], v5 offset:16384
    ds_read_b128 v[28:31], v5 offset:18432
    s_waitcnt lgkmcnt(0)
    s_barrier
    v_mfma_f32_16x16x32_bf16 v[112:115], v[16:19], v[32:35], v[112:115]
    v_mfma_f32_16x16x32_bf16 v[116:119], v[20:23], v[32:35], v[116:119]
    ds_read_b128 v[32:35], v9 offset:12288
    v_mfma_f32_16x16x32_bf16 v[120:123], v[16:19], v[36:39], v[120:123]
    v_mfma_f32_16x16x32_bf16 v[124:127], v[20:23], v[36:39], v[124:127]
    ds_read_b128 v[36:39], v9 offset:14336
    v_mfma_f32_16x16x32_bf16 v[128:131], v[16:19], v[40:43], v[128:131]
    v_max_f32 v56, v64, v65
    v_max3_f32 v56, v56, v66, v67
    v_max3_f32 v56, v56, v68, v69
    v_max3_f32 v56, v56, v70, v71
    v_mfma_f32_16x16x32_bf16 v[132:135], v[20:23], v[40:43], v[132:135]
    ds_read_b128 v[40:43], v9 offset:16384
    v_mfma_f32_16x16x32_bf16 v[136:139], v[16:19], v[44:47], v[136:139]
    v_max_f32 v57, v72, v73
    v_max3_f32 v57, v57, v74, v75
    v_max3_f32 v57, v57, v76, v77
    v_max3_f32 v57, v57, v78, v79
    v_mfma_f32_16x16x32_bf16 v[140:143], v[20:23], v[44:47], v[140:143]
    ds_read_b128 v[44:47], v9 offset:18432
    v_mfma_f32_16x16x32_bf16 v[144:147], v[16:19], v[48:51], v[144:147]
    v_max_f32 v58, v80, v81
    v_max3_f32 v58, v58, v82, v83
    v_max3_f32 v58, v58, v84, v85
    v_max3_f32 v58, v58, v86, v87
    v_mfma_f32_16x16x32_bf16 v[148:151], v[20:23], v[48:51], v[148:151]
    ds_read_b128 v[48:51], v9 offset:20480
    v_mfma_f32_16x16x32_bf16 v[152:155], v[16:19], v[52:55], v[152:155]
    v_max_f32 v59, v88, v89
    v_max3_f32 v59, v59, v90, v91
    v_max3_f32 v59, v59, v92, v93
    v_max3_f32 v59, v59, v94, v95
    v_mfma_f32_16x16x32_bf16 v[156:159], v[20:23], v[52:55], v[156:159]
    ds_read_b128 v[52:55], v9 offset:22528
    s_waitcnt vmcnt(4)
    ds_read_b128 v[16:19], v4 offset:32768
    ds_read_b128 v[20:23], v4 offset:34816
    s_waitcnt lgkmcnt(7)
    v_mfma_f32_16x16x32_bf16 v[112:115], v[24:27], v[32:35], v[112:115]
    v_max_f32 v60, v96, v97
    v_max3_f32 v60, v60, v98, v99
    v_max3_f32 v60, v60, v100, v101
    v_max3_f32 v60, v60, v102, v103
    v_mfma_f32_16x16x32_bf16 v[116:119], v[28:31], v[32:35], v[116:119]
    ds_read_b128 v[32:35], v8 offset:12288
    s_waitcnt lgkmcnt(7)
    v_mfma_f32_16x16x32_bf16 v[120:123], v[24:27], v[36:39], v[120:123]
    v_max_f32 v61, v104, v105
    v_max3_f32 v61, v61, v106, v107
    v_max3_f32 v61, v61, v108, v109
    v_max3_f32 v61, v61, v110, v111
    v_mfma_f32_16x16x32_bf16 v[124:127], v[28:31], v[36:39], v[124:127]
    ds_read_b128 v[36:39], v8 offset:14336
    s_waitcnt lgkmcnt(7)
    v_mfma_f32_16x16x32_bf16 v[128:131], v[24:27], v[40:43], v[128:131]
    v_mfma_f32_16x16x32_bf16 v[132:135], v[28:31], v[40:43], v[132:135]
    ds_read_b128 v[40:43], v8 offset:16384
    s_waitcnt lgkmcnt(7)
    v_mfma_f32_16x16x32_bf16 v[136:139], v[24:27], v[44:47], v[136:139]
    v_mfma_f32_16x16x32_bf16 v[140:143], v[28:31], v[44:47], v[140:143]
    ds_read_b128 v[44:47], v8 offset:18432
    s_waitcnt lgkmcnt(7)
    v_mfma_f32_16x16x32_bf16 v[144:147], v[24:27], v[48:51], v[144:147]
    v_mfma_f32_16x16x32_bf16 v[148:151], v[28:31], v[48:51], v[148:151]
    ds_read_b128 v[48:51], v8 offset:20480
    s_waitcnt lgkmcnt(7)
    v_mfma_f32_16x16x32_bf16 v[152:155], v[24:27], v[52:55], v[152:155]
    v_mfma_f32_16x16x32_bf16 v[156:159], v[28:31], v[52:55], v[156:159]
    ds_read_b128 v[52:55], v8 offset:22528
    ds_read_b128 v[24:27], v5 offset:32768
    ds_read_b128 v[28:31], v5 offset:34816
    s_waitcnt lgkmcnt(7)
    v_mfma_f32_16x16x32_bf16 v[160:163], v[16:19], v[32:35], v[160:163]
    v_mfma_f32_16x16x32_bf16 v[164:167], v[20:23], v[32:35], v[164:167]
    ds_read_b128 v[32:35], v9 offset:12288
    s_waitcnt lgkmcnt(7)
    v_mfma_f32_16x16x32_bf16 v[168:171], v[16:19], v[36:39], v[168:171]
    v_mfma_f32_16x16x32_bf16 v[172:175], v[20:23], v[36:39], v[172:175]
    ds_read_b128 v[36:39], v9 offset:14336
    s_waitcnt lgkmcnt(7)
    v_mfma_f32_16x16x32_bf16 v[176:179], v[16:19], v[40:43], v[176:179]
    v_max3_f32 v56, v56, v112, v113
    v_max3_f32 v56, v56, v114, v115
    v_max3_f32 v56, v56, v116, v117
    v_max3_f32 v56, v56, v118, v119
    v_mfma_f32_16x16x32_bf16 v[180:183], v[20:23], v[40:43], v[180:183]
    ds_read_b128 v[40:43], v9 offset:16384
    s_waitcnt lgkmcnt(7)
    v_mfma_f32_16x16x32_bf16 v[184:187], v[16:19], v[44:47], v[184:187]
    v_max3_f32 v57, v57, v120, v121
    v_max3_f32 v57, v57, v122, v123
    v_max3_f32 v57, v57, v124, v125
    v_max3_f32 v57, v57, v126, v127
    v_mfma_f32_16x16x32_bf16 v[188:191], v[20:23], v[44:47], v[188:191]
    ds_read_b128 v[44:47], v9 offset:18432
    s_waitcnt lgkmcnt(7)
    v_mfma_f32_16x16x32_bf16 v[192:195], v[16:19], v[48:51], v[192:195]
    v_max3_f32 v58, v58, v128, v129
    v_max3_f32 v58, v58, v130, v131
    v_max3_f32 v58, v58, v132, v133
    v_max3_f32 v58, v58, v134, v135
    v_mfma_f32_16x16x32_bf16 v[196:199], v[20:23], v[48:51], v[196:199]
    ds_read_b128 v[48:51], v9 offset:20480
    s_waitcnt lgkmcnt(7)
    v_mfma_f32_16x16x32_bf16 v[200:203], v[16:19], v[52:55], v[200:203]
    v_max3_f32 v59, v59, v136, v137
    v_max3_f32 v59, v59, v138, v139
    v_max3_f32 v59, v59, v140, v141
    v_max3_f32 v59, v59, v142, v143
    v_mfma_f32_16x16x32_bf16 v[204:207], v[20:23], v[52:55], v[204:207]
    ds_read_b128 v[52:55], v9 offset:22528
    s_waitcnt lgkmcnt(5)
    v_mfma_f32_16x16x32_bf16 v[160:163], v[24:27], v[32:35], v[160:163]
    v_max3_f32 v60, v60, v144, v145
    v_max3_f32 v60, v60, v146, v147
    v_max3_f32 v60, v60, v148, v149
    v_max3_f32 v60, v60, v150, v151
    v_mfma_f32_16x16x32_bf16 v[164:167], v[28:31], v[32:35], v[164:167]
    ds_read_b128 v[32:35], v8 offset:12288
    s_waitcnt lgkmcnt(5)
    v_mfma_f32_16x16x32_bf16 v[168:171], v[24:27], v[36:39], v[168:171]
    v_max3_f32 v61, v61, v152, v153
    v_max3_f32 v61, v61, v154, v155
    v_max3_f32 v61, v61, v156, v157
    v_max3_f32 v61, v61, v158, v159
    v_mfma_f32_16x16x32_bf16 v[172:175], v[28:31], v[36:39], v[172:175]
    ds_read_b128 v[36:39], v8 offset:14336
    s_waitcnt lgkmcnt(5)
    v_mfma_f32_16x16x32_bf16 v[176:179], v[24:27], v[40:43], v[176:179]
    v_mfma_f32_16x16x32_bf16 v[180:183], v[28:31], v[40:43], v[180:183]
    ds_read_b128 v[40:43], v8 offset:16384
    s_waitcnt lgkmcnt(5)
    v_mfma_f32_16x16x32_bf16 v[184:187], v[24:27], v[44:47], v[184:187]
    v_mfma_f32_16x16x32_bf16 v[188:191], v[28:31], v[44:47], v[188:191]
    ds_read_b128 v[44:47], v8 offset:18432
    s_waitcnt lgkmcnt(5)
    v_mfma_f32_16x16x32_bf16 v[192:195], v[24:27], v[48:51], v[192:195]
    v_mfma_f32_16x16x32_bf16 v[196:199], v[28:31], v[48:51], v[196:199]
    ds_read_b128 v[48:51], v8 offset:20480
    s_waitcnt lgkmcnt(5)
    v_mfma_f32_16x16x32_bf16 v[200:203], v[24:27], v[52:55], v[200:203]
    v_mfma_f32_16x16x32_bf16 v[204:207], v[28:31], v[52:55], v[204:207]
    ds_read_b128 v[52:55], v8 offset:22528
    s_waitcnt vmcnt(0)
    ds_read_b128 v[16:19], v4 offset:49152
    ds_read_b128 v[20:23], v4 offset:51200
    ds_read_b128 v[24:27], v5 offset:49152
    ds_read_b128 v[28:31], v5 offset:51200
    s_barrier
    s_waitcnt lgkmcnt(3)
    v_mfma_f32_16x16x32_bf16 v[208:211], v[16:19], v[32:35], v[208:211]
    s_waitcnt lgkmcnt(2)
    v_mfma_f32_16x16x32_bf16 v[212:215], v[20:23], v[32:35], v[212:215]
    ds_read_b128 v[32:35], v9 offset:12288
    v_mfma_f32_16x16x32_bf16 v[216:219], v[16:19], v[36:39], v[216:219]
    v_mfma_f32_16x16x32_bf16 v[220:223], v[20:23], v[36:39], v[220:223]
    ds_read_b128 v[36:39], v9 offset:14336
    v_mfma_f32_16x16x32_bf16 v[224:227], v[16:19], v[40:43], v[224:227]
    v_max3_f32 v56, v56, v160, v161
    v_max3_f32 v56, v56, v162, v163
    v_max3_f32 v56, v56, v164, v165
    v_max3_f32 v56, v56, v166, v167
    v_mfma_f32_16x16x32_bf16 v[228:231], v[20:23], v[40:43], v[228:231]
    ds_read_b128 v[40:43], v9 offset:16384
    v_mfma_f32_16x16x32_bf16 v[232:235], v[16:19], v[44:47], v[232:235]
    v_max3_f32 v57, v57, v168, v169
    v_max3_f32 v57, v57, v170, v171
    v_max3_f32 v57, v57, v172, v173
    v_max3_f32 v57, v57, v174, v175
    v_mfma_f32_16x16x32_bf16 v[236:239], v[20:23], v[44:47], v[236:239]
    ds_read_b128 v[44:47], v9 offset:18432
    v_mfma_f32_16x16x32_bf16 v[240:243], v[16:19], v[48:51], v[240:243]
    v_max3_f32 v58, v58, v176, v177
    v_max3_f32 v58, v58, v178, v179
    v_max3_f32 v58, v58, v180, v181
    v_max3_f32 v58, v58, v182, v183
    v_mfma_f32_16x16x32_bf16 v[244:247], v[20:23], v[48:51], v[244:247]
    ds_read_b128 v[48:51], v9 offset:20480
    v_mfma_f32_16x16x32_bf16 v[248:251], v[16:19], v[52:55], v[248:251]
    v_max3_f32 v59, v59, v184, v185
    v_max3_f32 v59, v59, v186, v187
    v_max3_f32 v59, v59, v188, v189
    v_max3_f32 v59, v59, v190, v191
    v_mfma_f32_16x16x32_bf16 v[252:255], v[20:23], v[52:55], v[252:255]
    ds_read_b128 v[52:55], v9 offset:22528
    s_waitcnt lgkmcnt(5)
    v_mfma_f32_16x16x32_bf16 v[208:211], v[24:27], v[32:35], v[208:211]
    v_max3_f32 v60, v60, v192, v193
    v_max3_f32 v60, v60, v194, v195
    v_max3_f32 v60, v60, v196, v197
    v_max3_f32 v60, v60, v198, v199
    v_mfma_f32_16x16x32_bf16 v[212:215], v[28:31], v[32:35], v[212:215]
    s_waitcnt lgkmcnt(4)
    v_mfma_f32_16x16x32_bf16 v[216:219], v[24:27], v[36:39], v[216:219]
    v_max3_f32 v61, v61, v200, v201
    v_max3_f32 v61, v61, v202, v203
    v_max3_f32 v61, v61, v204, v205
    v_max3_f32 v61, v61, v206, v207
    v_mfma_f32_16x16x32_bf16 v[220:223], v[28:31], v[36:39], v[220:223]
    s_waitcnt lgkmcnt(3)
    v_mfma_f32_16x16x32_bf16 v[224:227], v[24:27], v[40:43], v[224:227]
    v_mfma_f32_16x16x32_bf16 v[228:231], v[28:31], v[40:43], v[228:231]
    s_waitcnt lgkmcnt(2)
    v_mfma_f32_16x16x32_bf16 v[232:235], v[24:27], v[44:47], v[232:235]
    v_mfma_f32_16x16x32_bf16 v[236:239], v[28:31], v[44:47], v[236:239]
    s_waitcnt lgkmcnt(1)
    v_mfma_f32_16x16x32_bf16 v[240:243], v[24:27], v[48:51], v[240:243]
    v_mfma_f32_16x16x32_bf16 v[244:247], v[28:31], v[48:51], v[244:247]
    s_waitcnt lgkmcnt(0)
    v_mfma_f32_16x16x32_bf16 v[248:251], v[24:27], v[52:55], v[248:251]
    v_mfma_f32_16x16x32_bf16 v[252:255], v[28:31], v[52:55], v[252:255]
    v_max3_f32 v56, v56, v208, v209
    v_max3_f32 v56, v56, v210, v211
    v_max3_f32 v56, v56, v212, v213
    v_max3_f32 v56, v56, v214, v215
    ds_max_f32 v13, v56 offset:0
    v_max3_f32 v57, v57, v216, v217
    v_max3_f32 v57, v57, v218, v219
    v_max3_f32 v57, v57, v220, v221
    v_max3_f32 v57, v57, v222, v223
    ds_max_f32 v13, v57 offset:64
    v_max3_f32 v58, v58, v224, v225
    v_max3_f32 v58, v58, v226, v227
    v_max3_f32 v58, v58, v228, v229
    v_max3_f32 v58, v58, v230, v231
    ds_max_f32 v13, v58 offset:128
    v_max3_f32 v59, v59, v232, v233
    v_max3_f32 v59, v59, v234, v235
    v_max3_f32 v59, v59, v236, v237
    v_max3_f32 v59, v59, v238, v239
    ds_max_f32 v13, v59 offset:192
    v_max3_f32 v60, v60, v240, v241
    v_max3_f32 v60, v60, v242, v243
    v_max3_f32 v60, v60, v244, v245
    v_max3_f32 v60, v60, v246, v247
    ds_max_f32 v13, v60 offset:256
    v_max3_f32 v61, v61, v248, v249
    v_max3_f32 v61, v61, v250, v251
    v_max3_f32 v61, v61, v252, v253
    v_max3_f32 v61, v61, v254, v255
    ds_max_f32 v13, v61 offset:320
    s_waitcnt lgkmcnt(0)
    s_barrier
    s_setprio 1
    ds_read_b32 v56, v13 offset:0
    ds_read_b32 v57, v13 offset:64
    ds_read_b32 v58, v13 offset:128
    ds_read_b32 v59, v13 offset:192
    ds_read_b32 v60, v13 offset:256
    ds_read_b32 v61, v13 offset:320
    s_waitcnt lgkmcnt(5)
    v_mul_f32 v56, s20, v56
    v_sub_f32 v40, 0, v56
    s_waitcnt lgkmcnt(4)
    v_mul_f32 v57, s20, v57
    v_sub_f32 v42, 0, v57
    s_waitcnt lgkmcnt(3)
    v_mul_f32 v58, s20, v58
    v_sub_f32 v44, 0, v58
    s_waitcnt lgkmcnt(2)
    v_mul_f32 v59, s20, v59
    v_sub_f32 v46, 0, v59
    s_waitcnt lgkmcnt(1)
    v_mul_f32 v60, s20, v60
    v_sub_f32 v48, 0, v60
    s_waitcnt lgkmcnt(0)
    v_mul_f32 v61, s20, v61
    v_sub_f32 v50, 0, v61
    v_pk_fma_f32 v[64:65], v[64:65], s[20:21], v[40:41] op_sel_hi:[1,0,0]
    v_pk_fma_f32 v[66:67], v[66:67], s[20:21], v[40:41] op_sel_hi:[1,0,0]
    v_pk_fma_f32 v[68:69], v[68:69], s[20:21], v[40:41] op_sel_hi:[1,0,0]
    v_pk_fma_f32 v[70:71], v[70:71], s[20:21], v[40:41] op_sel_hi:[1,0,0]
    v_exp_f32 v64, v64
    v_exp_f32 v65, v65
    v_exp_f32 v66, v66
    v_exp_f32 v67, v67
    v_exp_f32 v68, v68
    v_exp_f32 v69, v69
    v_exp_f32 v70, v70
    v_exp_f32 v71, v71
    v_pk_fma_f32 v[72:73], v[72:73], s[20:21], v[42:43] op_sel_hi:[1,0,0]
    v_pk_fma_f32 v[74:75], v[74:75], s[20:21], v[42:43] op_sel_hi:[1,0,0]
    v_pk_fma_f32 v[76:77], v[76:77], s[20:21], v[42:43] op_sel_hi:[1,0,0]
    v_pk_fma_f32 v[78:79], v[78:79], s[20:21], v[42:43] op_sel_hi:[1,0,0]
    v_exp_f32 v72, v72
    v_exp_f32 v73, v73
    v_exp_f32 v74, v74
    v_exp_f32 v75, v75
    v_exp_f32 v76, v76
    v_exp_f32 v77, v77
    v_exp_f32 v78, v78
    v_exp_f32 v79, v79
    v_cvt_pk_bf16_f32 v16, v64, v65
    v_cvt_pk_bf16_f32 v17, v66, v67
    v_cvt_pk_bf16_f32 v18, v68, v69
    v_cvt_pk_bf16_f32 v19, v70, v71
    ds_write_b128 v10, v[16:19] offset:0
    v_pk_fma_f32 v[80:81], v[80:81], s[20:21], v[44:45] op_sel_hi:[1,0,0]
    v_pk_fma_f32 v[82:83], v[82:83], s[20:21], v[44:45] op_sel_hi:[1,0,0]
    v_pk_fma_f32 v[84:85], v[84:85], s[20:21], v[44:45] op_sel_hi:[1,0,0]
    v_pk_fma_f32 v[86:87], v[86:87], s[20:21], v[44:45] op_sel_hi:[1,0,0]
    v_exp_f32 v80, v80
    v_exp_f32 v81, v81
    v_exp_f32 v82, v82
    v_exp_f32 v83, v83
    v_exp_f32 v84, v84
    v_exp_f32 v85, v85
    v_exp_f32 v86, v86
    v_exp_f32 v87, v87
    v_cvt_pk_bf16_f32 v20, v72, v73
    v_cvt_pk_bf16_f32 v21, v74, v75
    v_cvt_pk_bf16_f32 v22, v76, v77
    v_cvt_pk_bf16_f32 v23, v78, v79
    ds_write_b128 v10, v[20:23] offset:1024
    v_pk_fma_f32 v[88:89], v[88:89], s[20:21], v[46:47] op_sel_hi:[1,0,0]
    v_pk_fma_f32 v[90:91], v[90:91], s[20:21], v[46:47] op_sel_hi:[1,0,0]
    v_pk_fma_f32 v[92:93], v[92:93], s[20:21], v[46:47] op_sel_hi:[1,0,0]
    v_pk_fma_f32 v[94:95], v[94:95], s[20:21], v[46:47] op_sel_hi:[1,0,0]
    v_exp_f32 v88, v88
    v_exp_f32 v89, v89
    v_exp_f32 v90, v90
    v_exp_f32 v91, v91
    v_exp_f32 v92, v92
    v_exp_f32 v93, v93
    v_exp_f32 v94, v94
    v_exp_f32 v95, v95
    v_cvt_pk_bf16_f32 v24, v80, v81
    v_cvt_pk_bf16_f32 v25, v82, v83
    v_cvt_pk_bf16_f32 v26, v84, v85
    v_cvt_pk_bf16_f32 v27, v86, v87
    ds_write_b128 v10, v[24:27] offset:2048
    v_pk_fma_f32 v[96:97], v[96:97], s[20:21], v[48:49] op_sel_hi:[1,0,0]
    v_pk_fma_f32 v[98:99], v[98:99], s[20:21], v[48:49] op_sel_hi:[1,0,0]
    v_pk_fma_f32 v[100:101], v[100:101], s[20:21], v[48:49] op_sel_hi:[1,0,0]
    v_pk_fma_f32 v[102:103], v[102:103], s[20:21], v[48:49] op_sel_hi:[1,0,0]
    v_exp_f32 v96, v96
    v_exp_f32 v97, v97
    v_exp_f32 v98, v98
    v_exp_f32 v99, v99
    v_exp_f32 v100, v100
    v_exp_f32 v101, v101
    v_exp_f32 v102, v102
    v_exp_f32 v103, v103
    v_cvt_pk_bf16_f32 v28, v88, v89
    v_cvt_pk_bf16_f32 v29, v90, v91
    v_cvt_pk_bf16_f32 v30, v92, v93
    v_cvt_pk_bf16_f32 v31, v94, v95
    ds_write_b128 v10, v[28:31] offset:3072
    v_pk_fma_f32 v[104:105], v[104:105], s[20:21], v[50:51] op_sel_hi:[1,0,0]
    v_pk_fma_f32 v[106:107], v[106:107], s[20:21], v[50:51] op_sel_hi:[1,0,0]
    v_pk_fma_f32 v[108:109], v[108:109], s[20:21], v[50:51] op_sel_hi:[1,0,0]
    v_pk_fma_f32 v[110:111], v[110:111], s[20:21], v[50:51] op_sel_hi:[1,0,0]
    v_exp_f32 v104, v104
    v_exp_f32 v105, v105
    v_exp_f32 v106, v106
    v_exp_f32 v107, v107
    v_exp_f32 v108, v108
    v_exp_f32 v109, v109
    v_exp_f32 v110, v110
    v_exp_f32 v111, v111
    v_cvt_pk_bf16_f32 v32, v96, v97
    v_cvt_pk_bf16_f32 v33, v98, v99
    v_cvt_pk_bf16_f32 v34, v100, v101
    v_cvt_pk_bf16_f32 v35, v102, v103
    ds_write_b128 v10, v[32:35] offset:4096
    v_cvt_pk_bf16_f32 v36, v104, v105
    v_cvt_pk_bf16_f32 v37, v106, v107
    v_cvt_pk_bf16_f32 v38, v108, v109
    v_cvt_pk_bf16_f32 v39, v110, v111
    ds_write_b128 v10, v[36:39] offset:5120
    v_pk_add_f32 v[64:65], v[64:65], v[68:69]
    v_pk_add_f32 v[66:67], v[66:67], v[70:71]
    v_pk_add_f32 v[72:73], v[72:73], v[76:77]
    v_pk_add_f32 v[74:75], v[74:75], v[78:79]
    v_pk_add_f32 v[80:81], v[80:81], v[84:85]
    v_pk_add_f32 v[82:83], v[82:83], v[86:87]
    v_pk_add_f32 v[88:89], v[88:89], v[92:93]
    v_pk_add_f32 v[90:91], v[90:91], v[94:95]
    v_pk_add_f32 v[96:97], v[96:97], v[100:101]
    v_pk_add_f32 v[98:99], v[98:99], v[102:103]
    v_pk_add_f32 v[104:105], v[104:105], v[108:109]
    v_pk_add_f32 v[106:107], v[106:107], v[110:111]
    v_pk_add_f32 v[64:65], v[64:65], v[66:67]
    v_pk_add_f32 v[72:73], v[72:73], v[74:75]
    v_pk_add_f32 v[80:81], v[80:81], v[82:83]
    v_pk_add_f32 v[88:89], v[88:89], v[90:91]
    v_pk_add_f32 v[96:97], v[96:97], v[98:99]
    v_pk_add_f32 v[104:105], v[104:105], v[106:107]
    s_waitcnt lgkmcnt(0)
    s_barrier
    v_pk_fma_f32 v[112:113], v[112:113], s[20:21], v[40:41] op_sel_hi:[1,0,0]
    v_pk_fma_f32 v[114:115], v[114:115], s[20:21], v[40:41] op_sel_hi:[1,0,0]
    v_pk_fma_f32 v[116:117], v[116:117], s[20:21], v[40:41] op_sel_hi:[1,0,0]
    v_pk_fma_f32 v[118:119], v[118:119], s[20:21], v[40:41] op_sel_hi:[1,0,0]
    v_exp_f32 v112, v112
    v_exp_f32 v113, v113
    v_exp_f32 v114, v114
    v_exp_f32 v115, v115
    v_exp_f32 v116, v116
    v_exp_f32 v117, v117
    v_exp_f32 v118, v118
    v_exp_f32 v119, v119
    v_pk_fma_f32 v[120:121], v[120:121], s[20:21], v[42:43] op_sel_hi:[1,0,0]
    v_pk_fma_f32 v[122:123], v[122:123], s[20:21], v[42:43] op_sel_hi:[1,0,0]
    v_pk_fma_f32 v[124:125], v[124:125], s[20:21], v[42:43] op_sel_hi:[1,0,0]
    v_pk_fma_f32 v[126:127], v[126:127], s[20:21], v[42:43] op_sel_hi:[1,0,0]
    v_exp_f32 v120, v120
    v_exp_f32 v121, v121
    v_exp_f32 v122, v122
    v_exp_f32 v123, v123
    v_exp_f32 v124, v124
    v_exp_f32 v125, v125
    v_exp_f32 v126, v126
    v_exp_f32 v127, v127
    v_cvt_pk_bf16_f32 v16, v112, v113
    v_cvt_pk_bf16_f32 v17, v114, v115
    v_cvt_pk_bf16_f32 v18, v116, v117
    v_cvt_pk_bf16_f32 v19, v118, v119
    ds_write_b128 v10, v[16:19] offset:24576
    v_pk_fma_f32 v[128:129], v[128:129], s[20:21], v[44:45] op_sel_hi:[1,0,0]
    v_pk_fma_f32 v[130:131], v[130:131], s[20:21], v[44:45] op_sel_hi:[1,0,0]
    v_pk_fma_f32 v[132:133], v[132:133], s[20:21], v[44:45] op_sel_hi:[1,0,0]
    v_pk_fma_f32 v[134:135], v[134:135], s[20:21], v[44:45] op_sel_hi:[1,0,0]
    v_exp_f32 v128, v128
    v_exp_f32 v129, v129
    v_exp_f32 v130, v130
    v_exp_f32 v131, v131
    v_exp_f32 v132, v132
    v_exp_f32 v133, v133
    v_exp_f32 v134, v134
    v_exp_f32 v135, v135
    v_cvt_pk_bf16_f32 v20, v120, v121
    v_cvt_pk_bf16_f32 v21, v122, v123
    v_cvt_pk_bf16_f32 v22, v124, v125
    v_cvt_pk_bf16_f32 v23, v126, v127
    ds_write_b128 v10, v[20:23] offset:25600
    v_pk_fma_f32 v[136:137], v[136:137], s[20:21], v[46:47] op_sel_hi:[1,0,0]
    v_pk_fma_f32 v[138:139], v[138:139], s[20:21], v[46:47] op_sel_hi:[1,0,0]
    v_pk_fma_f32 v[140:141], v[140:141], s[20:21], v[46:47] op_sel_hi:[1,0,0]
    v_pk_fma_f32 v[142:143], v[142:143], s[20:21], v[46:47] op_sel_hi:[1,0,0]
    v_exp_f32 v136, v136
    v_exp_f32 v137, v137
    v_exp_f32 v138, v138
    v_exp_f32 v139, v139
    v_exp_f32 v140, v140
    v_exp_f32 v141, v141
    v_exp_f32 v142, v142
    v_exp_f32 v143, v143
    v_cvt_pk_bf16_f32 v24, v128, v129
    v_cvt_pk_bf16_f32 v25, v130, v131
    v_cvt_pk_bf16_f32 v26, v132, v133
    v_cvt_pk_bf16_f32 v27, v134, v135
    ds_write_b128 v10, v[24:27] offset:26624
    v_pk_fma_f32 v[144:145], v[144:145], s[20:21], v[48:49] op_sel_hi:[1,0,0]
    v_pk_fma_f32 v[146:147], v[146:147], s[20:21], v[48:49] op_sel_hi:[1,0,0]
    v_pk_fma_f32 v[148:149], v[148:149], s[20:21], v[48:49] op_sel_hi:[1,0,0]
    v_pk_fma_f32 v[150:151], v[150:151], s[20:21], v[48:49] op_sel_hi:[1,0,0]
    v_exp_f32 v144, v144
    v_exp_f32 v145, v145
    v_exp_f32 v146, v146
    v_exp_f32 v147, v147
    v_exp_f32 v148, v148
    v_exp_f32 v149, v149
    v_exp_f32 v150, v150
    v_exp_f32 v151, v151
    v_cvt_pk_bf16_f32 v28, v136, v137
    v_cvt_pk_bf16_f32 v29, v138, v139
    v_cvt_pk_bf16_f32 v30, v140, v141
    v_cvt_pk_bf16_f32 v31, v142, v143
    ds_write_b128 v10, v[28:31] offset:27648
    v_pk_fma_f32 v[152:153], v[152:153], s[20:21], v[50:51] op_sel_hi:[1,0,0]
    v_pk_fma_f32 v[154:155], v[154:155], s[20:21], v[50:51] op_sel_hi:[1,0,0]
    v_pk_fma_f32 v[156:157], v[156:157], s[20:21], v[50:51] op_sel_hi:[1,0,0]
    v_pk_fma_f32 v[158:159], v[158:159], s[20:21], v[50:51] op_sel_hi:[1,0,0]
    v_exp_f32 v152, v152
    v_exp_f32 v153, v153
    v_exp_f32 v154, v154
    v_exp_f32 v155, v155
    v_exp_f32 v156, v156
    v_exp_f32 v157, v157
    v_exp_f32 v158, v158
    v_exp_f32 v159, v159
    v_cvt_pk_bf16_f32 v32, v144, v145
    v_cvt_pk_bf16_f32 v33, v146, v147
    v_cvt_pk_bf16_f32 v34, v148, v149
    v_cvt_pk_bf16_f32 v35, v150, v151
    ds_write_b128 v10, v[32:35] offset:28672
    v_cvt_pk_bf16_f32 v36, v152, v153
    v_cvt_pk_bf16_f32 v37, v154, v155
    v_cvt_pk_bf16_f32 v38, v156, v157
    v_cvt_pk_bf16_f32 v39, v158, v159
    ds_write_b128 v10, v[36:39] offset:29696
    v_pk_add_f32 v[112:113], v[112:113], v[116:117]
    v_pk_add_f32 v[114:115], v[114:115], v[118:119]
    v_pk_add_f32 v[120:121], v[120:121], v[124:125]
    v_pk_add_f32 v[122:123], v[122:123], v[126:127]
    v_pk_add_f32 v[128:129], v[128:129], v[132:133]
    v_pk_add_f32 v[130:131], v[130:131], v[134:135]
    v_pk_add_f32 v[136:137], v[136:137], v[140:141]
    v_pk_add_f32 v[138:139], v[138:139], v[142:143]
    v_pk_add_f32 v[144:145], v[144:145], v[148:149]
    v_pk_add_f32 v[146:147], v[146:147], v[150:151]
    v_pk_add_f32 v[152:153], v[152:153], v[156:157]
    v_pk_add_f32 v[154:155], v[154:155], v[158:159]
    v_pk_add_f32 v[112:113], v[112:113], v[114:115]
    v_pk_add_f32 v[120:121], v[120:121], v[122:123]
    v_pk_add_f32 v[128:129], v[128:129], v[130:131]
    v_pk_add_f32 v[136:137], v[136:137], v[138:139]
    v_pk_add_f32 v[144:145], v[144:145], v[146:147]
    v_pk_add_f32 v[152:153], v[152:153], v[154:155]
    v_pk_add_f32 v[64:65], v[64:65], v[112:113]
    v_pk_add_f32 v[72:73], v[72:73], v[120:121]
    v_pk_add_f32 v[80:81], v[80:81], v[128:129]
    v_pk_add_f32 v[88:89], v[88:89], v[136:137]
    v_pk_add_f32 v[96:97], v[96:97], v[144:145]
    v_pk_add_f32 v[104:105], v[104:105], v[152:153]
    s_waitcnt lgkmcnt(0)
    s_barrier
    v_pk_fma_f32 v[160:161], v[160:161], s[20:21], v[40:41] op_sel_hi:[1,0,0]
    v_pk_fma_f32 v[162:163], v[162:163], s[20:21], v[40:41] op_sel_hi:[1,0,0]
    v_pk_fma_f32 v[164:165], v[164:165], s[20:21], v[40:41] op_sel_hi:[1,0,0]
    v_pk_fma_f32 v[166:167], v[166:167], s[20:21], v[40:41] op_sel_hi:[1,0,0]
    v_exp_f32 v160, v160
    v_exp_f32 v161, v161
    v_exp_f32 v162, v162
    v_exp_f32 v163, v163
    v_exp_f32 v164, v164
    v_exp_f32 v165, v165
    v_exp_f32 v166, v166
    v_exp_f32 v167, v167
    v_pk_fma_f32 v[168:169], v[168:169], s[20:21], v[42:43] op_sel_hi:[1,0,0]
    v_pk_fma_f32 v[170:171], v[170:171], s[20:21], v[42:43] op_sel_hi:[1,0,0]
    v_pk_fma_f32 v[172:173], v[172:173], s[20:21], v[42:43] op_sel_hi:[1,0,0]
    v_pk_fma_f32 v[174:175], v[174:175], s[20:21], v[42:43] op_sel_hi:[1,0,0]
    v_exp_f32 v168, v168
    v_exp_f32 v169, v169
    v_exp_f32 v170, v170
    v_exp_f32 v171, v171
    v_exp_f32 v172, v172
    v_exp_f32 v173, v173
    v_exp_f32 v174, v174
    v_exp_f32 v175, v175
    v_cvt_pk_bf16_f32 v16, v160, v161
    v_cvt_pk_bf16_f32 v17, v162, v163
    v_cvt_pk_bf16_f32 v18, v164, v165
    v_cvt_pk_bf16_f32 v19, v166, v167
    ds_write_b128 v10, v[16:19] offset:0
    v_pk_fma_f32 v[176:177], v[176:177], s[20:21], v[44:45] op_sel_hi:[1,0,0]
    v_pk_fma_f32 v[178:179], v[178:179], s[20:21], v[44:45] op_sel_hi:[1,0,0]
    v_pk_fma_f32 v[180:181], v[180:181], s[20:21], v[44:45] op_sel_hi:[1,0,0]
    v_pk_fma_f32 v[182:183], v[182:183], s[20:21], v[44:45] op_sel_hi:[1,0,0]
    v_exp_f32 v176, v176
    v_exp_f32 v177, v177
    v_exp_f32 v178, v178
    v_exp_f32 v179, v179
    v_exp_f32 v180, v180
    v_exp_f32 v181, v181
    v_exp_f32 v182, v182
    v_exp_f32 v183, v183
    v_cvt_pk_bf16_f32 v20, v168, v169
    v_cvt_pk_bf16_f32 v21, v170, v171
    v_cvt_pk_bf16_f32 v22, v172, v173
    v_cvt_pk_bf16_f32 v23, v174, v175
    ds_write_b128 v10, v[20:23] offset:1024
    v_pk_fma_f32 v[184:185], v[184:185], s[20:21], v[46:47] op_sel_hi:[1,0,0]
    v_pk_fma_f32 v[186:187], v[186:187], s[20:21], v[46:47] op_sel_hi:[1,0,0]
    v_pk_fma_f32 v[188:189], v[188:189], s[20:21], v[46:47] op_sel_hi:[1,0,0]
    v_pk_fma_f32 v[190:191], v[190:191], s[20:21], v[46:47] op_sel_hi:[1,0,0]
    v_exp_f32 v184, v184
    v_exp_f32 v185, v185
    v_exp_f32 v186, v186
    v_exp_f32 v187, v187
    v_exp_f32 v188, v188
    v_exp_f32 v189, v189
    v_exp_f32 v190, v190
    v_exp_f32 v191, v191
    v_cvt_pk_bf16_f32 v24, v176, v177
    v_cvt_pk_bf16_f32 v25, v178, v179
    v_cvt_pk_bf16_f32 v26, v180, v181
    v_cvt_pk_bf16_f32 v27, v182, v183
    ds_write_b128 v10, v[24:27] offset:2048
    v_pk_fma_f32 v[192:193], v[192:193], s[20:21], v[48:49] op_sel_hi:[1,0,0]
    v_pk_fma_f32 v[194:195], v[194:195], s[20:21], v[48:49] op_sel_hi:[1,0,0]
    v_pk_fma_f32 v[196:197], v[196:197], s[20:21], v[48:49] op_sel_hi:[1,0,0]
    v_pk_fma_f32 v[198:199], v[198:199], s[20:21], v[48:49] op_sel_hi:[1,0,0]
    v_exp_f32 v192, v192
    v_exp_f32 v193, v193
    v_exp_f32 v194, v194
    v_exp_f32 v195, v195
    v_exp_f32 v196, v196
    v_exp_f32 v197, v197
    v_exp_f32 v198, v198
    v_exp_f32 v199, v199
    v_cvt_pk_bf16_f32 v28, v184, v185
    v_cvt_pk_bf16_f32 v29, v186, v187
    v_cvt_pk_bf16_f32 v30, v188, v189
    v_cvt_pk_bf16_f32 v31, v190, v191
    ds_write_b128 v10, v[28:31] offset:3072
    v_pk_fma_f32 v[200:201], v[200:201], s[20:21], v[50:51] op_sel_hi:[1,0,0]
    v_pk_fma_f32 v[202:203], v[202:203], s[20:21], v[50:51] op_sel_hi:[1,0,0]
    v_pk_fma_f32 v[204:205], v[204:205], s[20:21], v[50:51] op_sel_hi:[1,0,0]
    v_pk_fma_f32 v[206:207], v[206:207], s[20:21], v[50:51] op_sel_hi:[1,0,0]
    v_exp_f32 v200, v200
    v_exp_f32 v201, v201
    v_exp_f32 v202, v202
    v_exp_f32 v203, v203
    v_exp_f32 v204, v204
    v_exp_f32 v205, v205
    v_exp_f32 v206, v206
    v_exp_f32 v207, v207
    v_cvt_pk_bf16_f32 v32, v192, v193
    v_cvt_pk_bf16_f32 v33, v194, v195
    v_cvt_pk_bf16_f32 v34, v196, v197
    v_cvt_pk_bf16_f32 v35, v198, v199
    ds_write_b128 v10, v[32:35] offset:4096
    v_cvt_pk_bf16_f32 v36, v200, v201
    v_cvt_pk_bf16_f32 v37, v202, v203
    v_cvt_pk_bf16_f32 v38, v204, v205
    v_cvt_pk_bf16_f32 v39, v206, v207
    ds_write_b128 v10, v[36:39] offset:5120
    v_pk_add_f32 v[160:161], v[160:161], v[164:165]
    v_pk_add_f32 v[162:163], v[162:163], v[166:167]
    v_pk_add_f32 v[168:169], v[168:169], v[172:173]
    v_pk_add_f32 v[170:171], v[170:171], v[174:175]
    v_pk_add_f32 v[176:177], v[176:177], v[180:181]
    v_pk_add_f32 v[178:179], v[178:179], v[182:183]
    v_pk_add_f32 v[184:185], v[184:185], v[188:189]
    v_pk_add_f32 v[186:187], v[186:187], v[190:191]
    v_pk_add_f32 v[192:193], v[192:193], v[196:197]
    v_pk_add_f32 v[194:195], v[194:195], v[198:199]
    v_pk_add_f32 v[200:201], v[200:201], v[204:205]
    v_pk_add_f32 v[202:203], v[202:203], v[206:207]
    v_pk_add_f32 v[160:161], v[160:161], v[162:163]
    v_pk_add_f32 v[168:169], v[168:169], v[170:171]
    v_pk_add_f32 v[176:177], v[176:177], v[178:179]
    v_pk_add_f32 v[184:185], v[184:185], v[186:187]
    v_pk_add_f32 v[192:193], v[192:193], v[194:195]
    v_pk_add_f32 v[200:201], v[200:201], v[202:203]
    v_pk_add_f32 v[64:65], v[64:65], v[160:161]
    v_pk_add_f32 v[72:73], v[72:73], v[168:169]
    v_pk_add_f32 v[80:81], v[80:81], v[176:177]
    v_pk_add_f32 v[88:89], v[88:89], v[184:185]
    v_pk_add_f32 v[96:97], v[96:97], v[192:193]
    v_pk_add_f32 v[104:105], v[104:105], v[200:201]
    s_waitcnt lgkmcnt(0)
    s_barrier
    v_pk_fma_f32 v[208:209], v[208:209], s[20:21], v[40:41] op_sel_hi:[1,0,0]
    v_pk_fma_f32 v[210:211], v[210:211], s[20:21], v[40:41] op_sel_hi:[1,0,0]
    v_pk_fma_f32 v[212:213], v[212:213], s[20:21], v[40:41] op_sel_hi:[1,0,0]
    v_pk_fma_f32 v[214:215], v[214:215], s[20:21], v[40:41] op_sel_hi:[1,0,0]
    v_exp_f32 v208, v208
    v_exp_f32 v209, v209
    v_exp_f32 v210, v210
    v_exp_f32 v211, v211
    v_exp_f32 v212, v212
    v_exp_f32 v213, v213
    v_exp_f32 v214, v214
    v_exp_f32 v215, v215
    v_pk_fma_f32 v[216:217], v[216:217], s[20:21], v[42:43] op_sel_hi:[1,0,0]
    v_pk_fma_f32 v[218:219], v[218:219], s[20:21], v[42:43] op_sel_hi:[1,0,0]
    v_pk_fma_f32 v[220:221], v[220:221], s[20:21], v[42:43] op_sel_hi:[1,0,0]
    v_pk_fma_f32 v[222:223], v[222:223], s[20:21], v[42:43] op_sel_hi:[1,0,0]
    v_exp_f32 v216, v216
    v_exp_f32 v217, v217
    v_exp_f32 v218, v218
    v_exp_f32 v219, v219
    v_exp_f32 v220, v220
    v_exp_f32 v221, v221
    v_exp_f32 v222, v222
    v_exp_f32 v223, v223
    v_cvt_pk_bf16_f32 v16, v208, v209
    v_cvt_pk_bf16_f32 v17, v210, v211
    v_cvt_pk_bf16_f32 v18, v212, v213
    v_cvt_pk_bf16_f32 v19, v214, v215
    ds_write_b128 v10, v[16:19] offset:24576
    v_pk_fma_f32 v[224:225], v[224:225], s[20:21], v[44:45] op_sel_hi:[1,0,0]
    v_pk_fma_f32 v[226:227], v[226:227], s[20:21], v[44:45] op_sel_hi:[1,0,0]
    v_pk_fma_f32 v[228:229], v[228:229], s[20:21], v[44:45] op_sel_hi:[1,0,0]
    v_pk_fma_f32 v[230:231], v[230:231], s[20:21], v[44:45] op_sel_hi:[1,0,0]
    v_exp_f32 v224, v224
    v_exp_f32 v225, v225
    v_exp_f32 v226, v226
    v_exp_f32 v227, v227
    v_exp_f32 v228, v228
    v_exp_f32 v229, v229
    v_exp_f32 v230, v230
    v_exp_f32 v231, v231
    v_cvt_pk_bf16_f32 v20, v216, v217
    v_cvt_pk_bf16_f32 v21, v218, v219
    v_cvt_pk_bf16_f32 v22, v220, v221
    v_cvt_pk_bf16_f32 v23, v222, v223
    ds_write_b128 v10, v[20:23] offset:25600
    v_pk_fma_f32 v[232:233], v[232:233], s[20:21], v[46:47] op_sel_hi:[1,0,0]
    v_pk_fma_f32 v[234:235], v[234:235], s[20:21], v[46:47] op_sel_hi:[1,0,0]
    v_pk_fma_f32 v[236:237], v[236:237], s[20:21], v[46:47] op_sel_hi:[1,0,0]
    v_pk_fma_f32 v[238:239], v[238:239], s[20:21], v[46:47] op_sel_hi:[1,0,0]
    v_exp_f32 v232, v232
    v_exp_f32 v233, v233
    v_exp_f32 v234, v234
    v_exp_f32 v235, v235
    v_exp_f32 v236, v236
    v_exp_f32 v237, v237
    v_exp_f32 v238, v238
    v_exp_f32 v239, v239
    v_cvt_pk_bf16_f32 v24, v224, v225
    v_cvt_pk_bf16_f32 v25, v226, v227
    v_cvt_pk_bf16_f32 v26, v228, v229
    v_cvt_pk_bf16_f32 v27, v230, v231
    ds_write_b128 v10, v[24:27] offset:26624
    v_pk_fma_f32 v[240:241], v[240:241], s[20:21], v[48:49] op_sel_hi:[1,0,0]
    v_pk_fma_f32 v[242:243], v[242:243], s[20:21], v[48:49] op_sel_hi:[1,0,0]
    v_pk_fma_f32 v[244:245], v[244:245], s[20:21], v[48:49] op_sel_hi:[1,0,0]
    v_pk_fma_f32 v[246:247], v[246:247], s[20:21], v[48:49] op_sel_hi:[1,0,0]
    v_exp_f32 v240, v240
    v_exp_f32 v241, v241
    v_exp_f32 v242, v242
    v_exp_f32 v243, v243
    v_exp_f32 v244, v244
    v_exp_f32 v245, v245
    v_exp_f32 v246, v246
    v_exp_f32 v247, v247
    v_cvt_pk_bf16_f32 v28, v232, v233
    v_cvt_pk_bf16_f32 v29, v234, v235
    v_cvt_pk_bf16_f32 v30, v236, v237
    v_cvt_pk_bf16_f32 v31, v238, v239
    ds_write_b128 v10, v[28:31] offset:27648
    v_pk_fma_f32 v[248:249], v[248:249], s[20:21], v[50:51] op_sel_hi:[1,0,0]
    v_pk_fma_f32 v[250:251], v[250:251], s[20:21], v[50:51] op_sel_hi:[1,0,0]
    v_pk_fma_f32 v[252:253], v[252:253], s[20:21], v[50:51] op_sel_hi:[1,0,0]
    v_pk_fma_f32 v[254:255], v[254:255], s[20:21], v[50:51] op_sel_hi:[1,0,0]
    v_exp_f32 v248, v248
    v_exp_f32 v249, v249
    v_exp_f32 v250, v250
    v_exp_f32 v251, v251
    v_exp_f32 v252, v252
    v_exp_f32 v253, v253
    v_exp_f32 v254, v254
    v_exp_f32 v255, v255
    v_cvt_pk_bf16_f32 v32, v240, v241
    v_cvt_pk_bf16_f32 v33, v242, v243
    v_cvt_pk_bf16_f32 v34, v244, v245
    v_cvt_pk_bf16_f32 v35, v246, v247
    ds_write_b128 v10, v[32:35] offset:28672
    v_cvt_pk_bf16_f32 v36, v248, v249
    v_cvt_pk_bf16_f32 v37, v250, v251
    v_cvt_pk_bf16_f32 v38, v252, v253
    v_cvt_pk_bf16_f32 v39, v254, v255
    ds_write_b128 v10, v[36:39] offset:29696
    v_pk_add_f32 v[208:209], v[208:209], v[212:213]
    v_pk_add_f32 v[210:211], v[210:211], v[214:215]
    v_pk_add_f32 v[216:217], v[216:217], v[220:221]
    v_pk_add_f32 v[218:219], v[218:219], v[222:223]
    v_pk_add_f32 v[224:225], v[224:225], v[228:229]
    v_pk_add_f32 v[226:227], v[226:227], v[230:231]
    v_pk_add_f32 v[232:233], v[232:233], v[236:237]
    v_pk_add_f32 v[234:235], v[234:235], v[238:239]
    v_pk_add_f32 v[240:241], v[240:241], v[244:245]
    v_pk_add_f32 v[242:243], v[242:243], v[246:247]
    v_pk_add_f32 v[248:249], v[248:249], v[252:253]
    v_pk_add_f32 v[250:251], v[250:251], v[254:255]
    v_pk_add_f32 v[208:209], v[208:209], v[210:211]
    v_pk_add_f32 v[216:217], v[216:217], v[218:219]
    v_pk_add_f32 v[224:225], v[224:225], v[226:227]
    v_pk_add_f32 v[232:233], v[232:233], v[234:235]
    v_pk_add_f32 v[240:241], v[240:241], v[242:243]
    v_pk_add_f32 v[248:249], v[248:249], v[250:251]
    v_pk_add_f32 v[64:65], v[64:65], v[208:209]
    v_pk_add_f32 v[72:73], v[72:73], v[216:217]
    v_pk_add_f32 v[80:81], v[80:81], v[224:225]
    v_pk_add_f32 v[88:89], v[88:89], v[232:233]
    v_pk_add_f32 v[96:97], v[96:97], v[240:241]
    v_pk_add_f32 v[104:105], v[104:105], v[248:249]
    v_add_f32 v64, v64, v65
    ds_write_b32 v12, v64 offset:0
    v_add_f32 v72, v72, v73
    ds_write_b32 v12, v72 offset:1024
    v_add_f32 v80, v80, v81
    ds_write_b32 v12, v80 offset:2048
    v_add_f32 v88, v88, v89
    ds_write_b32 v12, v88 offset:3072
    v_add_f32 v96, v96, v97
    ds_write_b32 v12, v96 offset:4096
    v_add_f32 v104, v104, v105
    ds_write_b32 v12, v104 offset:5120
    s_waitcnt lgkmcnt(0)
    s_barrier
    s_setprio 0
    v_bfe_u32 v14, v0, 2, 4
    v_lshlrev_b32 v5, 7, v14
    v_bfe_u32 v14, v0, 3, 2
    v_bfe_u32 v15, v0, 6, 2
    v_xor_b32 v14, v14, v15
    v_lshl_add_u32 v5, v14, 5, v5
    v_and_b32 v14, 3, v0
    v_lshl_add_u32 v5, v14, 3, v5
    v_and_b32 v14, 63, v0
    v_lshlrev_b32 v6, 4, v14
    v_lshlrev_b32 v7, 4, v0
    s_mul_i32 s94, s22, 21
    s_add_u32 s95, s94, 21
    s_lshr_b32 s94, s94, 2
    s_lshr_b32 s95, s95, 2
    s_sub_u32 s95, s95, s94
    s_lshl_b32 s94, s94, 10
    s_lshl_b32 s95, s95, 10
    s_sub_u32 s94, s94, s17
    v_lshlrev_b32 v8, 9, v6
    s_add_u32 m0, s17, 147456
    s_add_u32 s18, s30, s31
    buffer_load_dwordx4 v3, s[8:11], s18 offen lds
    s_add_u32 m0, s17, 151552
    s_add_u32 s18, s18, 28672
    buffer_load_dwordx4 v3, s[8:11], s18 offen lds
    s_add_u32 s31, s31, 128
    s_cmp_eq_u32 s31, 896
    s_cselect_b32 s31, 0, s31
    s_add_u32 m0, s17, 139264
    s_add_u32 s18, s30, s31
    buffer_load_dwordx4 v3, s[8:11], s18 offen lds
    s_add_u32 m0, s17, 143360
    s_add_u32 s18, s18, 28672
    buffer_load_dwordx4 v3, s[8:11], s18 offen lds
    s_add_u32 s31, s31, 128
    s_cmp_eq_u32 s31, 896
    s_cselect_b32 s31, 0, s31
    s_barrier
    ds_read_b128 v[16:19], v6 offset:0
    ds_read_b128 v[20:23], v6 offset:1024
    ds_read_b128 v[24:27], v6 offset:2048
    ds_read_b128 v[28:31], v6 offset:3072
    ds_read_b128 v[32:35], v6 offset:4096
    ds_read_b128 v[36:39], v6 offset:5120
    ds_read_b128 v[40:43], v6 offset:6144
    ds_read_b128 v[44:47], v6 offset:7168
    ds_read_b128 v[48:51], v6 offset:8192
    ds_read_b128 v[52:55], v6 offset:9216
    ds_read_b128 v[56:59], v6 offset:10240
    ds_read_b128 v[60:63], v6 offset:11264
    s_add_u32 m0, s17, 131072
    s_add_u32 s18, s30, s31
    buffer_load_dwordx4 v3, s[8:11], s18 offen lds
    s_add_u32 m0, s17, 135168
    s_add_u32 s18, s18, 28672
    buffer_load_dwordx4 v3, s[8:11], s18 offen lds
    s_add_u32 s31, s31, 128
    s_cmp_eq_u32 s31, 896
    s_cselect_b32 s31, 0, s31
    s_add_u32 m0, s17, 122880
    s_add_u32 s18, s30, s31
    buffer_load_dwordx4 v3, s[8:11], s18 offen lds
    s_add_u32 m0, s17, 126976
    s_add_u32 s18, s18, 28672
    buffer_load_dwordx4 v3, s[8:11], s18 offen lds
    s_add_u32 s31, s31, 128
    s_cmp_eq_u32 s31, 896
    s_cselect_b32 s31, 0, s31
    s_waitcnt vmcnt(4) lgkmcnt(0)
    s_barrier
    v_add_u32 v14, 147456, v5
    ds_read_b64_tr_b16 v[232:233], v14 offset:0
    ds_read_b64_tr_b16 v[234:235], v14 offset:2048
    ds_read_b64_tr_b16 v[236:237], v14 offset:4096
    ds_read_b64_tr_b16 v[238:239], v14 offset:6144
    s_waitcnt lgkmcnt(2)
    v_mfma_f32_16x16x32_bf16 v[64:67], v[232:235], v[16:19], 0
    v_add_u32 v15, 139264, v5
    v_mfma_f32_16x16x32_bf16 v[68:71], v[232:235], v[20:23], 0
    ds_read_b64_tr_b16 v[240:241], v15 offset:0
    v_mfma_f32_16x16x32_bf16 v[72:75], v[232:235], v[24:27], 0
    ds_read_b64_tr_b16 v[242:243], v15 offset:2048
    v_mfma_f32_16x16x32_bf16 v[76:79], v[232:235], v[28:31], 0
    ds_read_b64_tr_b16 v[244:245], v15 offset:4096
    v_mfma_f32_16x16x32_bf16 v[80:83], v[232:235], v[32:35], 0
    ds_read_b64_tr_b16 v[246:247], v15 offset:6144
    v_mfma_f32_16x16x32_bf16 v[84:87], v[232:235], v[36:39], 0
    s_add_u32 m0, s17, 155648
    s_add_u32 s18, s30, s31
    buffer_load_dwordx4 v3, s[8:11], s18 offen lds
    s_waitcnt lgkmcnt(4)
    v_mfma_f32_16x16x32_bf16 v[64:67], v[236:239], v[40:43], v[64:67]
    v_mfma_f32_16x16x32_bf16 v[68:71], v[236:239], v[44:47], v[68:71]
    v_mfma_f32_16x16x32_bf16 v[72:75], v[236:239], v[48:51], v[72:75]
    s_add_u32 m0, s17, 159744
    s_add_u32 s18, s18, 28672
    buffer_load_dwordx4 v3, s[8:11], s18 offen lds
    s_add_u32 s31, s31, 128
    s_cmp_eq_u32 s31, 896
    s_cselect_b32 s31, 0, s31
    v_mfma_f32_16x16x32_bf16 v[76:79], v[236:239], v[52:55], v[76:79]
    v_mfma_f32_16x16x32_bf16 v[80:83], v[236:239], v[56:59], v[80:83]
    v_mfma_f32_16x16x32_bf16 v[84:87], v[236:239], v[60:63], v[84:87]
    s_add_u32 m0, s17, 114688
    s_add_u32 s18, s30, s31
    buffer_load_dwordx4 v3, s[8:11], s18 offen lds
    s_add_u32 m0, s17, 118784
    s_add_u32 s18, s18, 28672
    buffer_load_dwordx4 v3, s[8:11], s18 offen lds
    s_add_u32 s31, s31, 128
    s_cmp_eq_u32 s31, 896
    s_cselect_b32 s31, 0, s31
    s_waitcnt vmcnt(4) lgkmcnt(0)
    s_barrier
    v_mfma_f32_16x16x32_bf16 v[88:91], v[240:243], v[16:19], 0
    v_add_u32 v14, 131072, v5
    v_mfma_f32_16x16x32_bf16 v[92:95], v[240:243], v[20:23], 0
    ds_read_b64_tr_b16 v[232:233], v14 offset:0
    v_mfma_f32_16x16x32_bf16 v[96:99], v[240:243], v[24:27], 0
    ds_read_b64_tr_b16 v[234:235], v14 offset:2048
    v_mfma_f32_16x16x32_bf16 v[100:103], v[240:243], v[28:31], 0
    ds_read_b64_tr_b16 v[236:237], v14 offset:4096
    v_mfma_f32_16x16x32_bf16 v[104:107], v[240:243], v[32:35], 0
    ds_read_b64_tr_b16 v[238:239], v14 offset:6144
    v_mfma_f32_16x16x32_bf16 v[108:111], v[240:243], v[36:39], 0
    s_add_u32 m0, s17, 147456
    s_add_u32 s18, s30, s31
    buffer_load_dwordx4 v3, s[8:11], s18 offen lds
    v_mfma_f32_16x16x32_bf16 v[88:91], v[244:247], v[40:43], v[88:91]
    v_mfma_f32_16x16x32_bf16 v[92:95], v[244:247], v[44:47], v[92:95]
    v_mfma_f32_16x16x32_bf16 v[96:99], v[244:247], v[48:51], v[96:99]
    s_add_u32 m0, s17, 151552
    s_add_u32 s18, s18, 28672
    buffer_load_dwordx4 v3, s[8:11], s18 offen lds
    s_add_u32 s31, s31, 128
    s_cmp_eq_u32 s31, 896
    s_cselect_b32 s31, 0, s31
    s_add_u32 s30, s30, 57344
    s_cmp_eq_u32 s30, 229376
    s_cselect_b32 s30, 0, s30
    v_mfma_f32_16x16x32_bf16 v[100:103], v[244:247], v[52:55], v[100:103]
    v_mfma_f32_16x16x32_bf16 v[104:107], v[244:247], v[56:59], v[104:107]
    v_mfma_f32_16x16x32_bf16 v[108:111], v[244:247], v[60:63], v[108:111]
    s_add_u32 m0, s17, 139264
    s_add_u32 s18, s30, s31
    buffer_load_dwordx4 v3, s[8:11], s18 offen lds
    s_waitcnt lgkmcnt(2)
    v_mfma_f32_16x16x32_bf16 v[112:115], v[232:235], v[16:19], 0
    v_add_u32 v15, 122880, v5
    v_mfma_f32_16x16x32_bf16 v[116:119], v[232:235], v[20:23], 0
    ds_read_b64_tr_b16 v[240:241], v15 offset:0
    v_mfma_f32_16x16x32_bf16 v[120:123], v[232:235], v[24:27], 0
    ds_read_b64_tr_b16 v[242:243], v15 offset:2048
    v_mfma_f32_16x16x32_bf16 v[124:127], v[232:235], v[28:31], 0
    ds_read_b64_tr_b16 v[244:245], v15 offset:4096
    v_mfma_f32_16x16x32_bf16 v[128:131], v[232:235], v[32:35], 0
    ds_read_b64_tr_b16 v[246:247], v15 offset:6144
    v_mfma_f32_16x16x32_bf16 v[132:135], v[232:235], v[36:39], 0
    s_add_u32 m0, s17, 143360
    s_add_u32 s18, s18, 28672
    buffer_load_dwordx4 v3, s[8:11], s18 offen lds
    s_add_u32 s31, s31, 128
    s_cmp_eq_u32 s31, 896
    s_cselect_b32 s31, 0, s31
    s_waitcnt lgkmcnt(4)
    v_mfma_f32_16x16x32_bf16 v[112:115], v[236:239], v[40:43], v[112:115]
    v_mfma_f32_16x16x32_bf16 v[116:119], v[236:239], v[44:47], v[116:119]
    v_mfma_f32_16x16x32_bf16 v[120:123], v[236:239], v[48:51], v[120:123]
    v_mfma_f32_16x16x32_bf16 v[124:127], v[236:239], v[52:55], v[124:127]
    v_mfma_f32_16x16x32_bf16 v[128:131], v[236:239], v[56:59], v[128:131]
    v_mfma_f32_16x16x32_bf16 v[132:135], v[236:239], v[60:63], v[132:135]
    s_waitcnt vmcnt(4) lgkmcnt(0)
    s_barrier
    v_mfma_f32_16x16x32_bf16 v[136:139], v[240:243], v[16:19], 0
    v_add_u32 v14, 155648, v5
    v_mfma_f32_16x16x32_bf16 v[140:143], v[240:243], v[20:23], 0
    ds_read_b64_tr_b16 v[232:233], v14 offset:0
    v_mfma_f32_16x16x32_bf16 v[144:147], v[240:243], v[24:27], 0
    ds_read_b64_tr_b16 v[234:235], v14 offset:2048
    v_mfma_f32_16x16x32_bf16 v[148:151], v[240:243], v[28:31], 0
    ds_read_b64_tr_b16 v[236:237], v14 offset:4096
    v_mfma_f32_16x16x32_bf16 v[152:155], v[240:243], v[32:35], 0
    ds_read_b64_tr_b16 v[238:239], v14 offset:6144
    v_mfma_f32_16x16x32_bf16 v[156:159], v[240:243], v[36:39], 0
    s_add_u32 m0, s17, 131072
    s_add_u32 s18, s30, s31
    buffer_load_dwordx4 v3, s[8:11], s18 offen lds
    v_mfma_f32_16x16x32_bf16 v[136:139], v[244:247], v[40:43], v[136:139]
    v_mfma_f32_16x16x32_bf16 v[140:143], v[244:247], v[44:47], v[140:143]
    v_mfma_f32_16x16x32_bf16 v[144:147], v[244:247], v[48:51], v[144:147]
    s_add_u32 m0, s17, 135168
    s_add_u32 s18, s18, 28672
    buffer_load_dwordx4 v3, s[8:11], s18 offen lds
    s_add_u32 s31, s31, 128
    s_cmp_eq_u32 s31, 896
    s_cselect_b32 s31, 0, s31
    v_mfma_f32_16x16x32_bf16 v[148:151], v[244:247], v[52:55], v[148:151]
    v_mfma_f32_16x16x32_bf16 v[152:155], v[244:247], v[56:59], v[152:155]
    v_mfma_f32_16x16x32_bf16 v[156:159], v[244:247], v[60:63], v[156:159]
    s_add_u32 m0, s17, 122880
    s_add_u32 s18, s30, s31
    buffer_load_dwordx4 v3, s[8:11], s18 offen lds
    s_waitcnt lgkmcnt(2)
    v_mfma_f32_16x16x32_bf16 v[160:163], v[232:235], v[16:19], 0
    v_add_u32 v15, 114688, v5
    v_mfma_f32_16x16x32_bf16 v[164:167], v[232:235], v[20:23], 0
    ds_read_b64_tr_b16 v[240:241], v15 offset:0
    v_mfma_f32_16x16x32_bf16 v[168:171], v[232:235], v[24:27], 0
    ds_read_b64_tr_b16 v[242:243], v15 offset:2048
    v_mfma_f32_16x16x32_bf16 v[172:175], v[232:235], v[28:31], 0
    ds_read_b64_tr_b16 v[244:245], v15 offset:4096
    v_mfma_f32_16x16x32_bf16 v[176:179], v[232:235], v[32:35], 0
    ds_read_b64_tr_b16 v[246:247], v15 offset:6144
    v_mfma_f32_16x16x32_bf16 v[180:183], v[232:235], v[36:39], 0
    s_add_u32 m0, s17, 126976
    s_add_u32 s18, s18, 28672
    buffer_load_dwordx4 v3, s[8:11], s18 offen lds
    s_add_u32 s31, s31, 128
    s_cmp_eq_u32 s31, 896
    s_cselect_b32 s31, 0, s31
    s_waitcnt lgkmcnt(4)
    v_mfma_f32_16x16x32_bf16 v[160:163], v[236:239], v[40:43], v[160:163]
    v_mfma_f32_16x16x32_bf16 v[164:167], v[236:239], v[44:47], v[164:167]
    v_mfma_f32_16x16x32_bf16 v[168:171], v[236:239], v[48:51], v[168:171]
    v_mfma_f32_16x16x32_bf16 v[172:175], v[236:239], v[52:55], v[172:175]
    v_mfma_f32_16x16x32_bf16 v[176:179], v[236:239], v[56:59], v[176:179]
    v_mfma_f32_16x16x32_bf16 v[180:183], v[236:239], v[60:63], v[180:183]
    s_waitcnt vmcnt(6) lgkmcnt(0)
    s_barrier
    v_mfma_f32_16x16x32_bf16 v[184:187], v[240:243], v[16:19], 0
    v_add_u32 v14, 147456, v5
    v_mfma_f32_16x16x32_bf16 v[188:191], v[240:243], v[20:23], 0
    ds_read_b64_tr_b16 v[232:233], v14 offset:0
    v_mfma_f32_16x16x32_bf16 v[192:195], v[240:243], v[24:27], 0
    ds_read_b64_tr_b16 v[234:235], v14 offset:2048
    v_mfma_f32_16x16x32_bf16 v[196:199], v[240:243], v[28:31], 0
    ds_read_b64_tr_b16 v[236:237], v14 offset:4096
    v_mfma_f32_16x16x32_bf16 v[200:203], v[240:243], v[32:35], 0
    ds_read_b64_tr_b16 v[238:239], v14 offset:6144
    v_mfma_f32_16x16x32_bf16 v[204:207], v[240:243], v[36:39], 0
    s_add_u32 m0, s17, 155648
    s_add_u32 s18, s30, s31
    buffer_load_dwordx4 v3, s[8:11], s18 offen lds
    v_mfma_f32_16x16x32_bf16 v[184:187], v[244:247], v[40:43], v[184:187]
    v_mfma_f32_16x16x32_bf16 v[188:191], v[244:247], v[44:47], v[188:191]
    v_mfma_f32_16x16x32_bf16 v[192:195], v[244:247], v[48:51], v[192:195]
    s_add_u32 m0, s17, 159744
    s_add_u32 s18, s18, 28672
    buffer_load_dwordx4 v3, s[8:11], s18 offen lds
    s_add_u32 s31, s31, 128
    s_cmp_eq_u32 s31, 896
    s_cselect_b32 s31, 0, s31
    v_mfma_f32_16x16x32_bf16 v[196:199], v[244:247], v[52:55], v[196:199]
    v_mfma_f32_16x16x32_bf16 v[200:203], v[244:247], v[56:59], v[200:203]
    v_mfma_f32_16x16x32_bf16 v[204:207], v[244:247], v[60:63], v[204:207]
    s_add_u32 m0, s17, 114688
    s_add_u32 s18, s30, s31
    buffer_load_dwordx4 v3, s[8:11], s18 offen lds
    s_add_u32 m0, s17, 118784
    s_add_u32 s18, s18, 28672
    buffer_load_dwordx4 v3, s[8:11], s18 offen lds
    s_add_u32 s31, s31, 128
    s_cmp_eq_u32 s31, 896
    s_cselect_b32 s31, 0, s31
    s_waitcnt vmcnt(8) lgkmcnt(0)
    s_barrier
    v_add_u32 v15, 139264, v5
    ds_read_b64_tr_b16 v[240:241], v15 offset:0
    ds_read_b64_tr_b16 v[242:243], v15 offset:2048
    ds_read_b64_tr_b16 v[244:245], v15 offset:4096
    ds_read_b64_tr_b16 v[246:247], v15 offset:6144
    v_mfma_f32_16x16x32_bf16 v[208:211], v[232:235], v[16:19], 0
    ds_read_b128 v[16:19], v6 offset:12288
    v_mfma_f32_16x16x32_bf16 v[212:215], v[232:235], v[20:23], 0
    ds_read_b128 v[20:23], v6 offset:13312
    v_mfma_f32_16x16x32_bf16 v[216:219], v[232:235], v[24:27], 0
    ds_read_b128 v[24:27], v6 offset:14336
    s_add_u32 m0, s17, 147456
    s_add_u32 s18, s30, s31
    buffer_load_dwordx4 v3, s[8:11], s18 offen lds
    v_mfma_f32_16x16x32_bf16 v[220:223], v[232:235], v[28:31], 0
    ds_read_b128 v[28:31], v6 offset:15360
    v_mfma_f32_16x16x32_bf16 v[224:227], v[232:235], v[32:35], 0
    ds_read_b128 v[32:35], v6 offset:16384
    v_mfma_f32_16x16x32_bf16 v[228:231], v[232:235], v[36:39], 0
    ds_read_b128 v[36:39], v6 offset:17408
    s_add_u32 m0, s17, 151552
    s_add_u32 s18, s18, 28672
    buffer_load_dwordx4 v3, s[8:11], s18 offen lds
    s_add_u32 s31, s31, 128
    s_cmp_eq_u32 s31, 896
    s_cselect_b32 s31, 0, s31
    v_mfma_f32_16x16x32_bf16 v[208:211], v[236:239], v[40:43], v[208:211]
    ds_read_b128 v[40:43], v6 offset:18432
    v_mfma_f32_16x16x32_bf16 v[212:215], v[236:239], v[44:47], v[212:215]
    ds_read_b128 v[44:47], v6 offset:19456
    v_mfma_f32_16x16x32_bf16 v[216:219], v[236:239], v[48:51], v[216:219]
    ds_read_b128 v[48:51], v6 offset:20480
    s_add_u32 m0, s17, 106496
    s_add_u32 s18, s30, s31
    buffer_load_dwordx4 v3, s[8:11], s18 offen lds
    v_mfma_f32_16x16x32_bf16 v[220:223], v[236:239], v[52:55], v[220:223]
    ds_read_b128 v[52:55], v6 offset:21504
    v_mfma_f32_16x16x32_bf16 v[224:227], v[236:239], v[56:59], v[224:227]
    ds_read_b128 v[56:59], v6 offset:22528
    v_mfma_f32_16x16x32_bf16 v[228:231], v[236:239], v[60:63], v[228:231]
    ds_read_b128 v[60:63], v6 offset:23552
    s_add_u32 m0, s17, 110592
    s_add_u32 s18, s18, 28672
    buffer_load_dwordx4 v3, s[8:11], s18 offen lds
    s_add_u32 s31, s31, 128
    s_cmp_eq_u32 s31, 896
    s_cselect_b32 s31, 0, s31
    s_add_u32 s30, s30, 57344
    s_cmp_eq_u32 s30, 229376
    s_cselect_b32 s30, 0, s30
    s_waitcnt vmcnt(10) lgkmcnt(0)
    s_barrier
    v_mfma_f32_16x16x32_bf16 v[64:67], v[240:243], v[16:19], v[64:67]
    v_add_u32 v14, 131072, v5
    v_mfma_f32_16x16x32_bf16 v[68:71], v[240:243], v[20:23], v[68:71]
    ds_read_b64_tr_b16 v[232:233], v14 offset:0
    v_mfma_f32_16x16x32_bf16 v[72:75], v[240:243], v[24:27], v[72:75]
    ds_read_b64_tr_b16 v[234:235], v14 offset:2048
    v_mfma_f32_16x16x32_bf16 v[76:79], v[240:243], v[28:31], v[76:79]
    ds_read_b64_tr_b16 v[236:237], v14 offset:4096
    v_mfma_f32_16x16x32_bf16 v[80:83], v[240:243], v[32:35], v[80:83]
    ds_read_b64_tr_b16 v[238:239], v14 offset:6144
    v_mfma_f32_16x16x32_bf16 v[84:87], v[240:243], v[36:39], v[84:87]
    s_add_u32 m0, s17, 139264
    s_add_u32 s18, s30, s31
    buffer_load_dwordx4 v3, s[8:11], s18 offen lds
    v_mfma_f32_16x16x32_bf16 v[64:67], v[244:247], v[40:43], v[64:67]
    v_mfma_f32_16x16x32_bf16 v[68:71], v[244:247], v[44:47], v[68:71]
    v_mfma_f32_16x16x32_bf16 v[72:75], v[244:247], v[48:51], v[72:75]
    s_add_u32 m0, s17, 143360
    s_add_u32 s18, s18, 28672
    buffer_load_dwordx4 v3, s[8:11], s18 offen lds
    s_add_u32 s31, s31, 128
    s_cmp_eq_u32 s31, 896
    s_cselect_b32 s31, 0, s31
    v_mfma_f32_16x16x32_bf16 v[76:79], v[244:247], v[52:55], v[76:79]
    v_mfma_f32_16x16x32_bf16 v[80:83], v[244:247], v[56:59], v[80:83]
    v_mfma_f32_16x16x32_bf16 v[84:87], v[244:247], v[60:63], v[84:87]
    s_add_u32 m0, s17, 98304
    s_add_u32 s18, s30, s31
    buffer_load_dwordx4 v3, s[8:11], s18 offen lds
    s_add_u32 m0, s17, 102400
    s_add_u32 s18, s18, 28672
    buffer_load_dwordx4 v3, s[8:11], s18 offen lds
    s_add_u32 s31, s31, 128
    s_cmp_eq_u32 s31, 896
    s_cselect_b32 s31, 0, s31
    s_waitcnt vmcnt(12) lgkmcnt(0)
    s_barrier
    v_mfma_f32_16x16x32_bf16 v[88:91], v[232:235], v[16:19], v[88:91]
    v_add_u32 v15, 122880, v5
    v_mfma_f32_16x16x32_bf16 v[92:95], v[232:235], v[20:23], v[92:95]
    ds_read_b64_tr_b16 v[240:241], v15 offset:0
    v_mfma_f32_16x16x32_bf16 v[96:99], v[232:235], v[24:27], v[96:99]
    ds_read_b64_tr_b16 v[242:243], v15 offset:2048
    v_mfma_f32_16x16x32_bf16 v[100:103], v[232:235], v[28:31], v[100:103]
    ds_read_b64_tr_b16 v[244:245], v15 offset:4096
    v_mfma_f32_16x16x32_bf16 v[104:107], v[232:235], v[32:35], v[104:107]
    ds_read_b64_tr_b16 v[246:247], v15 offset:6144
    v_mfma_f32_16x16x32_bf16 v[108:111], v[232:235], v[36:39], v[108:111]
    s_add_u32 m0, s17, 131072
    s_add_u32 s18, s30, s31
    buffer_load_dwordx4 v3, s[8:11], s18 offen lds
    v_mfma_f32_16x16x32_bf16 v[88:91], v[236:239], v[40:43], v[88:91]
    v_mfma_f32_16x16x32_bf16 v[92:95], v[236:239], v[44:47], v[92:95]
    v_mfma_f32_16x16x32_bf16 v[96:99], v[236:239], v[48:51], v[96:99]
    s_add_u32 m0, s17, 135168
    s_add_u32 s18, s18, 28672
    buffer_load_dwordx4 v3, s[8:11], s18 offen lds
    s_add_u32 s31, s31, 128
    s_cmp_eq_u32 s31, 896
    s_cselect_b32 s31, 0, s31
    v_mfma_f32_16x16x32_bf16 v[100:103], v[236:239], v[52:55], v[100:103]
    v_mfma_f32_16x16x32_bf16 v[104:107], v[236:239], v[56:59], v[104:107]
    v_mfma_f32_16x16x32_bf16 v[108:111], v[236:239], v[60:63], v[108:111]
    s_add_u32 m0, s17, 90112
    s_add_u32 s18, s30, s31
    buffer_load_dwordx4 v3, s[8:11], s18 offen lds
    s_add_u32 m0, s17, 94208
    s_add_u32 s18, s18, 28672
    buffer_load_dwordx4 v3, s[8:11], s18 offen lds
    s_add_u32 s31, s31, 128
    s_cmp_eq_u32 s31, 896
    s_cselect_b32 s31, 0, s31
    s_waitcnt vmcnt(14) lgkmcnt(0)
    s_barrier
    v_mfma_f32_16x16x32_bf16 v[112:115], v[240:243], v[16:19], v[112:115]
    v_add_u32 v14, 155648, v5
    v_mfma_f32_16x16x32_bf16 v[116:119], v[240:243], v[20:23], v[116:119]
    ds_read_b64_tr_b16 v[232:233], v14 offset:0
    v_mfma_f32_16x16x32_bf16 v[120:123], v[240:243], v[24:27], v[120:123]
    ds_read_b64_tr_b16 v[234:235], v14 offset:2048
    v_mfma_f32_16x16x32_bf16 v[124:127], v[240:243], v[28:31], v[124:127]
    ds_read_b64_tr_b16 v[236:237], v14 offset:4096
    v_mfma_f32_16x16x32_bf16 v[128:131], v[240:243], v[32:35], v[128:131]
    ds_read_b64_tr_b16 v[238:239], v14 offset:6144
    v_mfma_f32_16x16x32_bf16 v[132:135], v[240:243], v[36:39], v[132:135]
    s_add_u32 m0, s17, 122880
    s_add_u32 s18, s30, s31
    buffer_load_dwordx4 v3, s[8:11], s18 offen lds
    v_mfma_f32_16x16x32_bf16 v[112:115], v[244:247], v[40:43], v[112:115]
    v_mfma_f32_16x16x32_bf16 v[116:119], v[244:247], v[44:47], v[116:119]
    v_mfma_f32_16x16x32_bf16 v[120:123], v[244:247], v[48:51], v[120:123]
    s_add_u32 m0, s17, 126976
    s_add_u32 s18, s18, 28672
    buffer_load_dwordx4 v3, s[8:11], s18 offen lds
    s_add_u32 s31, s31, 128
    s_cmp_eq_u32 s31, 896
    s_cselect_b32 s31, 0, s31
    v_mfma_f32_16x16x32_bf16 v[124:127], v[244:247], v[52:55], v[124:127]
    v_mfma_f32_16x16x32_bf16 v[128:131], v[244:247], v[56:59], v[128:131]
    v_mfma_f32_16x16x32_bf16 v[132:135], v[244:247], v[60:63], v[132:135]
    s_add_u32 m0, s17, 81920
    s_add_u32 s18, s30, s31
    buffer_load_dwordx4 v3, s[8:11], s18 offen lds
    s_add_u32 m0, s17, 86016
    s_add_u32 s18, s18, 28672
    buffer_load_dwordx4 v3, s[8:11], s18 offen lds
    s_add_u32 s31, s31, 128
    s_cmp_eq_u32 s31, 896
    s_cselect_b32 s31, 0, s31
    s_waitcnt vmcnt(16) lgkmcnt(0)
    s_barrier
    v_mfma_f32_16x16x32_bf16 v[136:139], v[232:235], v[16:19], v[136:139]
    v_add_u32 v15, 114688, v5
    v_mfma_f32_16x16x32_bf16 v[140:143], v[232:235], v[20:23], v[140:143]
    ds_read_b64_tr_b16 v[240:241], v15 offset:0
    v_mfma_f32_16x16x32_bf16 v[144:147], v[232:235], v[24:27], v[144:147]
    ds_read_b64_tr_b16 v[242:243], v15 offset:2048
    v_mfma_f32_16x16x32_bf16 v[148:151], v[232:235], v[28:31], v[148:151]
    ds_read_b64_tr_b16 v[244:245], v15 offset:4096
    v_mfma_f32_16x16x32_bf16 v[152:155], v[232:235], v[32:35], v[152:155]
    ds_read_b64_tr_b16 v[246:247], v15 offset:6144
    v_mfma_f32_16x16x32_bf16 v[156:159], v[232:235], v[36:39], v[156:159]
    s_add_u32 m0, s17, 155648
    s_add_u32 s18, s30, s31
    buffer_load_dwordx4 v3, s[8:11], s18 offen lds
    v_mfma_f32_16x16x32_bf16 v[136:139], v[236:239], v[40:43], v[136:139]
    v_mfma_f32_16x16x32_bf16 v[140:143], v[236:239], v[44:47], v[140:143]
    v_mfma_f32_16x16x32_bf16 v[144:147], v[236:239], v[48:51], v[144:147]
    s_add_u32 m0, s17, 159744
    s_add_u32 s18, s18, 28672
    buffer_load_dwordx4 v3, s[8:11], s18 offen lds
    s_add_u32 s31, s31, 128
    s_cmp_eq_u32 s31, 896
    s_cselect_b32 s31, 0, s31
    s_add_u32 s30, s30, 57344
    s_cmp_eq_u32 s30, 229376
    s_cselect_b32 s30, 0, s30
    v_mfma_f32_16x16x32_bf16 v[148:151], v[236:239], v[52:55], v[148:151]
    v_mfma_f32_16x16x32_bf16 v[152:155], v[236:239], v[56:59], v[152:155]
    v_mfma_f32_16x16x32_bf16 v[156:159], v[236:239], v[60:63], v[156:159]
    s_add_u32 m0, s17, 49152
    s_add_u32 s18, s30, s31
    buffer_load_dwordx4 v3, s[8:11], s18 offen lds
    s_add_u32 m0, s17, 53248
    s_add_u32 s18, s18, 28672
    buffer_load_dwordx4 v3, s[8:11], s18 offen lds
    s_add_u32 s31, s31, 128
    s_cmp_eq_u32 s31, 896
    s_cselect_b32 s31, 0, s31
    s_waitcnt vmcnt(18) lgkmcnt(0)
    s_barrier
    v_mfma_f32_16x16x32_bf16 v[160:163], v[240:243], v[16:19], v[160:163]
    v_add_u32 v14, 147456, v5
    v_mfma_f32_16x16x32_bf16 v[164:167], v[240:243], v[20:23], v[164:167]
    ds_read_b64_tr_b16 v[232:233], v14 offset:0
    v_mfma_f32_16x16x32_bf16 v[168:171], v[240:243], v[24:27], v[168:171]
    ds_read_b64_tr_b16 v[234:235], v14 offset:2048
    v_mfma_f32_16x16x32_bf16 v[172:175], v[240:243], v[28:31], v[172:175]
    ds_read_b64_tr_b16 v[236:237], v14 offset:4096
    v_mfma_f32_16x16x32_bf16 v[176:179], v[240:243], v[32:35], v[176:179]
    ds_read_b64_tr_b16 v[238:239], v14 offset:6144
    v_mfma_f32_16x16x32_bf16 v[180:183], v[240:243], v[36:39], v[180:183]
    s_add_u32 m0, s17, 114688
    s_add_u32 s18, s30, s31
    buffer_load_dwordx4 v3, s[8:11], s18 offen lds
    v_mfma_f32_16x16x32_bf16 v[160:163], v[244:247], v[40:43], v[160:163]
    v_mfma_f32_16x16x32_bf16 v[164:167], v[244:247], v[44:47], v[164:167]
    v_mfma_f32_16x16x32_bf16 v[168:171], v[244:247], v[48:51], v[168:171]
    s_add_u32 m0, s17, 118784
    s_add_u32 s18, s18, 28672
    buffer_load_dwordx4 v3, s[8:11], s18 offen lds
    s_add_u32 s31, s31, 128
    s_cmp_eq_u32 s31, 896
    s_cselect_b32 s31, 0, s31
    v_mfma_f32_16x16x32_bf16 v[172:175], v[244:247], v[52:55], v[172:175]
    v_mfma_f32_16x16x32_bf16 v[176:179], v[244:247], v[56:59], v[176:179]
    v_mfma_f32_16x16x32_bf16 v[180:183], v[244:247], v[60:63], v[180:183]
    s_add_u32 m0, s17, 57344
    s_add_u32 s18, s30, s31
    buffer_load_dwordx4 v3, s[8:11], s18 offen lds
    s_add_u32 m0, s17, 61440
    s_add_u32 s18, s18, 28672
    buffer_load_dwordx4 v3, s[8:11], s18 offen lds
    s_add_u32 s31, s31, 128
    s_cmp_eq_u32 s31, 896
    s_cselect_b32 s31, 0, s31
    s_add_u32 m0, s17, 24576
    s_add_u32 s18, s30, s31
    buffer_load_dwordx4 v3, s[8:11], s18 offen lds
    s_add_u32 m0, s17, 28672
    s_add_u32 s18, s18, 28672
    buffer_load_dwordx4 v3, s[8:11], s18 offen lds
    s_add_u32 s31, s31, 128
    s_cmp_eq_u32 s31, 896
    s_cselect_b32 s31, 0, s31
    s_waitcnt vmcnt(22) lgkmcnt(0)
    s_barrier
    v_mfma_f32_16x16x32_bf16 v[184:187], v[232:235], v[16:19], v[184:187]
    v_add_u32 v15, 106496, v5
    v_mfma_f32_16x16x32_bf16 v[188:191], v[232:235], v[20:23], v[188:191]
    ds_read_b64_tr_b16 v[240:241], v15 offset:0
    v_mfma_f32_16x16x32_bf16 v[192:195], v[232:235], v[24:27], v[192:195]
    ds_read_b64_tr_b16 v[242:243], v15 offset:2048
    v_mfma_f32_16x16x32_bf16 v[196:199], v[232:235], v[28:31], v[196:199]
    ds_read_b64_tr_b16 v[244:245], v15 offset:4096
    v_mfma_f32_16x16x32_bf16 v[200:203], v[232:235], v[32:35], v[200:203]
    ds_read_b64_tr_b16 v[246:247], v15 offset:6144
    v_mfma_f32_16x16x32_bf16 v[204:207], v[232:235], v[36:39], v[204:207]
    s_add_u32 m0, s17, 147456
    s_add_u32 s18, s30, s31
    buffer_load_dwordx4 v3, s[8:11], s18 offen lds
    v_mfma_f32_16x16x32_bf16 v[184:187], v[236:239], v[40:43], v[184:187]
    v_mfma_f32_16x16x32_bf16 v[188:191], v[236:239], v[44:47], v[188:191]
    v_mfma_f32_16x16x32_bf16 v[192:195], v[236:239], v[48:51], v[192:195]
    s_add_u32 m0, s17, 151552
    s_add_u32 s18, s18, 28672
    buffer_load_dwordx4 v3, s[8:11], s18 offen lds
    s_add_u32 s31, s31, 128
    s_cmp_eq_u32 s31, 896
    s_cselect_b32 s31, 0, s31
    v_mfma_f32_16x16x32_bf16 v[196:199], v[236:239], v[52:55], v[196:199]
    v_mfma_f32_16x16x32_bf16 v[200:203], v[236:239], v[56:59], v[200:203]
    v_mfma_f32_16x16x32_bf16 v[204:207], v[236:239], v[60:63], v[204:207]
    s_add_u32 m0, s17, 65536
    s_add_u32 s18, s30, s31
    buffer_load_dwordx4 v3, s[8:11], s18 offen lds
    s_add_u32 m0, s17, 69632
    s_add_u32 s18, s18, 28672
    buffer_load_dwordx4 v3, s[8:11], s18 offen lds
    s_add_u32 s31, s31, 128
    s_cmp_eq_u32 s31, 896
    s_cselect_b32 s31, 0, s31
    s_add_u32 m0, s17, 32768
    s_add_u32 s18, s30, s31
    buffer_load_dwordx4 v3, s[8:11], s18 offen lds
    s_add_u32 m0, s17, 36864
    s_add_u32 s18, s18, 28672
    buffer_load_dwordx4 v3, s[8:11], s18 offen lds
    s_add_u32 s31, s31, 128
    s_cmp_eq_u32 s31, 896
    s_cselect_b32 s31, 0, s31
    s_add_u32 s30, s30, 57344
    s_cmp_eq_u32 s30, 229376
    s_cselect_b32 s30, 0, s30
    s_waitcnt vmcnt(24) lgkmcnt(0)
    s_barrier
    v_add_u32 v14, 139264, v5
    ds_read_b64_tr_b16 v[232:233], v14 offset:0
    ds_read_b64_tr_b16 v[234:235], v14 offset:2048
    ds_read_b64_tr_b16 v[236:237], v14 offset:4096
    ds_read_b64_tr_b16 v[238:239], v14 offset:6144
    v_mfma_f32_16x16x32_bf16 v[208:211], v[240:243], v[16:19], v[208:211]
    ds_read_b128 v[16:19], v6 offset:0
    v_mfma_f32_16x16x32_bf16 v[212:215], v[240:243], v[20:23], v[212:215]
    ds_read_b128 v[20:23], v6 offset:1024
    v_mfma_f32_16x16x32_bf16 v[216:219], v[240:243], v[24:27], v[216:219]
    ds_read_b128 v[24:27], v6 offset:2048
    v_mfma_f32_16x16x32_bf16 v[220:223], v[240:243], v[28:31], v[220:223]
    ds_read_b128 v[28:31], v6 offset:3072
    v_mfma_f32_16x16x32_bf16 v[224:227], v[240:243], v[32:35], v[224:227]
    ds_read_b128 v[32:35], v6 offset:4096
    v_mfma_f32_16x16x32_bf16 v[228:231], v[240:243], v[36:39], v[228:231]
    ds_read_b128 v[36:39], v6 offset:5120
    v_mfma_f32_16x16x32_bf16 v[208:211], v[244:247], v[40:43], v[208:211]
    ds_read_b128 v[40:43], v6 offset:6144
    v_mfma_f32_16x16x32_bf16 v[212:215], v[244:247], v[44:47], v[212:215]
    ds_read_b128 v[44:47], v6 offset:7168
    v_mfma_f32_16x16x32_bf16 v[216:219], v[244:247], v[48:51], v[216:219]
    ds_read_b128 v[48:51], v6 offset:8192
    v_mfma_f32_16x16x32_bf16 v[220:223], v[244:247], v[52:55], v[220:223]
    ds_read_b128 v[52:55], v6 offset:9216
    v_mfma_f32_16x16x32_bf16 v[224:227], v[244:247], v[56:59], v[224:227]
    ds_read_b128 v[56:59], v6 offset:10240
    v_mfma_f32_16x16x32_bf16 v[228:231], v[244:247], v[60:63], v[228:231]
    ds_read_b128 v[60:63], v6 offset:11264
    s_waitcnt lgkmcnt(11)
    v_mfma_f32_16x16x32_bf16 v[64:67], v[232:235], v[16:19], v[64:67]
    v_add_u32 v15, 98304, v5
    s_waitcnt lgkmcnt(10)
    v_mfma_f32_16x16x32_bf16 v[68:71], v[232:235], v[20:23], v[68:71]
    ds_read_b64_tr_b16 v[240:241], v15 offset:0
    s_waitcnt lgkmcnt(10)
    v_mfma_f32_16x16x32_bf16 v[72:75], v[232:235], v[24:27], v[72:75]
    ds_read_b64_tr_b16 v[242:243], v15 offset:2048
    s_waitcnt lgkmcnt(10)
    v_mfma_f32_16x16x32_bf16 v[76:79], v[232:235], v[28:31], v[76:79]
    ds_read_b64_tr_b16 v[244:245], v15 offset:4096
    s_waitcnt lgkmcnt(10)
    v_mfma_f32_16x16x32_bf16 v[80:83], v[232:235], v[32:35], v[80:83]
    ds_read_b64_tr_b16 v[246:247], v15 offset:6144
    s_waitcnt lgkmcnt(10)
    v_mfma_f32_16x16x32_bf16 v[84:87], v[232:235], v[36:39], v[84:87]
    s_waitcnt lgkmcnt(9)
    v_mfma_f32_16x16x32_bf16 v[64:67], v[236:239], v[40:43], v[64:67]
    s_waitcnt lgkmcnt(8)
    v_mfma_f32_16x16x32_bf16 v[68:71], v[236:239], v[44:47], v[68:71]
    s_waitcnt lgkmcnt(7)
    v_mfma_f32_16x16x32_bf16 v[72:75], v[236:239], v[48:51], v[72:75]
    s_waitcnt lgkmcnt(6)
    v_mfma_f32_16x16x32_bf16 v[76:79], v[236:239], v[52:55], v[76:79]
    s_waitcnt lgkmcnt(5)
    v_mfma_f32_16x16x32_bf16 v[80:83], v[236:239], v[56:59], v[80:83]
    s_waitcnt lgkmcnt(4)
    v_mfma_f32_16x16x32_bf16 v[84:87], v[236:239], v[60:63], v[84:87]
    s_waitcnt vmcnt(0) lgkmcnt(0)
    s_barrier
    v_add_u32 v15, 49152, v5
    ds_read_b64_tr_b16 v[232:233], v15 offset:0
    ds_read_b64_tr_b16 v[234:235], v15 offset:2048
    ds_read_b64_tr_b16 v[236:237], v15 offset:4096
    ds_read_b64_tr_b16 v[238:239], v15 offset:6144
    v_mfma_f32_16x16x32_bf16 v[88:91], v[240:243], v[16:19], v[88:91]
    ds_read_b128 v[16:19], v6 offset:12288
    v_mfma_f32_16x16x32_bf16 v[92:95], v[240:243], v[20:23], v[92:95]
    ds_read_b128 v[20:23], v6 offset:13312
    v_mfma_f32_16x16x32_bf16 v[96:99], v[240:243], v[24:27], v[96:99]
    ds_read_b128 v[24:27], v6 offset:14336
    v_mfma_f32_16x16x32_bf16 v[100:103], v[240:243], v[28:31], v[100:103]
    ds_read_b128 v[28:31], v6 offset:15360
    v_mfma_f32_16x16x32_bf16 v[104:107], v[240:243], v[32:35], v[104:107]
    ds_read_b128 v[32:35], v6 offset:16384
    v_mfma_f32_16x16x32_bf16 v[108:111], v[240:243], v[36:39], v[108:111]
    ds_read_b128 v[36:39], v6 offset:17408
    v_mfma_f32_16x16x32_bf16 v[88:91], v[244:247], v[40:43], v[88:91]
    ds_read_b128 v[40:43], v6 offset:18432
    v_mfma_f32_16x16x32_bf16 v[92:95], v[244:247], v[44:47], v[92:95]
    ds_read_b128 v[44:47], v6 offset:19456
    v_mfma_f32_16x16x32_bf16 v[96:99], v[244:247], v[48:51], v[96:99]
    ds_read_b128 v[48:51], v6 offset:20480
    v_mfma_f32_16x16x32_bf16 v[100:103], v[244:247], v[52:55], v[100:103]
    ds_read_b128 v[52:55], v6 offset:21504
    v_mfma_f32_16x16x32_bf16 v[104:107], v[244:247], v[56:59], v[104:107]
    ds_read_b128 v[56:59], v6 offset:22528
    v_mfma_f32_16x16x32_bf16 v[108:111], v[244:247], v[60:63], v[108:111]
    ds_read_b128 v[60:63], v6 offset:23552
    v_add_u32 v14, 114688, v5
    ds_read_b64_tr_b16 v[240:241], v14 offset:0
    ds_read_b64_tr_b16 v[242:243], v14 offset:2048
    ds_read_b64_tr_b16 v[244:245], v14 offset:4096
    ds_read_b64_tr_b16 v[246:247], v14 offset:6144
    s_waitcnt lgkmcnt(15)
    v_mfma_f32_16x16x32_bf16 v[64:67], v[232:235], v[16:19], v[64:67]
    v_add_u32 v15, 57344, v5
    s_waitcnt lgkmcnt(14)
    v_mfma_f32_16x16x32_bf16 v[68:71], v[232:235], v[20:23], v[68:71]
    ds_read_b64_tr_b16 v[248:249], v15 offset:0
    s_waitcnt lgkmcnt(14)
    v_mfma_f32_16x16x32_bf16 v[72:75], v[232:235], v[24:27], v[72:75]
    ds_read_b64_tr_b16 v[250:251], v15 offset:2048
    s_waitcnt lgkmcnt(14)
    v_mfma_f32_16x16x32_bf16 v[76:79], v[232:235], v[28:31], v[76:79]
    ds_read_b64_tr_b16 v[252:253], v15 offset:4096
    s_waitcnt lgkmcnt(14)
    v_mfma_f32_16x16x32_bf16 v[80:83], v[232:235], v[32:35], v[80:83]
    ds_read_b64_tr_b16 v[254:255], v15 offset:6144
    s_waitcnt lgkmcnt(14)
    v_mfma_f32_16x16x32_bf16 v[84:87], v[232:235], v[36:39], v[84:87]
    s_waitcnt lgkmcnt(13)
    v_mfma_f32_16x16x32_bf16 v[64:67], v[236:239], v[40:43], v[64:67]
    s_waitcnt lgkmcnt(12)
    v_mfma_f32_16x16x32_bf16 v[68:71], v[236:239], v[44:47], v[68:71]
    s_waitcnt lgkmcnt(11)
    v_mfma_f32_16x16x32_bf16 v[72:75], v[236:239], v[48:51], v[72:75]
    s_waitcnt lgkmcnt(10)
    v_mfma_f32_16x16x32_bf16 v[76:79], v[236:239], v[52:55], v[76:79]
    s_waitcnt lgkmcnt(9)
    v_mfma_f32_16x16x32_bf16 v[80:83], v[236:239], v[56:59], v[80:83]
    s_waitcnt lgkmcnt(8)
    v_mfma_f32_16x16x32_bf16 v[84:87], v[236:239], v[60:63], v[84:87]
    s_waitcnt lgkmcnt(6)
    v_mfma_f32_16x16x32_bf16 v[88:91], v[240:243], v[16:19], v[88:91]
    v_add_u32 v14, 24576, v5
    v_mfma_f32_16x16x32_bf16 v[92:95], v[240:243], v[20:23], v[92:95]
    ds_read_b64_tr_b16 v[232:233], v14 offset:0
    v_mfma_f32_16x16x32_bf16 v[96:99], v[240:243], v[24:27], v[96:99]
    ds_read_b64_tr_b16 v[234:235], v14 offset:2048
    v_cvt_pk_bf16_f32 v64, v64, v65
    v_cvt_pk_bf16_f32 v65, v66, v67
    v_mfma_f32_16x16x32_bf16 v[100:103], v[240:243], v[28:31], v[100:103]
    ds_read_b64_tr_b16 v[236:237], v14 offset:4096
    v_cvt_pk_bf16_f32 v66, v68, v69
    v_cvt_pk_bf16_f32 v67, v70, v71
    v_mfma_f32_16x16x32_bf16 v[104:107], v[240:243], v[32:35], v[104:107]
    ds_read_b64_tr_b16 v[238:239], v14 offset:6144
    s_sub_u32 s19, s33, s94
    s_cmp_lt_u32 s19, s95
    s_cbranch_scc1 L_ow0_0
    buffer_store_dwordx4 v[64:67], v7, s[12:15], s33 offen sc1
L_ow0_0_r:
    s_add_u32 s33, s33, 4096
    v_mfma_f32_16x16x32_bf16 v[108:111], v[240:243], v[36:39], v[108:111]
    v_cvt_pk_bf16_f32 v72, v72, v73
    v_cvt_pk_bf16_f32 v73, v74, v75
    s_waitcnt lgkmcnt(8)
    v_mfma_f32_16x16x32_bf16 v[88:91], v[244:247], v[40:43], v[88:91]
    v_cvt_pk_bf16_f32 v74, v76, v77
    v_cvt_pk_bf16_f32 v75, v78, v79
    v_mfma_f32_16x16x32_bf16 v[92:95], v[244:247], v[44:47], v[92:95]
    s_sub_u32 s19, s33, s94
    s_cmp_lt_u32 s19, s95
    s_cbranch_scc1 L_ow0_1
    buffer_store_dwordx4 v[72:75], v7, s[12:15], s33 offen sc1
L_ow0_1_r:
    s_add_u32 s33, s33, 4096
    v_mfma_f32_16x16x32_bf16 v[96:99], v[244:247], v[48:51], v[96:99]
    v_cvt_pk_bf16_f32 v80, v80, v81
    v_cvt_pk_bf16_f32 v81, v82, v83
    v_mfma_f32_16x16x32_bf16 v[100:103], v[244:247], v[52:55], v[100:103]
    v_cvt_pk_bf16_f32 v82, v84, v85
    v_cvt_pk_bf16_f32 v83, v86, v87
    v_mfma_f32_16x16x32_bf16 v[104:107], v[244:247], v[56:59], v[104:107]
    s_sub_u32 s19, s33, s94
    s_cmp_lt_u32 s19, s95
    s_cbranch_scc1 L_ow0_2
    buffer_store_dwordx4 v[80:83], v7, s[12:15], s33 offen sc1
L_ow0_2_r:
    s_add_u32 s33, s33, 4096
    s_cmp_eq_u32 s33, 86016
    s_cselect_b32 s33, 0, s33
    v_mfma_f32_16x16x32_bf16 v[108:111], v[244:247], v[60:63], v[108:111]
    s_nop 1
    ds_read_b128 v[64:67], v6 offset:0
    ds_read_b128 v[68:71], v6 offset:1024
    ds_read_b128 v[72:75], v6 offset:2048
    ds_read_b128 v[76:79], v6 offset:3072
    ds_read_b128 v[80:83], v6 offset:4096
    ds_read_b128 v[84:87], v6 offset:5120
    s_waitcnt lgkmcnt(12)
    v_mfma_f32_16x16x32_bf16 v[112:115], v[248:251], v[16:19], v[112:115]
    v_add_u32 v14, 131072, v5
    v_mfma_f32_16x16x32_bf16 v[116:119], v[248:251], v[20:23], v[116:119]
    ds_read_b64_tr_b16 v[240:241], v14 offset:0
    v_mfma_f32_16x16x32_bf16 v[120:123], v[248:251], v[24:27], v[120:123]
    ds_read_b64_tr_b16 v[242:243], v14 offset:2048
    v_cvt_pk_bf16_f32 v88, v88, v89
    v_cvt_pk_bf16_f32 v89, v90, v91
    v_mfma_f32_16x16x32_bf16 v[124:127], v[248:251], v[28:31], v[124:127]
    ds_read_b64_tr_b16 v[244:245], v14 offset:4096
    v_cvt_pk_bf16_f32 v90, v92, v93
    v_cvt_pk_bf16_f32 v91, v94, v95
    v_mfma_f32_16x16x32_bf16 v[128:131], v[248:251], v[32:35], v[128:131]
    ds_read_b64_tr_b16 v[246:247], v14 offset:6144
    s_sub_u32 s19, s33, s94
    s_cmp_lt_u32 s19, s95
    s_cbranch_scc1 L_ow1_0
    buffer_store_dwordx4 v[88:91], v7, s[12:15], s33 offen sc1
L_ow1_0_r:
    s_add_u32 s33, s33, 4096
    v_mfma_f32_16x16x32_bf16 v[132:135], v[248:251], v[36:39], v[132:135]
    v_cvt_pk_bf16_f32 v96, v96, v97
    v_cvt_pk_bf16_f32 v97, v98, v99
    s_waitcnt lgkmcnt(14)
    v_mfma_f32_16x16x32_bf16 v[112:115], v[252:255], v[40:43], v[112:115]
    v_cvt_pk_bf16_f32 v98, v100, v101
    v_cvt_pk_bf16_f32 v99, v102, v103
    v_mfma_f32_16x16x32_bf16 v[116:119], v[252:255], v[44:47], v[116:119]
    s_sub_u32 s19, s33, s94
    s_cmp_lt_u32 s19, s95
    s_cbranch_scc1 L_ow1_1
    buffer_store_dwordx4 v[96:99], v7, s[12:15], s33 offen sc1
L_ow1_1_r:
    s_add_u32 s33, s33, 4096
    v_mfma_f32_16x16x32_bf16 v[120:123], v[252:255], v[48:51], v[120:123]
    v_cvt_pk_bf16_f32 v104, v104, v105
    v_cvt_pk_bf16_f32 v105, v106, v107
    v_mfma_f32_16x16x32_bf16 v[124:127], v[252:255], v[52:55], v[124:127]
    v_cvt_pk_bf16_f32 v106, v108, v109
    v_cvt_pk_bf16_f32 v107, v110, v111
    v_mfma_f32_16x16x32_bf16 v[128:131], v[252:255], v[56:59], v[128:131]
    s_sub_u32 s19, s33, s94
    s_cmp_lt_u32 s19, s95
    s_cbranch_scc1 L_ow1_2
    buffer_store_dwordx4 v[104:107], v7, s[12:15], s33 offen sc1
L_ow1_2_r:
    s_add_u32 s33, s33, 4096
    s_cmp_eq_u32 s33, 86016
    s_cselect_b32 s33, 0, s33
    v_mfma_f32_16x16x32_bf16 v[132:135], v[252:255], v[60:63], v[132:135]
    s_nop 1
    ds_read_b128 v[88:91], v6 offset:6144
    ds_read_b128 v[92:95], v6 offset:7168
    ds_read_b128 v[96:99], v6 offset:8192
    ds_read_b128 v[100:103], v6 offset:9216
    ds_read_b128 v[104:107], v6 offset:10240
    ds_read_b128 v[108:111], v6 offset:11264
    s_waitcnt lgkmcnt(15)
    v_mfma_f32_16x16x32_bf16 v[136:139], v[232:235], v[16:19], v[136:139]
    v_add_u32 v15, 90112, v5
    v_mfma_f32_16x16x32_bf16 v[140:143], v[232:235], v[20:23], v[140:143]
    ds_read_b64_tr_b16 v[248:249], v15 offset:0
    v_mfma_f32_16x16x32_bf16 v[144:147], v[232:235], v[24:27], v[144:147]
    ds_read_b64_tr_b16 v[250:251], v15 offset:2048
    v_mfma_f32_16x16x32_bf16 v[148:151], v[232:235], v[28:31], v[148:151]
    ds_read_b64_tr_b16 v[252:253], v15 offset:4096
    v_mfma_f32_16x16x32_bf16 v[152:155], v[232:235], v[32:35], v[152:155]
    ds_read_b64_tr_b16 v[254:255], v15 offset:6144
    v_mfma_f32_16x16x32_bf16 v[156:159], v[232:235], v[36:39], v[156:159]
    v_mfma_f32_16x16x32_bf16 v[136:139], v[236:239], v[40:43], v[136:139]
    v_mfma_f32_16x16x32_bf16 v[140:143], v[236:239], v[44:47], v[140:143]
    v_mfma_f32_16x16x32_bf16 v[144:147], v[236:239], v[48:51], v[144:147]
    v_mfma_f32_16x16x32_bf16 v[148:151], v[236:239], v[52:55], v[148:151]
    v_mfma_f32_16x16x32_bf16 v[152:155], v[236:239], v[56:59], v[152:155]
    v_mfma_f32_16x16x32_bf16 v[156:159], v[236:239], v[60:63], v[156:159]
    s_waitcnt lgkmcnt(12)
    v_mfma_f32_16x16x32_bf16 v[112:115], v[240:243], v[64:67], v[112:115]
    v_add_u32 v15, 147456, v5
    v_mfma_f32_16x16x32_bf16 v[116:119], v[240:243], v[68:71], v[116:119]
    ds_read_b64_tr_b16 v[232:233], v15 offset:0
    v_mfma_f32_16x16x32_bf16 v[120:123], v[240:243], v[72:75], v[120:123]
    ds_read_b64_tr_b16 v[234:235], v15 offset:2048
    v_mfma_f32_16x16x32_bf16 v[124:127], v[240:243], v[76:79], v[124:127]
    ds_read_b64_tr_b16 v[236:237], v15 offset:4096
    v_mfma_f32_16x16x32_bf16 v[128:131], v[240:243], v[80:83], v[128:131]
    ds_read_b64_tr_b16 v[238:239], v15 offset:6144
    v_mfma_f32_16x16x32_bf16 v[132:135], v[240:243], v[84:87], v[132:135]
    s_waitcnt lgkmcnt(13)
    v_mfma_f32_16x16x32_bf16 v[112:115], v[244:247], v[88:91], v[112:115]
    s_waitcnt lgkmcnt(12)
    v_mfma_f32_16x16x32_bf16 v[116:119], v[244:247], v[92:95], v[116:119]
    s_waitcnt lgkmcnt(11)
    v_mfma_f32_16x16x32_bf16 v[120:123], v[244:247], v[96:99], v[120:123]
    s_waitcnt lgkmcnt(10)
    v_mfma_f32_16x16x32_bf16 v[124:127], v[244:247], v[100:103], v[124:127]
    s_waitcnt lgkmcnt(9)
    v_mfma_f32_16x16x32_bf16 v[128:131], v[244:247], v[104:107], v[128:131]
    s_waitcnt lgkmcnt(8)
    v_mfma_f32_16x16x32_bf16 v[132:135], v[244:247], v[108:111], v[132:135]
    s_waitcnt lgkmcnt(6)
    v_mfma_f32_16x16x32_bf16 v[136:139], v[248:251], v[64:67], v[136:139]
    v_add_u32 v14, 122880, v5
    v_mfma_f32_16x16x32_bf16 v[140:143], v[248:251], v[68:71], v[140:143]
    ds_read_b64_tr_b16 v[240:241], v14 offset:0
    v_mfma_f32_16x16x32_bf16 v[144:147], v[248:251], v[72:75], v[144:147]
    ds_read_b64_tr_b16 v[242:243], v14 offset:2048
    v_cvt_pk_bf16_f32 v112, v112, v113
    v_cvt_pk_bf16_f32 v113, v114, v115
    v_mfma_f32_16x16x32_bf16 v[148:151], v[248:251], v[76:79], v[148:151]
    ds_read_b64_tr_b16 v[244:245], v14 offset:4096
    v_cvt_pk_bf16_f32 v114, v116, v117
    v_cvt_pk_bf16_f32 v115, v118, v119
    v_mfma_f32_16x16x32_bf16 v[152:155], v[248:251], v[80:83], v[152:155]
    ds_read_b64_tr_b16 v[246:247], v14 offset:6144
    s_sub_u32 s19, s33, s94
    s_cmp_lt_u32 s19, s95
    s_cbranch_scc1 L_ow2_0
    buffer_store_dwordx4 v[112:115], v7, s[12:15], s33 offen sc1
L_ow2_0_r:
    s_add_u32 s33, s33, 4096
    v_mfma_f32_16x16x32_bf16 v[156:159], v[248:251], v[84:87], v[156:159]
    v_cvt_pk_bf16_f32 v120, v120, v121
    v_cvt_pk_bf16_f32 v121, v122, v123
    s_waitcnt lgkmcnt(8)
    v_mfma_f32_16x16x32_bf16 v[136:139], v[252:255], v[88:91], v[136:139]
    v_cvt_pk_bf16_f32 v122, v124, v125
    v_cvt_pk_bf16_f32 v123, v126, v127
    v_mfma_f32_16x16x32_bf16 v[140:143], v[252:255], v[92:95], v[140:143]
    s_sub_u32 s19, s33, s94
    s_cmp_lt_u32 s19, s95
    s_cbranch_scc1 L_ow2_1
    buffer_store_dwordx4 v[120:123], v7, s[12:15], s33 offen sc1
L_ow2_1_r:
    s_add_u32 s33, s33, 4096
    v_mfma_f32_16x16x32_bf16 v[144:147], v[252:255], v[96:99], v[144:147]
    v_cvt_pk_bf16_f32 v128, v128, v129
    v_cvt_pk_bf16_f32 v129, v130, v131
    v_mfma_f32_16x16x32_bf16 v[148:151], v[252:255], v[100:103], v[148:151]
    v_cvt_pk_bf16_f32 v130, v132, v133
    v_cvt_pk_bf16_f32 v131, v134, v135
    v_mfma_f32_16x16x32_bf16 v[152:155], v[252:255], v[104:107], v[152:155]
    s_sub_u32 s19, s33, s94
    s_cmp_lt_u32 s19, s95
    s_cbranch_scc1 L_ow2_2
    buffer_store_dwordx4 v[128:131], v7, s[12:15], s33 offen sc1
L_ow2_2_r:
    s_add_u32 s33, s33, 4096
    s_cmp_eq_u32 s33, 86016
    s_cselect_b32 s33, 0, s33
    v_mfma_f32_16x16x32_bf16 v[156:159], v[252:255], v[108:111], v[156:159]
    s_waitcnt lgkmcnt(6)
    v_mfma_f32_16x16x32_bf16 v[160:163], v[232:235], v[16:19], v[160:163]
    v_add_u32 v14, 65536, v5
    v_mfma_f32_16x16x32_bf16 v[164:167], v[232:235], v[20:23], v[164:167]
    ds_read_b64_tr_b16 v[248:249], v14 offset:0
    v_mfma_f32_16x16x32_bf16 v[168:171], v[232:235], v[24:27], v[168:171]
    ds_read_b64_tr_b16 v[250:251], v14 offset:2048
    v_cvt_pk_bf16_f32 v136, v136, v137
    v_cvt_pk_bf16_f32 v137, v138, v139
    v_mfma_f32_16x16x32_bf16 v[172:175], v[232:235], v[28:31], v[172:175]
    ds_read_b64_tr_b16 v[252:253], v14 offset:4096
    v_cvt_pk_bf16_f32 v138, v140, v141
    v_cvt_pk_bf16_f32 v139, v142, v143
    v_mfma_f32_16x16x32_bf16 v[176:179], v[232:235], v[32:35], v[176:179]
    ds_read_b64_tr_b16 v[254:255], v14 offset:6144
    s_sub_u32 s19, s33, s94
    s_cmp_lt_u32 s19, s95
    s_cbranch_scc1 L_ow3_0
    buffer_store_dwordx4 v[136:139], v7, s[12:15], s33 offen sc1
L_ow3_0_r:
    s_add_u32 s33, s33, 4096
    v_mfma_f32_16x16x32_bf16 v[180:183], v[232:235], v[36:39], v[180:183]
    v_cvt_pk_bf16_f32 v144, v144, v145
    v_cvt_pk_bf16_f32 v145, v146, v147
    s_waitcnt lgkmcnt(8)
    v_mfma_f32_16x16x32_bf16 v[160:163], v[236:239], v[40:43], v[160:163]
    v_cvt_pk_bf16_f32 v146, v148, v149
    v_cvt_pk_bf16_f32 v147, v150, v151
    v_mfma_f32_16x16x32_bf16 v[164:167], v[236:239], v[44:47], v[164:167]
    s_sub_u32 s19, s33, s94
    s_cmp_lt_u32 s19, s95
    s_cbranch_scc1 L_ow3_1
    buffer_store_dwordx4 v[144:147], v7, s[12:15], s33 offen sc1
L_ow3_1_r:
    s_add_u32 s33, s33, 4096
    v_mfma_f32_16x16x32_bf16 v[168:171], v[236:239], v[48:51], v[168:171]
    v_cvt_pk_bf16_f32 v152, v152, v153
    v_cvt_pk_bf16_f32 v153, v154, v155
    v_mfma_f32_16x16x32_bf16 v[172:175], v[236:239], v[52:55], v[172:175]
    v_cvt_pk_bf16_f32 v154, v156, v157
    v_cvt_pk_bf16_f32 v155, v158, v159
    v_mfma_f32_16x16x32_bf16 v[176:179], v[236:239], v[56:59], v[176:179]
    s_sub_u32 s19, s33, s94
    s_cmp_lt_u32 s19, s95
    s_cbranch_scc1 L_ow3_2
    buffer_store_dwordx4 v[152:155], v7, s[12:15], s33 offen sc1
L_ow3_2_r:
    s_add_u32 s33, s33, 4096
    s_cmp_eq_u32 s33, 86016
    s_cselect_b32 s33, 0, s33
    v_mfma_f32_16x16x32_bf16 v[180:183], v[236:239], v[60:63], v[180:183]
    s_waitcnt lgkmcnt(6)
    v_mfma_f32_16x16x32_bf16 v[160:163], v[240:243], v[64:67], v[160:163]
    v_add_u32 v15, 81920, v5
    v_mfma_f32_16x16x32_bf16 v[164:167], v[240:243], v[68:71], v[164:167]
    ds_read_b64_tr_b16 v[232:233], v15 offset:0
    v_mfma_f32_16x16x32_bf16 v[168:171], v[240:243], v[72:75], v[168:171]
    ds_read_b64_tr_b16 v[234:235], v15 offset:2048
    v_mfma_f32_16x16x32_bf16 v[172:175], v[240:243], v[76:79], v[172:175]
    ds_read_b64_tr_b16 v[236:237], v15 offset:4096
    v_mfma_f32_16x16x32_bf16 v[176:179], v[240:243], v[80:83], v[176:179]
    ds_read_b64_tr_b16 v[238:239], v15 offset:6144
    v_mfma_f32_16x16x32_bf16 v[180:183], v[240:243], v[84:87], v[180:183]
    s_waitcnt lgkmcnt(8)
    v_mfma_f32_16x16x32_bf16 v[160:163], v[244:247], v[88:91], v[160:163]
    v_mfma_f32_16x16x32_bf16 v[164:167], v[244:247], v[92:95], v[164:167]
    v_mfma_f32_16x16x32_bf16 v[168:171], v[244:247], v[96:99], v[168:171]
    v_mfma_f32_16x16x32_bf16 v[172:175], v[244:247], v[100:103], v[172:175]
    v_mfma_f32_16x16x32_bf16 v[176:179], v[244:247], v[104:107], v[176:179]
    v_mfma_f32_16x16x32_bf16 v[180:183], v[244:247], v[108:111], v[180:183]
    s_waitcnt lgkmcnt(6)
    v_mfma_f32_16x16x32_bf16 v[184:187], v[248:251], v[16:19], v[184:187]
    v_add_u32 v15, 32768, v5
    v_mfma_f32_16x16x32_bf16 v[188:191], v[248:251], v[20:23], v[188:191]
    ds_read_b64_tr_b16 v[240:241], v15 offset:0
    v_mfma_f32_16x16x32_bf16 v[192:195], v[248:251], v[24:27], v[192:195]
    ds_read_b64_tr_b16 v[242:243], v15 offset:2048
    v_cvt_pk_bf16_f32 v160, v160, v161
    v_cvt_pk_bf16_f32 v161, v162, v163
    v_mfma_f32_16x16x32_bf16 v[196:199], v[248:251], v[28:31], v[196:199]
    ds_read_b64_tr_b16 v[244:245], v15 offset:4096
    v_cvt_pk_bf16_f32 v162, v164, v165
    v_cvt_pk_bf16_f32 v163, v166, v167
    v_mfma_f32_16x16x32_bf16 v[200:203], v[248:251], v[32:35], v[200:203]
    ds_read_b64_tr_b16 v[246:247], v15 offset:6144
    s_sub_u32 s19, s33, s94
    s_cmp_lt_u32 s19, s95
    s_cbranch_scc1 L_ow4_0
    buffer_store_dwordx4 v[160:163], v7, s[12:15], s33 offen sc1
L_ow4_0_r:
    s_add_u32 s33, s33, 4096
    v_mfma_f32_16x16x32_bf16 v[204:207], v[248:251], v[36:39], v[204:207]
    v_cvt_pk_bf16_f32 v168, v168, v169
    v_cvt_pk_bf16_f32 v169, v170, v171
    s_waitcnt lgkmcnt(8)
    v_mfma_f32_16x16x32_bf16 v[184:187], v[252:255], v[40:43], v[184:187]
    v_cvt_pk_bf16_f32 v170, v172, v173
    v_cvt_pk_bf16_f32 v171, v174, v175
    v_mfma_f32_16x16x32_bf16 v[188:191], v[252:255], v[44:47], v[188:191]
    s_sub_u32 s19, s33, s94
    s_cmp_lt_u32 s19, s95
    s_cbranch_scc1 L_ow4_1
    buffer_store_dwordx4 v[168:171], v7, s[12:15], s33 offen sc1
L_ow4_1_r:
    s_add_u32 s33, s33, 4096
    v_mfma_f32_16x16x32_bf16 v[192:195], v[252:255], v[48:51], v[192:195]
    v_cvt_pk_bf16_f32 v176, v176, v177
    v_cvt_pk_bf16_f32 v177, v178, v179
    v_mfma_f32_16x16x32_bf16 v[196:199], v[252:255], v[52:55], v[196:199]
    v_cvt_pk_bf16_f32 v178, v180, v181
    v_cvt_pk_bf16_f32 v179, v182, v183
    v_mfma_f32_16x16x32_bf16 v[200:203], v[252:255], v[56:59], v[200:203]
    s_sub_u32 s19, s33, s94
    s_cmp_lt_u32 s19, s95
    s_cbranch_scc1 L_ow4_2
    buffer_store_dwordx4 v[176:179], v7, s[12:15], s33 offen sc1
L_ow4_2_r:
    s_add_u32 s33, s33, 4096
    s_cmp_eq_u32 s33, 86016
    s_cselect_b32 s33, 0, s33
    v_mfma_f32_16x16x32_bf16 v[204:207], v[252:255], v[60:63], v[204:207]
    s_waitcnt lgkmcnt(6)
    v_mfma_f32_16x16x32_bf16 v[184:187], v[232:235], v[64:67], v[184:187]
    v_add_u32 v14, 155648, v5
    v_mfma_f32_16x16x32_bf16 v[188:191], v[232:235], v[68:71], v[188:191]
    ds_read_b64_tr_b16 v[248:249], v14 offset:0
    v_mfma_f32_16x16x32_bf16 v[192:195], v[232:235], v[72:75], v[192:195]
    ds_read_b64_tr_b16 v[250:251], v14 offset:2048
    v_mfma_f32_16x16x32_bf16 v[196:199], v[232:235], v[76:79], v[196:199]
    ds_read_b64_tr_b16 v[252:253], v14 offset:4096
    v_mfma_f32_16x16x32_bf16 v[200:203], v[232:235], v[80:83], v[200:203]
    ds_read_b64_tr_b16 v[254:255], v14 offset:6144
    v_mfma_f32_16x16x32_bf16 v[204:207], v[232:235], v[84:87], v[204:207]
    s_waitcnt lgkmcnt(8)
    v_mfma_f32_16x16x32_bf16 v[184:187], v[236:239], v[88:91], v[184:187]
    v_mfma_f32_16x16x32_bf16 v[188:191], v[236:239], v[92:95], v[188:191]
    v_mfma_f32_16x16x32_bf16 v[192:195], v[236:239], v[96:99], v[192:195]
    v_mfma_f32_16x16x32_bf16 v[196:199], v[236:239], v[100:103], v[196:199]
    v_mfma_f32_16x16x32_bf16 v[200:203], v[236:239], v[104:107], v[200:203]
    v_mfma_f32_16x16x32_bf16 v[204:207], v[236:239], v[108:111], v[204:207]
    s_waitcnt lgkmcnt(6)
    v_mfma_f32_16x16x32_bf16 v[208:211], v[240:243], v[16:19], v[208:211]
    v_mfma_f32_16x16x32_bf16 v[212:215], v[240:243], v[20:23], v[212:215]
    v_mfma_f32_16x16x32_bf16 v[216:219], v[240:243], v[24:27], v[216:219]
    v_cvt_pk_bf16_f32 v184, v184, v185
    v_cvt_pk_bf16_f32 v185, v186, v187
    v_mfma_f32_16x16x32_bf16 v[220:223], v[240:243], v[28:31], v[220:223]
    v_cvt_pk_bf16_f32 v186, v188, v189
    v_cvt_pk_bf16_f32 v187, v190, v191
    v_mfma_f32_16x16x32_bf16 v[224:227], v[240:243], v[32:35], v[224:227]
    s_sub_u32 s19, s33, s94
    s_cmp_lt_u32 s19, s95
    s_cbranch_scc1 L_ow5_0
    buffer_store_dwordx4 v[184:187], v7, s[12:15], s33 offen sc1
L_ow5_0_r:
    s_add_u32 s33, s33, 4096
    v_mfma_f32_16x16x32_bf16 v[228:231], v[240:243], v[36:39], v[228:231]
    v_cvt_pk_bf16_f32 v192, v192, v193
    v_cvt_pk_bf16_f32 v193, v194, v195
    s_waitcnt lgkmcnt(4)
    v_mfma_f32_16x16x32_bf16 v[208:211], v[244:247], v[40:43], v[208:211]
    v_cvt_pk_bf16_f32 v194, v196, v197
    v_cvt_pk_bf16_f32 v195, v198, v199
    v_mfma_f32_16x16x32_bf16 v[212:215], v[244:247], v[44:47], v[212:215]
    s_sub_u32 s19, s33, s94
    s_cmp_lt_u32 s19, s95
    s_cbranch_scc1 L_ow5_1
    buffer_store_dwordx4 v[192:195], v7, s[12:15], s33 offen sc1
L_ow5_1_r:
    s_add_u32 s33, s33, 4096
    v_mfma_f32_16x16x32_bf16 v[216:219], v[244:247], v[48:51], v[216:219]
    v_cvt_pk_bf16_f32 v200, v200, v201
    v_cvt_pk_bf16_f32 v201, v202, v203
    v_mfma_f32_16x16x32_bf16 v[220:223], v[244:247], v[52:55], v[220:223]
    v_cvt_pk_bf16_f32 v202, v204, v205
    v_cvt_pk_bf16_f32 v203, v206, v207
    v_mfma_f32_16x16x32_bf16 v[224:227], v[244:247], v[56:59], v[224:227]
    s_sub_u32 s19, s33, s94
    s_cmp_lt_u32 s19, s95
    s_cbranch_scc1 L_ow5_2
    buffer_store_dwordx4 v[200:203], v7, s[12:15], s33 offen sc1
L_ow5_2_r:
    s_add_u32 s33, s33, 4096
    s_cmp_eq_u32 s33, 86016
    s_cselect_b32 s33, 0, s33
    v_mfma_f32_16x16x32_bf16 v[228:231], v[244:247], v[60:63], v[228:231]
    s_waitcnt lgkmcnt(2)
    v_mfma_f32_16x16x32_bf16 v[208:211], v[248:251], v[64:67], v[208:211]
    v_mfma_f32_16x16x32_bf16 v[212:215], v[248:251], v[68:71], v[212:215]
    v_mfma_f32_16x16x32_bf16 v[216:219], v[248:251], v[72:75], v[216:219]
    v_mfma_f32_16x16x32_bf16 v[220:223], v[248:251], v[76:79], v[220:223]
    v_mfma_f32_16x16x32_bf16 v[224:227], v[248:251], v[80:83], v[224:227]
    v_mfma_f32_16x16x32_bf16 v[228:231], v[248:251], v[84:87], v[228:231]
    s_waitcnt lgkmcnt(0)
    v_mfma_f32_16x16x32_bf16 v[208:211], v[252:255], v[88:91], v[208:211]
    v_mfma_f32_16x16x32_bf16 v[212:215], v[252:255], v[92:95], v[212:215]
    v_mfma_f32_16x16x32_bf16 v[216:219], v[252:255], v[96:99], v[216:219]
    v_mfma_f32_16x16x32_bf16 v[220:223], v[252:255], v[100:103], v[220:223]
    v_mfma_f32_16x16x32_bf16 v[224:227], v[252:255], v[104:107], v[224:227]
    v_mfma_f32_16x16x32_bf16 v[228:231], v[252:255], v[108:111], v[228:231]
    s_nop 2
    v_cvt_pk_bf16_f32 v208, v208, v209
    v_cvt_pk_bf16_f32 v209, v210, v211
    v_cvt_pk_bf16_f32 v210, v212, v213
    v_cvt_pk_bf16_f32 v211, v214, v215
    s_sub_u32 s19, s33, s94
    s_cmp_lt_u32 s19, s95
    s_cbranch_scc1 L_ow6_0
    buffer_store_dwordx4 v[208:211], v7, s[12:15], s33 offen sc1
L_ow6_0_r:
    s_add_u32 s33, s33, 4096
    v_cvt_pk_bf16_f32 v216, v216, v217
    v_cvt_pk_bf16_f32 v217, v218, v219
    v_cvt_pk_bf16_f32 v218, v220, v221
    v_cvt_pk_bf16_f32 v219, v222, v223
    s_sub_u32 s19, s33, s94
    s_cmp_lt_u32 s19, s95
    s_cbranch_scc1 L_ow6_1
    buffer_store_dwordx4 v[216:219], v7, s[12:15], s33 offen sc1
L_ow6_1_r:
    s_add_u32 s33, s33, 4096
    v_cvt_pk_bf16_f32 v224, v224, v225
    v_cvt_pk_bf16_f32 v225, v226, v227
    v_cvt_pk_bf16_f32 v226, v228, v229
    v_cvt_pk_bf16_f32 v227, v230, v231
    s_sub_u32 s19, s33, s94
    s_cmp_lt_u32 s19, s95
    s_cbranch_scc1 L_ow6_2
    buffer_store_dwordx4 v[224:227], v7, s[12:15], s33 offen sc1
L_ow6_2_r:
    s_add_u32 s33, s33, 4096
    s_cmp_eq_u32 s33, 86016
    s_cselect_b32 s33, 0, s33
L_red:
    s_nop 11
    s_load_dwordx4 s[40:43], s[0:1], 80
    s_lshr_b32 s19, s16, 2
    s_lshl_b32 s19, s19, 8
    v_add_u32 v1, s19, v0
    s_mul_i32 s94, s22, 21
    s_add_u32 s95, s94, 21
    s_lshr_b32 s94, s94, 2
    s_lshr_b32 s95, s95, 2
    s_sub_u32 s95, s95, s94
    s_lshl_b32 s94, s94, 10
    s_lshl_b32 s95, s95, 10
    s_lshr_b32 s19, s94, 4
    s_lshr_b32 s95, s95, 4
    v_add_u32 v2, s19, v1
    v_lshlrev_b32 v3, 4, v2
    v_mov_b32 v4, 0x200000
    v_cmp_gt_u32 vcc, s95, v1
    s_nop 1
    v_cndmask_b32 v3, v4, v3, vcc
    s_lshl_b32 s48, s21, 3
    s_add_u32 s48, s48, s23
    s_mul_i32 s19, s48, 1376256
    s_add_u32 s44, s60, s19
    s_addc_u32 s45, s61, 0
    s_mov_b32 s46, 1376256
    s_mov_b32 s47, 0x20000
    v_lshrrev_b32 v5, 8, v2
    v_mul_u32_u24 v6, 43, v5
    v_lshrrev_b32 v6, 7, v6
    v_mul_u32_u24 v7, 3, v6
    v_sub_u32 v7, v5, v7
    v_and_b32 v8, 15, v2
    v_lshl_add_u32 v8, v7, 5, v8
    v_mul_u32_u24 v8, 1792, v8
    v_lshl_add_u32 v8, v6, 7, v8
    v_bfe_u32 v9, v2, 4, 4
    v_lshl_add_u32 v8, v9, 3, v8
    v_cndmask_b32 v8, v4, v8, vcc
    s_mul_i32 s49, s23, 172032
    s_mul_i32 s19, s21, 896
    s_add_u32 s49, s49, s19
    s_waitcnt vmcnt(0) lgkmcnt(0)
    s_mov_b64 s[52:53], s[40:41]
    s_mov_b32 s54, 1376256
    s_mov_b32 s55, 0x20000
    s_barrier
    s_cmp_lg_u32 s16, 0
    s_cbranch_scc1 L_go
    s_lshl_b32 s50, s48, 4
    s_mov_b32 s50, 0
    s_mov_b64 s[42:43], s[36:37]
    v_mov_b32 v10, s50
    v_mov_b32 v11, 1
    s_mov_b64 exec, 1
    global_atomic_add v12, v10, v11, s[42:43] sc0
    s_mov_b32 s51, 0
    s_waitcnt vmcnt(0)
    v_add_u32 v12, 1, v12
L_poll:
    s_nop 0
    v_readfirstlane_b32 s50, v12
    s_add_u32 s51, s51, 1
    s_cmp_ge_u32 s50, 16
    s_cbranch_scc1 L_polled
    s_cmp_ge_u32 s51, 200000
    s_cbranch_scc1 L_polled
    global_load_dword v12, v10, s[42:43] sc1
    s_waitcnt vmcnt(0)
    s_branch L_poll
L_polled:
    s_mov_b64 exec, -1
L_go:
    s_barrier
    s_cmp_ge_u32 s16, 6
    s_cbranch_scc1 L_end1
    s_mul_i32 s18, s22, 86016
    s_add_u32 s18, s18, 86016
    s_cmp_eq_u32 s18, 1376256
    s_cselect_b32 s18, 0, s18
    buffer_load_dwordx4 v[36:39], v3, s[44:47], s18 offen sc1
    s_add_u32 s18, s18, 86016
    s_cmp_eq_u32 s18, 1376256
    s_cselect_b32 s18, 0, s18
    buffer_load_dwordx4 v[40:43], v3, s[44:47], s18 offen sc1
    s_add_u32 s18, s18, 86016
    s_cmp_eq_u32 s18, 1376256
    s_cselect_b32 s18, 0, s18
    buffer_load_dwordx4 v[44:47], v3, s[44:47], s18 offen sc1
    s_add_u32 s18, s18, 86016
    s_cmp_eq_u32 s18, 1376256
    s_cselect_b32 s18, 0, s18
    buffer_load_dwordx4 v[48:51], v3, s[44:47], s18 offen sc1
    s_add_u32 s18, s18, 86016
    s_cmp_eq_u32 s18, 1376256
    s_cselect_b32 s18, 0, s18
    buffer_load_dwordx4 v[52:55], v3, s[44:47], s18 offen sc1
    s_add_u32 s18, s18, 86016
    s_cmp_eq_u32 s18, 1376256
    s_cselect_b32 s18, 0, s18
    buffer_load_dwordx4 v[56:59], v3, s[44:47], s18 offen sc1
    s_add_u32 s18, s18, 86016
    s_cmp_eq_u32 s18, 1376256
    s_cselect_b32 s18, 0, s18
    buffer_load_dwordx4 v[60:63], v3, s[44:47], s18 offen sc1
    s_add_u32 s18, s18, 86016
    s_cmp_eq_u32 s18, 1376256
    s_cselect_b32 s18, 0, s18
    buffer_load_dwordx4 v[64:67], v3, s[44:47], s18 offen sc1
    s_add_u32 s18, s18, 86016
    s_cmp_eq_u32 s18, 1376256
    s_cselect_b32 s18, 0, s18
    buffer_load_dwordx4 v[68:71], v3, s[44:47], s18 offen sc1
    s_add_u32 s18, s18, 86016
    s_cmp_eq_u32 s18, 1376256
    s_cselect_b32 s18, 0, s18
    buffer_load_dwordx4 v[72:75], v3, s[44:47], s18 offen sc1
    s_add_u32 s18, s18, 86016
    s_cmp_eq_u32 s18, 1376256
    s_cselect_b32 s18, 0, s18
    buffer_load_dwordx4 v[76:79], v3, s[44:47], s18 offen sc1
    s_add_u32 s18, s18, 86016
    s_cmp_eq_u32 s18, 1376256
    s_cselect_b32 s18, 0, s18
    buffer_load_dwordx4 v[80:83], v3, s[44:47], s18 offen sc1
    s_add_u32 s18, s18, 86016
    s_cmp_eq_u32 s18, 1376256
    s_cselect_b32 s18, 0, s18
    buffer_load_dwordx4 v[84:87], v3, s[44:47], s18 offen sc1
    s_add_u32 s18, s18, 86016
    s_cmp_eq_u32 s18, 1376256
    s_cselect_b32 s18, 0, s18
    buffer_load_dwordx4 v[88:91], v3, s[44:47], s18 offen sc1
    s_add_u32 s18, s18, 86016
    s_cmp_eq_u32 s18, 1376256
    s_cselect_b32 s18, 0, s18
    buffer_load_dwordx4 v[92:95], v3, s[44:47], s18 offen sc1
    v_lshlrev_b32 v1, 4, v1
    v_add_u32 v1, 40960, v1
    ds_read_b128 v[32:35], v1
    s_mov_b32 s50, 0xffff0000
    s_waitcnt lgkmcnt(0)
    v_lshlrev_b32 v16, 16, v32
    v_and_b32 v17, s50, v32
    v_lshlrev_b32 v18, 16, v33
    v_and_b32 v19, s50, v33
    v_lshlrev_b32 v20, 16, v34
    v_and_b32 v21, s50, v34
    v_lshlrev_b32 v22, 16, v35
    v_and_b32 v23, s50, v35
    s_waitcnt vmcnt(14)
    v_lshlrev_b32 v24, 16, v36
    v_and_b32 v25, s50, v36
    v_pk_add_f32 v[16:17], v[16:17], v[24:25]
    v_lshlrev_b32 v26, 16, v37
    v_and_b32 v27, s50, v37
    v_pk_add_f32 v[18:19], v[18:19], v[26:27]
    v_lshlrev_b32 v28, 16, v38
    v_and_b32 v29, s50, v38
    v_pk_add_f32 v[20:21], v[20:21], v[28:29]
    v_lshlrev_b32 v30, 16, v39
    v_and_b32 v31, s50, v39
    v_pk_add_f32 v[22:23], v[22:23], v[30:31]
    s_waitcnt vmcnt(13)
    v_lshlrev_b32 v24, 16, v40
    v_and_b32 v25, s50, v40
    v_pk_add_f32 v[16:17], v[16:17], v[24:25]
    v_lshlrev_b32 v26, 16, v41
    v_and_b32 v27, s50, v41
    v_pk_add_f32 v[18:19], v[18:19], v[26:27]
    v_lshlrev_b32 v28, 16, v42
    v_and_b32 v29, s50, v42
    v_pk_add_f32 v[20:21], v[20:21], v[28:29]
    v_lshlrev_b32 v30, 16, v43
    v_and_b32 v31, s50, v43
    v_pk_add_f32 v[22:23], v[22:23], v[30:31]
    s_waitcnt vmcnt(12)
    v_lshlrev_b32 v24, 16, v44
    v_and_b32 v25, s50, v44
    v_pk_add_f32 v[16:17], v[16:17], v[24:25]
    v_lshlrev_b32 v26, 16, v45
    v_and_b32 v27, s50, v45
    v_pk_add_f32 v[18:19], v[18:19], v[26:27]
    v_lshlrev_b32 v28, 16, v46
    v_and_b32 v29, s50, v46
    v_pk_add_f32 v[20:21], v[20:21], v[28:29]
    v_lshlrev_b32 v30, 16, v47
    v_and_b32 v31, s50, v47
    v_pk_add_f32 v[22:23], v[22:23], v[30:31]
    s_waitcnt vmcnt(11)
    v_lshlrev_b32 v24, 16, v48
    v_and_b32 v25, s50, v48
    v_pk_add_f32 v[16:17], v[16:17], v[24:25]
    v_lshlrev_b32 v26, 16, v49
    v_and_b32 v27, s50, v49
    v_pk_add_f32 v[18:19], v[18:19], v[26:27]
    v_lshlrev_b32 v28, 16, v50
    v_and_b32 v29, s50, v50
    v_pk_add_f32 v[20:21], v[20:21], v[28:29]
    v_lshlrev_b32 v30, 16, v51
    v_and_b32 v31, s50, v51
    v_pk_add_f32 v[22:23], v[22:23], v[30:31]
    s_waitcnt vmcnt(10)
    v_lshlrev_b32 v24, 16, v52
    v_and_b32 v25, s50, v52
    v_pk_add_f32 v[16:17], v[16:17], v[24:25]
    v_lshlrev_b32 v26, 16, v53
    v_and_b32 v27, s50, v53
    v_pk_add_f32 v[18:19], v[18:19], v[26:27]
    v_lshlrev_b32 v28, 16, v54
    v_and_b32 v29, s50, v54
    v_pk_add_f32 v[20:21], v[20:21], v[28:29]
    v_lshlrev_b32 v30, 16, v55
    v_and_b32 v31, s50, v55
    v_pk_add_f32 v[22:23], v[22:23], v[30:31]
    s_waitcnt vmcnt(9)
    v_lshlrev_b32 v24, 16, v56
    v_and_b32 v25, s50, v56
    v_pk_add_f32 v[16:17], v[16:17], v[24:25]
    v_lshlrev_b32 v26, 16, v57
    v_and_b32 v27, s50, v57
    v_pk_add_f32 v[18:19], v[18:19], v[26:27]
    v_lshlrev_b32 v28, 16, v58
    v_and_b32 v29, s50, v58
    v_pk_add_f32 v[20:21], v[20:21], v[28:29]
    v_lshlrev_b32 v30, 16, v59
    v_and_b32 v31, s50, v59
    v_pk_add_f32 v[22:23], v[22:23], v[30:31]
    s_waitcnt vmcnt(8)
    v_lshlrev_b32 v24, 16, v60
    v_and_b32 v25, s50, v60
    v_pk_add_f32 v[16:17], v[16:17], v[24:25]
    v_lshlrev_b32 v26, 16, v61
    v_and_b32 v27, s50, v61
    v_pk_add_f32 v[18:19], v[18:19], v[26:27]
    v_lshlrev_b32 v28, 16, v62
    v_and_b32 v29, s50, v62
    v_pk_add_f32 v[20:21], v[20:21], v[28:29]
    v_lshlrev_b32 v30, 16, v63
    v_and_b32 v31, s50, v63
    v_pk_add_f32 v[22:23], v[22:23], v[30:31]
    s_waitcnt vmcnt(7)
    v_lshlrev_b32 v24, 16, v64
    v_and_b32 v25, s50, v64
    v_pk_add_f32 v[16:17], v[16:17], v[24:25]
    v_lshlrev_b32 v26, 16, v65
    v_and_b32 v27, s50, v65
    v_pk_add_f32 v[18:19], v[18:19], v[26:27]
    v_lshlrev_b32 v28, 16, v66
    v_and_b32 v29, s50, v66
    v_pk_add_f32 v[20:21], v[20:21], v[28:29]
    v_lshlrev_b32 v30, 16, v67
    v_and_b32 v31, s50, v67
    v_pk_add_f32 v[22:23], v[22:23], v[30:31]
    s_waitcnt vmcnt(6)
    v_lshlrev_b32 v24, 16, v68
    v_and_b32 v25, s50, v68
    v_pk_add_f32 v[16:17], v[16:17], v[24:25]
    v_lshlrev_b32 v26, 16, v69
    v_and_b32 v27, s50, v69
    v_pk_add_f32 v[18:19], v[18:19], v[26:27]
    v_lshlrev_b32 v28, 16, v70
    v_and_b32 v29, s50, v70
    v_pk_add_f32 v[20:21], v[20:21], v[28:29]
    v_lshlrev_b32 v30, 16, v71
    v_and_b32 v31, s50, v71
    v_pk_add_f32 v[22:23], v[22:23], v[30:31]
    s_waitcnt vmcnt(5)
    v_lshlrev_b32 v24, 16, v72
    v_and_b32 v25, s50, v72
    v_pk_add_f32 v[16:17], v[16:17], v[24:25]
    v_lshlrev_b32 v26, 16, v73
    v_and_b32 v27, s50, v73
    v_pk_add_f32 v[18:19], v[18:19], v[26:27]
    v_lshlrev_b32 v28, 16, v74
    v_and_b32 v29, s50, v74
    v_pk_add_f32 v[20:21], v[20:21], v[28:29]
    v_lshlrev_b32 v30, 16, v75
    v_and_b32 v31, s50, v75
    v_pk_add_f32 v[22:23], v[22:23], v[30:31]
    s_waitcnt vmcnt(4)
    v_lshlrev_b32 v24, 16, v76
    v_and_b32 v25, s50, v76
    v_pk_add_f32 v[16:17], v[16:17], v[24:25]
    v_lshlrev_b32 v26, 16, v77
    v_and_b32 v27, s50, v77
    v_pk_add_f32 v[18:19], v[18:19], v[26:27]
    v_lshlrev_b32 v28, 16, v78
    v_and_b32 v29, s50, v78
    v_pk_add_f32 v[20:21], v[20:21], v[28:29]
    v_lshlrev_b32 v30, 16, v79
    v_and_b32 v31, s50, v79
    v_pk_add_f32 v[22:23], v[22:23], v[30:31]
    s_waitcnt vmcnt(3)
    v_lshlrev_b32 v24, 16, v80
    v_and_b32 v25, s50, v80
    v_pk_add_f32 v[16:17], v[16:17], v[24:25]
    v_lshlrev_b32 v26, 16, v81
    v_and_b32 v27, s50, v81
    v_pk_add_f32 v[18:19], v[18:19], v[26:27]
    v_lshlrev_b32 v28, 16, v82
    v_and_b32 v29, s50, v82
    v_pk_add_f32 v[20:21], v[20:21], v[28:29]
    v_lshlrev_b32 v30, 16, v83
    v_and_b32 v31, s50, v83
    v_pk_add_f32 v[22:23], v[22:23], v[30:31]
    s_waitcnt vmcnt(2)
    v_lshlrev_b32 v24, 16, v84
    v_and_b32 v25, s50, v84
    v_pk_add_f32 v[16:17], v[16:17], v[24:25]
    v_lshlrev_b32 v26, 16, v85
    v_and_b32 v27, s50, v85
    v_pk_add_f32 v[18:19], v[18:19], v[26:27]
    v_lshlrev_b32 v28, 16, v86
    v_and_b32 v29, s50, v86
    v_pk_add_f32 v[20:21], v[20:21], v[28:29]
    v_lshlrev_b32 v30, 16, v87
    v_and_b32 v31, s50, v87
    v_pk_add_f32 v[22:23], v[22:23], v[30:31]
    s_waitcnt vmcnt(1)
    v_lshlrev_b32 v24, 16, v88
    v_and_b32 v25, s50, v88
    v_pk_add_f32 v[16:17], v[16:17], v[24:25]
    v_lshlrev_b32 v26, 16, v89
    v_and_b32 v27, s50, v89
    v_pk_add_f32 v[18:19], v[18:19], v[26:27]
    v_lshlrev_b32 v28, 16, v90
    v_and_b32 v29, s50, v90
    v_pk_add_f32 v[20:21], v[20:21], v[28:29]
    v_lshlrev_b32 v30, 16, v91
    v_and_b32 v31, s50, v91
    v_pk_add_f32 v[22:23], v[22:23], v[30:31]
    s_waitcnt vmcnt(0)
    v_lshlrev_b32 v24, 16, v92
    v_and_b32 v25, s50, v92
    v_pk_add_f32 v[16:17], v[16:17], v[24:25]
    v_lshlrev_b32 v26, 16, v93
    v_and_b32 v27, s50, v93
    v_pk_add_f32 v[18:19], v[18:19], v[26:27]
    v_lshlrev_b32 v28, 16, v94
    v_and_b32 v29, s50, v94
    v_pk_add_f32 v[20:21], v[20:21], v[28:29]
    v_lshlrev_b32 v30, 16, v95
    v_and_b32 v31, s50, v95
    v_pk_add_f32 v[22:23], v[22:23], v[30:31]
    v_cvt_pk_bf16_f32 v24, v16, v17
    v_cvt_pk_bf16_f32 v25, v18, v19
    v_cvt_pk_bf16_f32 v26, v20, v21
    v_cvt_pk_bf16_f32 v27, v22, v23
    buffer_store_dwordx2 v[24:25], v8, s[52:55], s49 offen
    s_add_u32 s49, s49, 28672
    buffer_store_dwordx2 v[26:27], v8, s[52:55], s49 offen
L_end1:
    s_endpgm
L_ow0_0:
    v_add_u32 v4, s19, v6
    v_add_u32 v4, 40960, v4
    ds_write_b128 v4, v[64:67]
    s_waitcnt lgkmcnt(0)
    s_branch L_ow0_0_r
L_ow0_1:
    v_add_u32 v4, s19, v6
    v_add_u32 v4, 40960, v4
    ds_write_b128 v4, v[72:75]
    s_waitcnt lgkmcnt(0)
    s_branch L_ow0_1_r
L_ow0_2:
    v_add_u32 v4, s19, v6
    v_add_u32 v4, 40960, v4
    ds_write_b128 v4, v[80:83]
    s_waitcnt lgkmcnt(0)
    s_branch L_ow0_2_r
L_ow1_0:
    v_add_u32 v4, s19, v6
    v_add_u32 v4, 40960, v4
    ds_write_b128 v4, v[88:91]
    s_waitcnt lgkmcnt(0)
    s_branch L_ow1_0_r
L_ow1_1:
    v_add_u32 v4, s19, v6
    v_add_u32 v4, 40960, v4
    ds_write_b128 v4, v[96:99]
    s_waitcnt lgkmcnt(0)
    s_branch L_ow1_1_r
L_ow1_2:
    v_add_u32 v4, s19, v6
    v_add_u32 v4, 40960, v4
    ds_write_b128 v4, v[104:107]
    s_waitcnt lgkmcnt(0)
    s_branch L_ow1_2_r
L_ow2_0:
    v_add_u32 v4, s19, v6
    v_add_u32 v4, 40960, v4
    ds_write_b128 v4, v[112:115]
    s_waitcnt lgkmcnt(0)
    s_branch L_ow2_0_r
L_ow2_1:
    v_add_u32 v4, s19, v6
    v_add_u32 v4, 40960, v4
    ds_write_b128 v4, v[120:123]
    s_waitcnt lgkmcnt(0)
    s_branch L_ow2_1_r
L_ow2_2:
    v_add_u32 v4, s19, v6
    v_add_u32 v4, 40960, v4
    ds_write_b128 v4, v[128:131]
    s_waitcnt lgkmcnt(0)
    s_branch L_ow2_2_r
L_ow3_0:
    v_add_u32 v4, s19, v6
    v_add_u32 v4, 40960, v4
    ds_write_b128 v4, v[136:139]
    s_waitcnt lgkmcnt(0)
    s_branch L_ow3_0_r
L_ow3_1:
    v_add_u32 v4, s19, v6
    v_add_u32 v4, 40960, v4
    ds_write_b128 v4, v[144:147]
    s_waitcnt lgkmcnt(0)
    s_branch L_ow3_1_r
L_ow3_2:
    v_add_u32 v4, s19, v6
    v_add_u32 v4, 40960, v4
    ds_write_b128 v4, v[152:155]
    s_waitcnt lgkmcnt(0)
    s_branch L_ow3_2_r
L_ow4_0:
    v_add_u32 v4, s19, v6
    v_add_u32 v4, 40960, v4
    ds_write_b128 v4, v[160:163]
    s_waitcnt lgkmcnt(0)
    s_branch L_ow4_0_r
L_ow4_1:
    v_add_u32 v4, s19, v6
    v_add_u32 v4, 40960, v4
    ds_write_b128 v4, v[168:171]
    s_waitcnt lgkmcnt(0)
    s_branch L_ow4_1_r
L_ow4_2:
    v_add_u32 v4, s19, v6
    v_add_u32 v4, 40960, v4
    ds_write_b128 v4, v[176:179]
    s_waitcnt lgkmcnt(0)
    s_branch L_ow4_2_r
L_ow5_0:
    v_add_u32 v4, s19, v6
    v_add_u32 v4, 40960, v4
    ds_write_b128 v4, v[184:187]
    s_waitcnt lgkmcnt(0)
    s_branch L_ow5_0_r
L_ow5_1:
    v_add_u32 v4, s19, v6
    v_add_u32 v4, 40960, v4
    ds_write_b128 v4, v[192:195]
    s_waitcnt lgkmcnt(0)
    s_branch L_ow5_1_r
L_ow5_2:
    v_add_u32 v4, s19, v6
    v_add_u32 v4, 40960, v4
    ds_write_b128 v4, v[200:203]
    s_waitcnt lgkmcnt(0)
    s_branch L_ow5_2_r
L_ow6_0:
    v_add_u32 v4, s19, v6
    v_add_u32 v4, 40960, v4
    ds_write_b128 v4, v[208:211]
    s_waitcnt lgkmcnt(0)
    s_branch L_ow6_0_r
L_ow6_1:
    v_add_u32 v4, s19, v6
    v_add_u32 v4, 40960, v4
    ds_write_b128 v4, v[216:219]
    s_waitcnt lgkmcnt(0)
    s_branch L_ow6_1_r
L_ow6_2:
    v_add_u32 v4, s19, v6
    v_add_u32 v4, 40960, v4
    ds_write_b128 v4, v[224:227]
    s_waitcnt lgkmcnt(0)
    s_branch L_ow6_2_r
.fill (49152 - (. - concat_heads__mha_block_cached__mha_block_cached__near_ridge_kernel)) / 4, 4, 0xbf810000
.section .rodata,"a"
.p2align 6
.amdhsa_kernel concat_heads__mha_block_cached__mha_block_cached__near_ridge_kernel
  .amdhsa_next_free_vgpr 256
  .amdhsa_next_free_sgpr 102
  .amdhsa_accum_offset 256
  .amdhsa_group_segment_fixed_size 0
  .amdhsa_kernarg_size 104
  .amdhsa_user_sgpr_count 2
  .amdhsa_user_sgpr_kernarg_segment_ptr 1
  .amdhsa_system_sgpr_workgroup_id_x 1
  .amdhsa_float_denorm_mode_32 3
.end_amdhsa_kernel
```
